```python
import torch

def _softmax(x, axis=-1):
    return torch.softmax(x, dim=axis)
def _gelu(x):
    return torch.nn.functional.gelu(x, approximate="tanh")
def _silu(x):
    return torch.nn.functional.silu(x)
def _sigmoid(x):
    return torch.sigmoid(x)
def _layernorm(x, axis=-1, eps=1e-5):
    m = x.mean(dim=axis, keepdim=True)
    v = x.var(dim=axis, keepdim=True, unbiased=False)
    return (x - m) / torch.sqrt(v + eps)
def _scatter_add(tgt, idx, src, axis=0):
    return tgt.clone().index_add_(axis, idx, src)
def _segment_sum(src, seg, n):
    out = torch.zeros((n,) + src.shape[1:], dtype=src.dtype)
    return out.index_add_(0, seg, src)
def _pad(x, pw):
    flat = tuple(v for pair in reversed(pw) for v in pair)
    return torch.nn.functional.pad(x, flat)

kernel_name = 'sequential_preLN__mha_block_cached__glu_gated_reglu__decode'

def setup_inputs():

    _w = (lambda a: (lambda t: t.to(torch.bfloat16) if t.is_floating_point() else t)(torch.as_tensor(a)))
    def _A_setup():
        B, Sq, D = 8, 1, 512
        H, Sk, Dh = 32, 4096, 128
        return {
            "x": _w((lambda *s: torch.randn(*s, dtype=torch.bfloat16) * 0.05)(B, Sq, D)),
            "k_cache": _w((lambda *s: torch.randn(*s, dtype=torch.bfloat16) * 1.6)(B, H, Sk, Dh)),
            "v_cache": _w((lambda *s: torch.randn(*s, dtype=torch.bfloat16) * 0.8)(B, H, Sk, Dh)),
            "wq": _w((lambda *s: torch.randn(*s, dtype=torch.bfloat16) * 1.6)(D, H * Dh) * (D ** -0.5)),
            "wo": _w((lambda *s: torch.randn(*s, dtype=torch.bfloat16) * 0.8)(H * Dh, D) * ((H * Dh) ** -0.5)),
        }
    _A_in = _A_setup()

    def _B_setup():
        B, S, D, F = 8, 1, 512, 1792
        return {
            "x": _w((lambda *s: torch.randn(*s, dtype=torch.bfloat16) * 0.05)(B, S, D)),
            "W_gate": _w((lambda *s: torch.randn(*s, dtype=torch.bfloat16) * 0.4)(D, F) * (2.0 / D) ** 0.5),
            "W_up": _w((lambda *s: torch.randn(*s, dtype=torch.bfloat16) * 0.4)(D, F) * (2.0 / D) ** 0.5),
            "W_down": _w((lambda *s: torch.randn(*s, dtype=torch.bfloat16) * 0.4)(F, D) * (1.0 / F) ** 0.5),
        }
    _B_in = _B_setup()

    return {
        "A_x": _A_in["x"],
        "A_k_cache": _A_in["k_cache"],
        "A_v_cache": _A_in["v_cache"],
        "A_wq": _A_in["wq"],
        "A_wo": _A_in["wo"],
        "B_x": _B_in["x"],
        "B_W_gate": _B_in["W_gate"],
        "B_W_up": _B_in["W_up"],
        "B_W_down": _B_in["W_down"],
    }

def reference(A_x, A_k_cache, A_v_cache, A_wq, A_wo, B_x, B_W_gate, B_W_up, B_W_down):
    def _A_ref(x, k_cache, v_cache, wq, wo):
        B, Sq, D = x.shape
        H, Dh = 32, 128
        q = (lambda x, *d: x.permute(*d))((x @ wq).reshape(B, Sq, H, Dh), 0, 2, 1, 3)
        scores = torch.einsum("bhqd,bhkd->bhqk", q, k_cache) * (Dh ** -0.5)
        p = _softmax(scores, axis=-1)
        o = torch.einsum("bhqk,bhkd->bhqd", p, v_cache)
        return (lambda x, *d: x.permute(*d))(o, 0, 2, 1, 3).reshape(B, Sq, H * Dh) @ wo

    def _B_ref(x, W_gate, W_up, W_down):
        gate = torch.einsum("bsd,df->bsf", x, W_gate)
        up = torch.einsum("bsd,df->bsf", x, W_up)
        gate = gate * (lambda x, dt: x.to(dt))(gate > 0, gate.dtype)
        h = gate * up
        return torch.einsum("bsf,fd->bsd", h, W_down)

    x = A_x
    h = x + _A_ref(_layernorm(x, axis=-1), A_k_cache, A_v_cache, A_wq, A_wo)
    h2 = h + _B_ref(_layernorm(h, axis=-1), B_W_gate, B_W_up, B_W_down)
    return h2
```

```asm
; @launch grid=(256,1,1) block=(256,1,1) lds=10368
.amdgcn_target "amdgcn-amd-amdhsa--gfx950"
.text
.globl sequential_preLN__mha_block_cached__glu_gated_reglu__decode_kernel
.p2align 8
.type sequential_preLN__mha_block_cached__glu_gated_reglu__decode_kernel,@function
sequential_preLN__mha_block_cached__glu_gated_reglu__decode_kernel:
  s_cmp_ge_u32 s2, 256
  s_cbranch_scc1 L_end
  s_memrealtime s[84:85]
  s_load_dwordx16 s[60:75], s[0:1], 0
  s_load_dwordx8 s[76:83], s[0:1], 64
  v_lshrrev_b32 v68, 6, v0
  v_and_b32 v1, 63, v0
  v_readfirstlane_b32 s3, v68
  s_lshr_b32 s4, s2, 5
  s_and_b32 s5, s2, 31
  s_mov_b32 s90, s4
  s_mov_b32 s91, s5
  s_min_u32 s6, s91, 27
  v_and_b32 v69, 15, v1
  v_lshrrev_b32 v70, 4, v1
  v_lshlrev_b32 v10, 2, v1
  v_lshlrev_b32 v2, 4, v1
  s_and_b32 s50, s3, 1
  s_lshl_b32 s50, s50, 13
  s_lshr_b32 s51, s3, 1
  s_lshl_b32 s51, s51, 15
  s_or_b32 s50, s50, s51
  v_add_u32 v2, s50, v2
  v_xor_b32 v0, 0x2000, v2
  s_add_u32 s94, s3, 0
  s_and_b32 s94, s94, 3
  s_lshl_b32 s94, s94, 8
  s_add_u32 s95, s3, 1
  s_and_b32 s95, s95, 3
  s_lshl_b32 s95, s95, 8
  s_add_u32 s96, s3, 2
  s_and_b32 s96, s96, 3
  s_lshl_b32 s96, s96, 8
  s_add_u32 s97, s3, 3
  s_and_b32 s97, s97, 3
  s_lshl_b32 s97, s97, 8
  v_lshlrev_b32 v71, 4, v69
  s_lshl_b32 s50, s3, 20
  s_lshl_b32 s51, s5, 8
  s_add_u32 s50, s50, s51
  v_lshlrev_b32 v3, 18, v70
  v_add3_u32 v3, v3, v71, s50
  s_mov_b32 s48, 0
  s_bitcmp1_b32 s2, 0
  s_cselect_b32 s49, 540672, 0
  s_or_b32 s48, s48, 40960
  s_add_u32 s48, s48, s49
  s_and_b32 s48, s48, 1003520
  s_bitcmp1_b32 s2, 1
  s_cselect_b32 s49, 196608, 0
  s_or_b32 s48, s48, 40960
  s_add_u32 s48, s48, s49
  s_and_b32 s48, s48, 1003520
  s_bitcmp1_b32 s2, 2
  s_cselect_b32 s49, 409600, 0
  s_or_b32 s48, s48, 40960
  s_add_u32 s48, s48, s49
  s_and_b32 s48, s48, 1003520
  s_bitcmp1_b32 s2, 3
  s_cselect_b32 s49, 724992, 0
  s_or_b32 s48, s48, 40960
  s_add_u32 s48, s48, s49
  s_and_b32 s48, s48, 1003520
  s_bitcmp1_b32 s2, 4
  s_cselect_b32 s49, 524288, 0
  s_or_b32 s48, s48, 40960
  s_add_u32 s48, s48, s49
  s_and_b32 s48, s48, 1003520
  s_bitcmp1_b32 s2, 5
  s_cselect_b32 s49, 217088, 0
  s_or_b32 s48, s48, 40960
  s_add_u32 s48, s48, s49
  s_and_b32 s48, s48, 1003520
  s_bitcmp1_b32 s2, 6
  s_cselect_b32 s49, 790528, 0
  s_or_b32 s48, s48, 40960
  s_add_u32 s48, s48, s49
  s_and_b32 s48, s48, 1003520
  s_bitcmp1_b32 s2, 7
  s_cselect_b32 s49, 282624, 0
  s_or_b32 s48, s48, 40960
  s_add_u32 s48, s48, s49
  s_and_b32 s48, s48, 1003520
  s_and_b32 s48, s48, 1003520
  s_waitcnt lgkmcnt(0)
  s_lshl_b32 s50, s4, 10
  s_add_u32 s32, s60, s50
  s_addc_u32 s33, s61, 0
  s_mov_b32 s34, 1024
  s_mov_b32 s35, 0x20000
  s_lshl_b32 s50, s2, 20
  s_add_u32 s8, s62, s50
  s_addc_u32 s9, s63, 0
  s_mov_b32 s10, 1048576
  s_mov_b32 s11, 0x20000
  buffer_load_dword v76, v10, s[32:35], s94 offen
  buffer_load_dword v77, v10, s[32:35], s95 offen
  buffer_load_dword v78, v10, s[32:35], s96 offen
  buffer_load_dword v79, v10, s[32:35], s97 offen
  s_mov_b32 s16, s66
  s_mov_b32 s17, s67
  s_mov_b32 s18, 4194304
  s_mov_b32 s19, 0x20000
  buffer_load_dwordx4 v[96:99], v2, s[8:11], s48 offen offset:0 nt
  s_mov_b32 s49, 0
  buffer_load_dwordx4 a[0:3], v3, s[16:19], s49 offen nt
  s_mov_b32 s49, 8192
  buffer_load_dwordx4 a[4:7], v3, s[16:19], s49 offen nt
  buffer_load_dwordx4 v[100:103], v2, s[8:11], s48 offen offset:1024 nt
  s_mov_b32 s49, 16384
  buffer_load_dwordx4 a[8:11], v3, s[16:19], s49 offen nt
  buffer_load_dwordx4 v[104:107], v2, s[8:11], s48 offen offset:2048 nt
  s_mov_b32 s49, 24576
  buffer_load_dwordx4 a[12:15], v3, s[16:19], s49 offen nt
  buffer_load_dwordx4 v[108:111], v2, s[8:11], s48 offen offset:3072 nt
  s_or_b32 s48, s48, 40960
  s_add_u32 s48, s48, 4096
  s_and_b32 s48, s48, 1003520
  s_mov_b32 s49, 32768
  buffer_load_dwordx4 a[16:19], v3, s[16:19], s49 offen nt
  buffer_load_dwordx4 v[112:115], v2, s[8:11], s48 offen offset:0 nt
  s_mov_b32 s49, 40960
  buffer_load_dwordx4 a[20:23], v3, s[16:19], s49 offen nt
  s_lshl_b32 s51, s90, 7
  s_load_dwordx2 s[56:57], s[82:83], s51
  s_lshl_b32 s51, s4, 7
  s_load_dwordx2 s[88:89], s[82:83], s51
  s_add_u32 s12, s64, s50
  s_addc_u32 s13, s65, 0
  s_mov_b32 s14, 1048576
  s_mov_b32 s15, 0x20000
  s_lshl_b32 s50, s5, 17
  s_add_u32 s20, s68, s50
  s_addc_u32 s21, s69, 0
  s_mov_b32 s22, 131072
  s_mov_b32 s23, 0x20000
  s_lshl_b32 s50, s6, 16
  s_add_u32 s24, s76, s50
  s_addc_u32 s25, s77, 0
  s_mov_b32 s26, 65536
  s_mov_b32 s27, 0x20000
  s_cmp_ge_u32 s91, 28
  s_cselect_b32 s26, 0, s26
  s_lshl_b32 s50, s90, 10
  s_add_u32 s40, s60, s50
  s_addc_u32 s41, s61, 0
  s_mov_b32 s42, 1024
  s_mov_b32 s43, 0x20000
  s_mov_b32 s36, s78
  s_mov_b32 s37, s79
  s_mov_b32 s38, 8192
  s_mov_b32 s39, 0x20000
  s_mov_b32 s28, s82
  s_mov_b32 s29, s83
  s_mov_b32 s30, 10485760
  s_mov_b32 s31, 0x20000
  s_lshl_b32 s50, s3, 8
  v_lshlrev_b32 v4, 15, v70
  v_add3_u32 v4, v4, v71, s50
  v_lshlrev_b32 v5, 14, v70
  v_add3_u32 v5, v5, v71, s50
  v_cmp_gt_u32 vcc, 8, v69
  v_mov_b32 v72, s74
  v_mov_b32 v73, s72
  v_cndmask_b32 v6, v72, v73, vcc
  v_mov_b32 v72, s75
  v_mov_b32 v73, s73
  v_cndmask_b32 v7, v72, v73, vcc
  s_mul_i32 s50, s3, 458752
  s_lshl_b32 s51, s6, 7
  s_add_u32 s50, s50, s51
  v_mul_u32_u24 v72, 114688, v70
  v_and_b32 v73, 0x70, v71
  v_add3_u32 v72, v72, v73, s50
  s_cmp_ge_u32 s91, 28
  s_cselect_b32 s50, 0, -1
  s_cselect_b32 s98, 0, 7168
  v_and_b32 v72, s50, v72
  v_mov_b32 v73, 0
  v_lshl_add_u64 v[6:7], v[72:73], 0, v[6:7]
  s_mov_b32 s99, 0
  s_lshl_b32 s50, s3, 9
  v_lshlrev_b32 v11, 5, v69
  v_lshlrev_b32 v72, 3, v70
  v_add3_u32 v11, v11, v72, s50
  s_lshl_b32 s50, s2, 12
  v_lshl_add_u32 v8, v11, 1, s50
  s_lshl_b32 s50, s90, 17
  s_lshl_b32 s51, s91, 7
  s_add_u32 s50, s50, s51
  s_lshl_b32 s51, s3, 5
  s_add_u32 s50, s50, s51
  v_lshrrev_b32 v9, 1, v1
  v_lshlrev_b32 v9, 12, v9
  v_and_b32 v72, 16, v71
  v_add3_u32 v9, v9, v72, s50
  s_mov_b32 s86, 65536
  v_lshlrev_b32 v88, 4, v1
  v_lshlrev_b32 v84, 3, v1
  v_add_u32 v84, 4096, v84
  v_add_u32 v85, 6144, v10
  v_lshlrev_b32 v86, 5, v69
  v_and_b32 v87, 4, v10
  v_and_b32 v72, 3, v1
  v_mov_b32 v73, 0xffff
  v_mov_b32 v74, 0xffff0000
  v_mov_b32 v12, 0
  v_mov_b32 v13, 0
  v_cmp_eq_u32 vcc, 0, v72
  s_nop 1
  v_cndmask_b32 v12, v12, v73, vcc
  v_cmp_eq_u32 vcc, 1, v72
  s_nop 1
  v_cndmask_b32 v12, v12, v74, vcc
  v_cmp_eq_u32 vcc, 2, v72
  s_nop 1
  v_cndmask_b32 v13, v13, v73, vcc
  v_cmp_eq_u32 vcc, 3, v72
  s_nop 1
  v_cndmask_b32 v13, v13, v74, vcc
  s_mov_b32 s52, 0xaaaaaaaa
  s_mov_b32 s53, 0xaaaaaaaa
  s_mov_b32 s54, 0xcccccccc
  s_mov_b32 s55, 0xcccccccc
  s_mov_b32 s59, 0x3fb8aa3b
  s_mov_b32 s44, 0x3db504f3
  s_mov_b32 s45, 0xffff
  s_mov_b32 s46, 1114112
  s_lshl_b32 s50, s90, 10
  s_lshl_b32 s51, s91, 5
  s_add_u32 s100, s50, s51
  s_lshl_b32 s51, s3, 3
  s_add_u32 s100, s100, s51
  s_lshl_b32 s47, s100, 2
  s_add_u32 s47, s47, 2162688
  s_lshl_b32 s50, s90, 12
  s_lshl_b32 s94, s3, 10
  s_add_u32 s94, s94, s50
  s_add_u32 s94, s94, 2162688
  s_add_u32 s92, s47, 32768
  s_add_u32 s93, s94, 32768
  s_mov_b32 s87, 2228224
  v_mov_b32 v15, 0xff800000
  s_waitcnt lgkmcnt(0)
  s_mul_i32 s56, s56, 1664525
  s_add_u32 s56, s56, 1013904223
  s_mul_i32 s57, s57, 22695477
  s_add_u32 s57, s57, 1
  s_mul_i32 s88, s88, 1664525
  s_add_u32 s88, s88, 1013904223
  s_mul_i32 s89, s89, 22695477
  s_add_u32 s89, s89, 1
  v_mov_b32 v94, s88
  v_mov_b32 v95, s89
  s_waitcnt vmcnt(11)
  v_lshlrev_b32 v28, 16, v76
  v_and_b32 v29, 0xffff0000, v76
  v_lshlrev_b32 v30, 16, v77
  v_and_b32 v31, 0xffff0000, v77
  v_lshlrev_b32 v32, 16, v78
  v_and_b32 v33, 0xffff0000, v78
  v_lshlrev_b32 v34, 16, v79
  v_and_b32 v35, 0xffff0000, v79
  v_add_f32 v36, v28, v29
  v_add_f32 v37, v30, v31
  v_add_f32 v38, v32, v33
  v_add_f32 v39, v34, v35
  v_add_f32 v36, v36, v38
  v_add_f32 v37, v37, v39
  v_add_f32 v40, v36, v37
  s_nop 1
  v_add_f32_dpp v40, v40, v40 row_ror:8 row_mask:0xf bank_mask:0xf
  s_nop 1
  v_add_f32_dpp v40, v40, v40 row_ror:4 row_mask:0xf bank_mask:0xf
  s_nop 1
  v_add_f32_dpp v40, v40, v40 row_ror:2 row_mask:0xf bank_mask:0xf
  s_nop 1
  v_add_f32_dpp v40, v40, v40 row_ror:1 row_mask:0xf bank_mask:0xf
  v_mov_b32 v41, v40
  s_nop 1
  v_permlane16_swap_b32 v40, v41
  v_add_f32 v40, v40, v41
  v_mov_b32 v41, v40
  s_nop 1
  v_permlane32_swap_b32 v40, v41
  v_add_f32 v40, v40, v41
  v_mul_f32 v40, 0x3b000000, v40
  v_sub_f32 v76, v28, v40
  v_sub_f32 v36, v29, v40
  v_sub_f32 v77, v30, v40
  v_sub_f32 v37, v31, v40
  v_sub_f32 v78, v32, v40
  v_sub_f32 v38, v33, v40
  v_sub_f32 v79, v34, v40
  v_sub_f32 v39, v35, v40
  v_mul_f32 v76, v76, v76
  v_mul_f32 v77, v77, v77
  v_mul_f32 v78, v78, v78
  v_mul_f32 v79, v79, v79
  v_fmac_f32 v76, v36, v36
  v_fmac_f32 v77, v37, v37
  v_fmac_f32 v78, v38, v38
  v_fmac_f32 v79, v39, v39
  v_add_f32 v76, v76, v78
  v_add_f32 v77, v77, v79
  v_add_f32 v76, v76, v77
  s_nop 1
  v_add_f32_dpp v76, v76, v76 row_ror:8 row_mask:0xf bank_mask:0xf
  s_nop 1
  v_add_f32_dpp v76, v76, v76 row_ror:4 row_mask:0xf bank_mask:0xf
  s_nop 1
  v_add_f32_dpp v76, v76, v76 row_ror:2 row_mask:0xf bank_mask:0xf
  s_nop 1
  v_add_f32_dpp v76, v76, v76 row_ror:1 row_mask:0xf bank_mask:0xf
  v_mov_b32 v41, v76
  s_nop 1
  v_permlane16_swap_b32 v76, v41
  v_add_f32 v76, v76, v41
  v_mov_b32 v41, v76
  s_nop 1
  v_permlane32_swap_b32 v76, v41
  v_add_f32 v76, v76, v41
  v_mul_f32 v76, 0x3b000000, v76
  v_cvt_pk_bf16_f32 v41, v40, v76
  v_lshlrev_b32 v40, 16, v41
  v_and_b32 v41, 0xffff0000, v41
  v_add_f32 v41, 0x3727c5ac, v41
  v_sub_f32 v28, v28, v40
  v_cvt_pk_bf16_f32 v41, v41, v41
  v_sub_f32 v29, v29, v40
  v_and_b32 v41, 0xffff0000, v41
  v_cvt_pk_bf16_f32 v28, v28, v29
  v_sqrt_f32 v41, v41
  v_and_b32 v29, 0xffff0000, v28
  v_lshlrev_b32 v28, 16, v28
  v_cvt_pk_bf16_f32 v41, v41, v41
  v_and_b32 v41, 0xffff0000, v41
  v_rcp_f32 v40, v41
  s_nop 0
  v_mul_f32 v30, v28, v40
  v_mul_f32 v31, v29, v40
  v_fma_f32 v32, -v30, v41, v28
  v_fma_f32 v33, -v31, v41, v29
  v_fmac_f32 v30, v32, v40
  v_fmac_f32 v31, v33, v40
  v_cvt_pk_bf16_f32 v20, v30, v30
  v_cvt_pk_bf16_f32 v21, v31, v31
  s_nop 0
  v_and_b32_dpp v44, v20, v12 quad_perm:[0,0,0,0] row_mask:0xf bank_mask:0xf
  v_and_b32_dpp v45, v20, v13 quad_perm:[0,0,0,0] row_mask:0xf bank_mask:0xf
  v_and_b32_dpp v46, v21, v12 quad_perm:[0,0,0,0] row_mask:0xf bank_mask:0xf
  v_and_b32_dpp v47, v21, v13 quad_perm:[0,0,0,0] row_mask:0xf bank_mask:0xf
  v_and_b32_dpp v48, v20, v12 quad_perm:[1,1,1,1] row_mask:0xf bank_mask:0xf
  v_and_b32_dpp v49, v20, v13 quad_perm:[1,1,1,1] row_mask:0xf bank_mask:0xf
  v_and_b32_dpp v50, v21, v12 quad_perm:[1,1,1,1] row_mask:0xf bank_mask:0xf
  v_and_b32_dpp v51, v21, v13 quad_perm:[1,1,1,1] row_mask:0xf bank_mask:0xf
  v_and_b32_dpp v52, v20, v12 quad_perm:[2,2,2,2] row_mask:0xf bank_mask:0xf
  v_and_b32_dpp v53, v20, v13 quad_perm:[2,2,2,2] row_mask:0xf bank_mask:0xf
  v_and_b32_dpp v54, v21, v12 quad_perm:[2,2,2,2] row_mask:0xf bank_mask:0xf
  v_and_b32_dpp v55, v21, v13 quad_perm:[2,2,2,2] row_mask:0xf bank_mask:0xf
  v_and_b32_dpp v56, v20, v12 quad_perm:[3,3,3,3] row_mask:0xf bank_mask:0xf
  v_and_b32_dpp v57, v20, v13 quad_perm:[3,3,3,3] row_mask:0xf bank_mask:0xf
  v_and_b32_dpp v58, v21, v12 quad_perm:[3,3,3,3] row_mask:0xf bank_mask:0xf
  v_and_b32_dpp v59, v21, v13 quad_perm:[3,3,3,3] row_mask:0xf bank_mask:0xf
  s_waitcnt vmcnt(10)
  buffer_load_dwordx4 v[116:119], v2, s[8:11], s48 offen offset:1024 nt
  s_waitcnt vmcnt(10)
  s_mov_b32 s49, 49152
  buffer_load_dwordx4 a[24:27], v3, s[16:19], s49 offen nt
  v_mfma_f32_4x4x4_16b_bf16 v[60:63], v[44:45], a[0:1], 0 cbsz:2 abid:0
  v_mfma_f32_4x4x4_16b_bf16 v[64:67], v[44:45], a[2:3], 0 cbsz:2 abid:0
  s_waitcnt vmcnt(10)
  s_mov_b32 s49, 57344
  buffer_load_dwordx4 a[28:31], v3, s[16:19], s49 offen nt
  v_mfma_f32_4x4x4_16b_bf16 v[60:63], v[46:47], a[4:5], v[60:63] cbsz:2 abid:0
  v_mfma_f32_4x4x4_16b_bf16 v[64:67], v[46:47], a[6:7], v[64:67] cbsz:2 abid:0
  s_waitcnt vmcnt(10)
  buffer_load_dwordx4 v[120:123], v2, s[8:11], s48 offen offset:2048 nt
  s_waitcnt vmcnt(10)
  s_mov_b32 s49, 65536
  buffer_load_dwordx4 a[32:35], v3, s[16:19], s49 offen nt
  v_mfma_f32_4x4x4_16b_bf16 v[60:63], v[48:49], a[8:9], v[60:63] cbsz:2 abid:0
  v_mfma_f32_4x4x4_16b_bf16 v[64:67], v[48:49], a[10:11], v[64:67] cbsz:2 abid:0
  s_waitcnt vmcnt(10)
  buffer_load_dwordx4 v[124:127], v2, s[8:11], s48 offen offset:3072 nt
  s_or_b32 s48, s48, 40960
  s_add_u32 s48, s48, 4096
  s_and_b32 s48, s48, 1003520
  s_waitcnt vmcnt(10)
  s_mov_b32 s49, 73728
  buffer_load_dwordx4 a[36:39], v3, s[16:19], s49 offen nt
  v_mfma_f32_4x4x4_16b_bf16 v[60:63], v[50:51], a[12:13], v[60:63] cbsz:2 abid:0
  v_mfma_f32_4x4x4_16b_bf16 v[64:67], v[50:51], a[14:15], v[64:67] cbsz:2 abid:0
  s_waitcnt vmcnt(10)
  buffer_load_dwordx4 v[128:131], v2, s[8:11], s48 offen offset:0 nt
  s_waitcnt vmcnt(10)
  s_mov_b32 s49, 81920
  buffer_load_dwordx4 a[40:43], v3, s[16:19], s49 offen nt
  v_mfma_f32_4x4x4_16b_bf16 v[60:63], v[52:53], a[16:17], v[60:63] cbsz:2 abid:0
  v_mfma_f32_4x4x4_16b_bf16 v[64:67], v[52:53], a[18:19], v[64:67] cbsz:2 abid:0
  s_waitcnt vmcnt(10)
  buffer_load_dwordx4 v[132:135], v2, s[8:11], s48 offen offset:1024 nt
  s_waitcnt vmcnt(10)
  s_mov_b32 s49, 90112
  buffer_load_dwordx4 a[44:47], v3, s[16:19], s49 offen nt
  v_mfma_f32_4x4x4_16b_bf16 v[60:63], v[54:55], a[20:21], v[60:63] cbsz:2 abid:0
  v_mfma_f32_4x4x4_16b_bf16 v[64:67], v[54:55], a[22:23], v[64:67] cbsz:2 abid:0
  s_waitcnt vmcnt(10)
  buffer_load_dwordx4 v[136:139], v2, s[8:11], s48 offen offset:2048 nt
  s_waitcnt vmcnt(10)
  s_mov_b32 s49, 98304
  buffer_load_dwordx4 a[48:51], v3, s[16:19], s49 offen nt
  v_mfma_f32_4x4x4_16b_bf16 v[60:63], v[56:57], a[24:25], v[60:63] cbsz:2 abid:0
  v_mfma_f32_4x4x4_16b_bf16 v[64:67], v[56:57], a[26:27], v[64:67] cbsz:2 abid:0
  s_waitcnt vmcnt(10)
  s_mov_b32 s49, 106496
  buffer_load_dwordx4 a[52:55], v3, s[16:19], s49 offen nt
  v_mfma_f32_4x4x4_16b_bf16 v[60:63], v[58:59], a[28:29], v[60:63] cbsz:2 abid:0
  v_mfma_f32_4x4x4_16b_bf16 v[64:67], v[58:59], a[30:31], v[64:67] cbsz:2 abid:0
  s_waitcnt vmcnt(10)
  buffer_load_dwordx4 v[140:143], v2, s[8:11], s48 offen offset:3072 nt
  s_or_b32 s48, s48, 40960
  s_add_u32 s48, s48, 4096
  s_and_b32 s48, s48, 1003520
  s_waitcnt vmcnt(10)
  s_mov_b32 s49, 114688
  buffer_load_dwordx4 a[56:59], v3, s[16:19], s49 offen nt
  v_mfma_f32_4x4x4_16b_bf16 v[60:63], v[44:45], a[32:33], v[60:63] cbsz:2 abid:1
  v_mfma_f32_4x4x4_16b_bf16 v[64:67], v[44:45], a[34:35], v[64:67] cbsz:2 abid:1
  s_waitcnt vmcnt(10)
  buffer_load_dwordx4 v[144:147], v2, s[8:11], s48 offen offset:0 nt
  s_waitcnt vmcnt(10)
  s_mov_b32 s49, 122880
  buffer_load_dwordx4 a[60:63], v3, s[16:19], s49 offen nt
  v_mfma_f32_4x4x4_16b_bf16 v[60:63], v[46:47], a[36:37], v[60:63] cbsz:2 abid:1
  v_mfma_f32_4x4x4_16b_bf16 v[64:67], v[46:47], a[38:39], v[64:67] cbsz:2 abid:1
  s_waitcnt vmcnt(10)
  buffer_load_dwordx4 v[148:151], v2, s[8:11], s48 offen offset:1024 nt
  s_waitcnt vmcnt(10)
  s_mov_b32 s49, 131072
  buffer_load_dwordx4 a[64:67], v3, s[16:19], s49 offen nt
  v_mfma_f32_4x4x4_16b_bf16 v[60:63], v[48:49], a[40:41], v[60:63] cbsz:2 abid:1
  v_mfma_f32_4x4x4_16b_bf16 v[64:67], v[48:49], a[42:43], v[64:67] cbsz:2 abid:1
  s_waitcnt vmcnt(10)
  buffer_load_dwordx4 v[152:155], v2, s[8:11], s48 offen offset:2048 nt
  s_waitcnt vmcnt(10)
  s_mov_b32 s49, 139264
  buffer_load_dwordx4 a[68:71], v3, s[16:19], s49 offen nt
  v_mfma_f32_4x4x4_16b_bf16 v[60:63], v[50:51], a[44:45], v[60:63] cbsz:2 abid:1
  v_mfma_f32_4x4x4_16b_bf16 v[64:67], v[50:51], a[46:47], v[64:67] cbsz:2 abid:1
  s_waitcnt vmcnt(10)
  buffer_load_dwordx4 v[156:159], v2, s[8:11], s48 offen offset:3072 nt
  s_or_b32 s48, s48, 40960
  s_add_u32 s48, s48, 4096
  s_and_b32 s48, s48, 1003520
  s_waitcnt vmcnt(10)
  s_mov_b32 s49, 147456
  buffer_load_dwordx4 a[72:75], v3, s[16:19], s49 offen nt
  v_mfma_f32_4x4x4_16b_bf16 v[60:63], v[52:53], a[48:49], v[60:63] cbsz:2 abid:1
  v_mfma_f32_4x4x4_16b_bf16 v[64:67], v[52:53], a[50:51], v[64:67] cbsz:2 abid:1
  s_waitcnt vmcnt(10)
  s_mov_b32 s49, 155648
  buffer_load_dwordx4 a[76:79], v3, s[16:19], s49 offen nt
  v_mfma_f32_4x4x4_16b_bf16 v[60:63], v[54:55], a[52:53], v[60:63] cbsz:2 abid:1
  v_mfma_f32_4x4x4_16b_bf16 v[64:67], v[54:55], a[54:55], v[64:67] cbsz:2 abid:1
  s_waitcnt vmcnt(10)
  buffer_load_dwordx4 v[160:163], v2, s[8:11], s48 offen offset:0 nt
  s_waitcnt vmcnt(10)
  s_mov_b32 s49, 163840
  buffer_load_dwordx4 a[80:83], v3, s[16:19], s49 offen nt
  v_mfma_f32_4x4x4_16b_bf16 v[60:63], v[56:57], a[56:57], v[60:63] cbsz:2 abid:1
  v_mfma_f32_4x4x4_16b_bf16 v[64:67], v[56:57], a[58:59], v[64:67] cbsz:2 abid:1
  s_waitcnt vmcnt(10)
  buffer_load_dwordx4 v[164:167], v2, s[8:11], s48 offen offset:1024 nt
  s_waitcnt vmcnt(10)
  s_mov_b32 s49, 172032
  buffer_load_dwordx4 a[84:87], v3, s[16:19], s49 offen nt
  v_mfma_f32_4x4x4_16b_bf16 v[60:63], v[58:59], a[60:61], v[60:63] cbsz:2 abid:1
  v_mfma_f32_4x4x4_16b_bf16 v[64:67], v[58:59], a[62:63], v[64:67] cbsz:2 abid:1
  s_waitcnt vmcnt(10)
  buffer_load_dwordx4 v[168:171], v2, s[8:11], s48 offen offset:2048 nt
  s_waitcnt vmcnt(10)
  s_mov_b32 s49, 180224
  buffer_load_dwordx4 a[88:91], v3, s[16:19], s49 offen nt
  v_mfma_f32_4x4x4_16b_bf16 v[60:63], v[44:45], a[64:65], v[60:63] cbsz:2 abid:2
  v_mfma_f32_4x4x4_16b_bf16 v[64:67], v[44:45], a[66:67], v[64:67] cbsz:2 abid:2
  s_waitcnt vmcnt(10)
  buffer_load_dwordx4 v[172:175], v2, s[8:11], s48 offen offset:3072 nt
  s_or_b32 s48, s48, 40960
  s_add_u32 s48, s48, 4096
  s_and_b32 s48, s48, 1003520
  s_waitcnt vmcnt(10)
  s_mov_b32 s49, 188416
  buffer_load_dwordx4 a[92:95], v3, s[16:19], s49 offen nt
  v_mfma_f32_4x4x4_16b_bf16 v[60:63], v[46:47], a[68:69], v[60:63] cbsz:2 abid:2
  v_mfma_f32_4x4x4_16b_bf16 v[64:67], v[46:47], a[70:71], v[64:67] cbsz:2 abid:2
  s_waitcnt vmcnt(10)
  buffer_load_dwordx4 v[176:179], v2, s[8:11], s48 offen offset:0 nt
  s_waitcnt vmcnt(10)
  s_mov_b32 s49, 196608
  buffer_load_dwordx4 a[96:99], v3, s[16:19], s49 offen nt
  v_mfma_f32_4x4x4_16b_bf16 v[60:63], v[48:49], a[72:73], v[60:63] cbsz:2 abid:2
  v_mfma_f32_4x4x4_16b_bf16 v[64:67], v[48:49], a[74:75], v[64:67] cbsz:2 abid:2
  s_waitcnt vmcnt(10)
  s_mov_b32 s49, 204800
  buffer_load_dwordx4 a[100:103], v3, s[16:19], s49 offen nt
  v_mfma_f32_4x4x4_16b_bf16 v[60:63], v[50:51], a[76:77], v[60:63] cbsz:2 abid:2
  v_mfma_f32_4x4x4_16b_bf16 v[64:67], v[50:51], a[78:79], v[64:67] cbsz:2 abid:2
  s_waitcnt vmcnt(10)
  buffer_load_dwordx4 v[180:183], v2, s[8:11], s48 offen offset:1024 nt
  s_waitcnt vmcnt(10)
  s_mov_b32 s49, 212992
  buffer_load_dwordx4 a[104:107], v3, s[16:19], s49 offen nt
  v_mfma_f32_4x4x4_16b_bf16 v[60:63], v[52:53], a[80:81], v[60:63] cbsz:2 abid:2
  v_mfma_f32_4x4x4_16b_bf16 v[64:67], v[52:53], a[82:83], v[64:67] cbsz:2 abid:2
  s_waitcnt vmcnt(10)
  buffer_load_dwordx4 v[184:187], v2, s[8:11], s48 offen offset:2048 nt
  s_waitcnt vmcnt(10)
  s_mov_b32 s49, 221184
  buffer_load_dwordx4 a[108:111], v3, s[16:19], s49 offen nt
  v_mfma_f32_4x4x4_16b_bf16 v[60:63], v[54:55], a[84:85], v[60:63] cbsz:2 abid:2
  v_mfma_f32_4x4x4_16b_bf16 v[64:67], v[54:55], a[86:87], v[64:67] cbsz:2 abid:2
  s_waitcnt vmcnt(10)
  buffer_load_dwordx4 v[188:191], v2, s[8:11], s48 offen offset:3072 nt
  s_or_b32 s48, s48, 40960
  s_add_u32 s48, s48, 4096
  s_and_b32 s48, s48, 1003520
  s_waitcnt vmcnt(10)
  s_mov_b32 s49, 229376
  buffer_load_dwordx4 a[112:115], v3, s[16:19], s49 offen nt
  v_mfma_f32_4x4x4_16b_bf16 v[60:63], v[56:57], a[88:89], v[60:63] cbsz:2 abid:2
  v_mfma_f32_4x4x4_16b_bf16 v[64:67], v[56:57], a[90:91], v[64:67] cbsz:2 abid:2
  s_waitcnt vmcnt(10)
  buffer_load_dwordx4 v[192:195], v2, s[8:11], s48 offen offset:0 nt
  s_waitcnt vmcnt(10)
  s_mov_b32 s49, 237568
  buffer_load_dwordx4 a[116:119], v3, s[16:19], s49 offen nt
  v_mfma_f32_4x4x4_16b_bf16 v[60:63], v[58:59], a[92:93], v[60:63] cbsz:2 abid:2
  v_mfma_f32_4x4x4_16b_bf16 v[64:67], v[58:59], a[94:95], v[64:67] cbsz:2 abid:2
  s_waitcnt vmcnt(10)
  buffer_load_dwordx4 v[196:199], v2, s[8:11], s48 offen offset:1024 nt
  s_waitcnt vmcnt(10)
  s_mov_b32 s49, 245760
  buffer_load_dwordx4 a[120:123], v3, s[16:19], s49 offen nt
  v_mfma_f32_4x4x4_16b_bf16 v[60:63], v[44:45], a[96:97], v[60:63] cbsz:2 abid:3
  v_mfma_f32_4x4x4_16b_bf16 v[64:67], v[44:45], a[98:99], v[64:67] cbsz:2 abid:3
  s_waitcnt vmcnt(10)
  s_mov_b32 s49, 253952
  buffer_load_dwordx4 a[124:127], v3, s[16:19], s49 offen nt
  v_mfma_f32_4x4x4_16b_bf16 v[60:63], v[46:47], a[100:101], v[60:63] cbsz:2 abid:3
  v_mfma_f32_4x4x4_16b_bf16 v[64:67], v[46:47], a[102:103], v[64:67] cbsz:2 abid:3
  s_waitcnt vmcnt(9)
  buffer_load_dwordx4 v[200:203], v2, s[8:11], s48 offen offset:2048 nt
  v_mfma_f32_4x4x4_16b_bf16 v[60:63], v[48:49], a[104:105], v[60:63] cbsz:2 abid:3
  v_mfma_f32_4x4x4_16b_bf16 v[64:67], v[48:49], a[106:107], v[64:67] cbsz:2 abid:3
  s_waitcnt vmcnt(8)
  buffer_load_dwordx4 v[204:207], v2, s[8:11], s48 offen offset:3072 nt
  s_or_b32 s48, s48, 40960
  s_add_u32 s48, s48, 4096
  s_and_b32 s48, s48, 1003520
  v_mfma_f32_4x4x4_16b_bf16 v[60:63], v[50:51], a[108:109], v[60:63] cbsz:2 abid:3
  v_mfma_f32_4x4x4_16b_bf16 v[64:67], v[50:51], a[110:111], v[64:67] cbsz:2 abid:3
  s_waitcnt vmcnt(7)
  buffer_load_dwordx4 v[208:211], v2, s[8:11], s48 offen offset:0 nt
  v_mfma_f32_4x4x4_16b_bf16 v[60:63], v[52:53], a[112:113], v[60:63] cbsz:2 abid:3
  v_mfma_f32_4x4x4_16b_bf16 v[64:67], v[52:53], a[114:115], v[64:67] cbsz:2 abid:3
  s_waitcnt vmcnt(6)
  buffer_load_dwordx4 v[212:215], v2, s[8:11], s48 offen offset:1024 nt
  v_mfma_f32_4x4x4_16b_bf16 v[60:63], v[54:55], a[116:117], v[60:63] cbsz:2 abid:3
  v_mfma_f32_4x4x4_16b_bf16 v[64:67], v[54:55], a[118:119], v[64:67] cbsz:2 abid:3
  s_waitcnt vmcnt(5)
  buffer_load_dwordx4 v[216:219], v2, s[8:11], s48 offen offset:2048 nt
  v_mfma_f32_4x4x4_16b_bf16 v[60:63], v[56:57], a[120:121], v[60:63] cbsz:2 abid:3
  v_mfma_f32_4x4x4_16b_bf16 v[64:67], v[56:57], a[122:123], v[64:67] cbsz:2 abid:3
  s_waitcnt vmcnt(5)
  v_mfma_f32_4x4x4_16b_bf16 v[60:63], v[58:59], a[124:125], v[60:63] cbsz:2 abid:3
  v_mfma_f32_4x4x4_16b_bf16 v[64:67], v[58:59], a[126:127], v[64:67] cbsz:2 abid:3
  s_nop 4
  v_permlane32_swap_b32 v60, v64
  v_permlane32_swap_b32 v61, v65
  v_permlane32_swap_b32 v62, v66
  v_permlane32_swap_b32 v63, v67
  v_add_f32 v60, v60, v64
  v_add_f32 v61, v61, v65
  v_add_f32 v62, v62, v66
  v_add_f32 v63, v63, v67
  s_nop 0
  v_permlane16_swap_b32 v60, v62
  v_permlane16_swap_b32 v61, v63
  v_add_f32 v68, v60, v62
  v_add_f32 v69, v61, v63
  ds_write_b64 v11, v[68:69] offset:0
  buffer_load_dwordx4 v[220:223], v2, s[8:11], s48 offen offset:3072 nt
  s_or_b32 s48, s48, 40960
  s_add_u32 s48, s48, 4096
  s_and_b32 s48, s48, 1003520
  s_waitcnt lgkmcnt(0)
  s_barrier
  buffer_load_dwordx4 v[224:227], v0, s[8:11], s48 offen offset:0 nt
  ds_read_b128 v[28:31], v86 offset:0
  ds_read_b128 v[32:35], v86 offset:16
  ds_read_b128 v[36:39], v86 offset:512
  ds_read_b128 v[40:43], v86 offset:528
  ds_read_b128 v[44:47], v86 offset:1024
  ds_read_b128 v[48:51], v86 offset:1040
  ds_read_b128 v[52:55], v86 offset:1536
  ds_read_b128 v[56:59], v86 offset:1552
  s_waitcnt lgkmcnt(0)
  v_add_f32 v28, v28, v36
  v_add_f32 v29, v29, v37
  v_add_f32 v30, v30, v38
  v_add_f32 v31, v31, v39
  v_add_f32 v32, v32, v40
  v_add_f32 v33, v33, v41
  v_add_f32 v34, v34, v42
  v_add_f32 v35, v35, v43
  v_add_f32 v44, v44, v52
  v_add_f32 v45, v45, v53
  v_add_f32 v46, v46, v54
  v_add_f32 v47, v47, v55
  v_add_f32 v48, v48, v56
  v_add_f32 v49, v49, v57
  v_add_f32 v50, v50, v58
  v_add_f32 v51, v51, v59
  v_add_f32 v28, v28, v44
  v_add_f32 v29, v29, v45
  v_add_f32 v30, v30, v46
  v_add_f32 v31, v31, v47
  v_add_f32 v32, v32, v48
  v_add_f32 v33, v33, v49
  v_add_f32 v34, v34, v50
  v_add_f32 v35, v35, v51
  buffer_load_dwordx4 v[228:231], v0, s[8:11], s48 offen offset:1024 nt
  v_cvt_pk_bf16_f32 v16, v28, v29
  v_cvt_pk_bf16_f32 v17, v30, v31
  v_cvt_pk_bf16_f32 v18, v32, v33
  v_cvt_pk_bf16_f32 v19, v34, v35
  s_getpc_b64 s[78:79]
L_pc:
  s_lshl_b32 s50, s3, 7
  s_add_u32 s78, s78, s50
  s_addc_u32 s79, s79, 0
  s_mov_b32 s101, 0
L_blk0:
  s_mov_b32 s82, L_blk3-L_pc
  s_load_dword s83, s[78:79], s82 offset:0
  s_load_dword s83, s[78:79], s82 offset:512
  s_load_dword s83, s[78:79], s82 offset:1024
  s_load_dword s83, s[78:79], s82 offset:1536
  v_dot2_f32_bf16 v20, v96, v16, 0
  v_dot2_f32_bf16 v21, v100, v16, 0
  v_dot2_f32_bf16 v22, v104, v16, 0
  v_dot2_f32_bf16 v23, v108, v16, 0
  v_dot2_f32_bf16 v20, v97, v17, v20
  v_dot2_f32_bf16 v21, v101, v17, v21
  v_dot2_f32_bf16 v22, v105, v17, v22
  v_dot2_f32_bf16 v23, v109, v17, v23
  v_dot2_f32_bf16 v20, v98, v18, v20
  v_dot2_f32_bf16 v21, v102, v18, v21
  v_dot2_f32_bf16 v22, v106, v18, v22
  v_dot2_f32_bf16 v23, v110, v18, v23
  buffer_load_dwordx4 v[232:235], v0, s[8:11], s48 offen offset:2048 nt
  v_dot2_f32_bf16 v20, v99, v19, v20
  v_dot2_f32_bf16 v21, v103, v19, v21
  v_dot2_f32_bf16 v22, v107, v19, v22
  v_dot2_f32_bf16 v23, v111, v19, v23
  v_add_f32_dpp v20, v20, v20 row_ror:8 row_mask:0xf bank_mask:0x3
  v_add_f32_dpp v21, v21, v21 row_ror:8 row_mask:0xf bank_mask:0x3
  v_add_f32_dpp v20, v22, v22 row_ror:8 row_mask:0xf bank_mask:0xc
  v_add_f32_dpp v21, v23, v23 row_ror:8 row_mask:0xf bank_mask:0xc
  s_nop 0
  v_add_f32_dpp v24, v20, v20 row_half_mirror row_mask:0xf bank_mask:0x5
  v_add_f32_dpp v24, v21, v21 row_half_mirror row_mask:0xf bank_mask:0xa
  v_dot2_f32_bf16 v20, v112, v16, 0
  v_dot2_f32_bf16 v21, v116, v16, 0
  v_dot2_f32_bf16 v22, v120, v16, 0
  v_dot2_f32_bf16 v23, v124, v16, 0
  v_dot2_f32_bf16 v20, v113, v17, v20
  v_dot2_f32_bf16 v21, v117, v17, v21
  v_dot2_f32_bf16 v22, v121, v17, v22
  v_dot2_f32_bf16 v23, v125, v17, v23
  v_dot2_f32_bf16 v20, v114, v18, v20
  v_dot2_f32_bf16 v21, v118, v18, v21
  v_dot2_f32_bf16 v22, v122, v18, v22
  v_dot2_f32_bf16 v23, v126, v18, v23
  v_dot2_f32_bf16 v20, v115, v19, v20
  v_dot2_f32_bf16 v21, v119, v19, v21
  v_dot2_f32_bf16 v22, v123, v19, v22
  v_dot2_f32_bf16 v23, v127, v19, v23
  buffer_load_dwordx4 v[96:99], v0, s[8:11], s48 offen offset:3072 nt
  s_or_b32 s48, s48, 40960
  s_add_u32 s48, s48, 4096
  s_and_b32 s48, s48, 1003520
  v_add_f32_dpp v20, v20, v20 row_ror:8 row_mask:0xf bank_mask:0x3
  v_add_f32_dpp v21, v21, v21 row_ror:8 row_mask:0xf bank_mask:0x3
  v_add_f32_dpp v20, v22, v22 row_ror:8 row_mask:0xf bank_mask:0xc
  v_add_f32_dpp v21, v23, v23 row_ror:8 row_mask:0xf bank_mask:0xc
  s_nop 0
  v_add_f32_dpp v25, v20, v20 row_half_mirror row_mask:0xf bank_mask:0x5
  v_add_f32_dpp v25, v21, v21 row_half_mirror row_mask:0xf bank_mask:0xa
  v_dot2_f32_bf16 v20, v128, v16, 0
  v_dot2_f32_bf16 v21, v132, v16, 0
  v_dot2_f32_bf16 v22, v136, v16, 0
  v_dot2_f32_bf16 v23, v140, v16, 0
  v_dot2_f32_bf16 v20, v129, v17, v20
  v_dot2_f32_bf16 v21, v133, v17, v21
  v_dot2_f32_bf16 v22, v137, v17, v22
  v_dot2_f32_bf16 v23, v141, v17, v23
  v_dot2_f32_bf16 v20, v130, v18, v20
  v_dot2_f32_bf16 v21, v134, v18, v21
  v_dot2_f32_bf16 v22, v138, v18, v22
  v_dot2_f32_bf16 v23, v142, v18, v23
  v_dot2_f32_bf16 v20, v131, v19, v20
  v_dot2_f32_bf16 v21, v135, v19, v21
  v_dot2_f32_bf16 v22, v139, v19, v22
  v_dot2_f32_bf16 v23, v143, v19, v23
  v_add_f32_dpp v20, v20, v20 row_ror:8 row_mask:0xf bank_mask:0x3
  v_add_f32_dpp v21, v21, v21 row_ror:8 row_mask:0xf bank_mask:0x3
  v_add_f32_dpp v20, v22, v22 row_ror:8 row_mask:0xf bank_mask:0xc
  v_add_f32_dpp v21, v23, v23 row_ror:8 row_mask:0xf bank_mask:0xc
  s_nop 0
  v_add_f32_dpp v26, v20, v20 row_half_mirror row_mask:0xf bank_mask:0x5
  v_add_f32_dpp v26, v21, v21 row_half_mirror row_mask:0xf bank_mask:0xa
  buffer_load_dwordx4 v[100:103], v0, s[8:11], s48 offen offset:0 nt
  v_dot2_f32_bf16 v20, v144, v16, 0
  v_dot2_f32_bf16 v21, v148, v16, 0
  v_dot2_f32_bf16 v22, v152, v16, 0
  v_dot2_f32_bf16 v23, v156, v16, 0
  v_dot2_f32_bf16 v20, v145, v17, v20
  v_dot2_f32_bf16 v21, v149, v17, v21
  v_dot2_f32_bf16 v22, v153, v17, v22
  v_dot2_f32_bf16 v23, v157, v17, v23
L_blk1:
  v_dot2_f32_bf16 v20, v146, v18, v20
  v_dot2_f32_bf16 v21, v150, v18, v21
  v_dot2_f32_bf16 v22, v154, v18, v22
  v_dot2_f32_bf16 v23, v158, v18, v23
  v_dot2_f32_bf16 v20, v147, v19, v20
  v_dot2_f32_bf16 v21, v151, v19, v21
  v_dot2_f32_bf16 v22, v155, v19, v22
  v_dot2_f32_bf16 v23, v159, v19, v23
  v_add_f32_dpp v20, v20, v20 row_ror:8 row_mask:0xf bank_mask:0x3
  v_add_f32_dpp v21, v21, v21 row_ror:8 row_mask:0xf bank_mask:0x3
  v_add_f32_dpp v20, v22, v22 row_ror:8 row_mask:0xf bank_mask:0xc
  v_add_f32_dpp v21, v23, v23 row_ror:8 row_mask:0xf bank_mask:0xc
  s_nop 0
  v_add_f32_dpp v27, v20, v20 row_half_mirror row_mask:0xf bank_mask:0x5
  v_add_f32_dpp v27, v21, v21 row_half_mirror row_mask:0xf bank_mask:0xa
  v_add_f32_dpp v24, v24, v24 quad_perm:[1,0,3,2] row_mask:0xf bank_mask:0xf
  v_add_f32_dpp v25, v25, v25 quad_perm:[1,0,3,2] row_mask:0xf bank_mask:0xf
  v_add_f32_dpp v26, v26, v26 quad_perm:[1,0,3,2] row_mask:0xf bank_mask:0xf
  v_add_f32_dpp v27, v27, v27 quad_perm:[1,0,3,2] row_mask:0xf bank_mask:0xf
  v_cndmask_b32 v24, v24, v25, s[52:53]
  v_cndmask_b32 v26, v26, v27, s[52:53]
  s_nop 0
  v_add_f32_dpp v24, v24, v24 quad_perm:[2,3,0,1] row_mask:0xf bank_mask:0xf
  v_add_f32_dpp v26, v26, v26 quad_perm:[2,3,0,1] row_mask:0xf bank_mask:0xf
  v_cndmask_b32 v28, v24, v26, s[54:55]
  s_mov_b32 s82, L_blk4-L_pc
  s_load_dword s83, s[78:79], s82 offset:0
  s_load_dword s83, s[78:79], s82 offset:512
  s_load_dword s83, s[78:79], s82 offset:1024
  s_load_dword s83, s[78:79], s82 offset:1536
  v_cvt_pk_bf16_f32 v28, v28, v28
  v_and_b32 v28, 0xffff0000, v28
  v_mul_f32 v28, s44, v28
  v_cvt_pk_bf16_f32 v28, v28, v28
  v_and_b32 v28, 0xffff0000, v28
  v_max_f32 v15, v15, v28
  v_dot2_f32_bf16 v20, v160, v16, 0
  v_dot2_f32_bf16 v21, v164, v16, 0
  v_dot2_f32_bf16 v22, v168, v16, 0
  v_dot2_f32_bf16 v23, v172, v16, 0
  buffer_load_dwordx4 v[104:107], v0, s[8:11], s48 offen offset:1024 nt
  v_dot2_f32_bf16 v20, v161, v17, v20
  v_dot2_f32_bf16 v21, v165, v17, v21
  v_dot2_f32_bf16 v22, v169, v17, v22
  v_dot2_f32_bf16 v23, v173, v17, v23
  v_dot2_f32_bf16 v20, v162, v18, v20
  v_dot2_f32_bf16 v21, v166, v18, v21
  v_dot2_f32_bf16 v22, v170, v18, v22
  v_dot2_f32_bf16 v23, v174, v18, v23
  v_dot2_f32_bf16 v20, v163, v19, v20
  v_dot2_f32_bf16 v21, v167, v19, v21
  v_dot2_f32_bf16 v22, v171, v19, v22
  v_dot2_f32_bf16 v23, v175, v19, v23
  v_add_f32_dpp v20, v20, v20 row_ror:8 row_mask:0xf bank_mask:0x3
  v_add_f32_dpp v21, v21, v21 row_ror:8 row_mask:0xf bank_mask:0x3
  v_add_f32_dpp v20, v22, v22 row_ror:8 row_mask:0xf bank_mask:0xc
  v_add_f32_dpp v21, v23, v23 row_ror:8 row_mask:0xf bank_mask:0xc
  s_nop 0
  v_add_f32_dpp v24, v20, v20 row_half_mirror row_mask:0xf bank_mask:0x5
  v_add_f32_dpp v24, v21, v21 row_half_mirror row_mask:0xf bank_mask:0xa
  v_dot2_f32_bf16 v20, v176, v16, 0
  v_dot2_f32_bf16 v21, v180, v16, 0
  v_dot2_f32_bf16 v22, v184, v16, 0
  v_dot2_f32_bf16 v23, v188, v16, 0
  v_dot2_f32_bf16 v20, v177, v17, v20
  v_dot2_f32_bf16 v21, v181, v17, v21
  v_dot2_f32_bf16 v22, v185, v17, v22
  v_dot2_f32_bf16 v23, v189, v17, v23
  buffer_load_dwordx4 v[108:111], v0, s[8:11], s48 offen offset:2048 nt
  v_dot2_f32_bf16 v20, v178, v18, v20
  v_dot2_f32_bf16 v21, v182, v18, v21
  v_dot2_f32_bf16 v22, v186, v18, v22
  v_dot2_f32_bf16 v23, v190, v18, v23
  s_waitcnt vmcnt(12)
  v_dot2_f32_bf16 v20, v179, v19, v20
  v_dot2_f32_bf16 v21, v183, v19, v21
  v_dot2_f32_bf16 v22, v187, v19, v22
  v_dot2_f32_bf16 v23, v191, v19, v23
  s_waitcnt vmcnt(11)
  v_add_f32_dpp v20, v20, v20 row_ror:8 row_mask:0xf bank_mask:0x3
  v_add_f32_dpp v21, v21, v21 row_ror:8 row_mask:0xf bank_mask:0x3
  v_add_f32_dpp v20, v22, v22 row_ror:8 row_mask:0xf bank_mask:0xc
  v_add_f32_dpp v21, v23, v23 row_ror:8 row_mask:0xf bank_mask:0xc
  s_nop 0
  v_add_f32_dpp v25, v20, v20 row_half_mirror row_mask:0xf bank_mask:0x5
  v_add_f32_dpp v25, v21, v21 row_half_mirror row_mask:0xf bank_mask:0xa
  v_dot2_f32_bf16 v20, v192, v16, 0
  v_dot2_f32_bf16 v21, v196, v16, 0
  v_dot2_f32_bf16 v22, v200, v16, 0
  v_dot2_f32_bf16 v23, v204, v16, 0
  s_waitcnt vmcnt(10)
  v_dot2_f32_bf16 v20, v193, v17, v20
  v_dot2_f32_bf16 v21, v197, v17, v21
  v_dot2_f32_bf16 v22, v201, v17, v22
  v_dot2_f32_bf16 v23, v205, v17, v23
  s_waitcnt vmcnt(9)
  v_dot2_f32_bf16 v20, v194, v18, v20
  v_dot2_f32_bf16 v21, v198, v18, v21
  v_dot2_f32_bf16 v22, v202, v18, v22
  v_dot2_f32_bf16 v23, v206, v18, v23
  s_waitcnt vmcnt(8)
  buffer_load_dwordx4 v[112:115], v0, s[8:11], s48 offen offset:3072 nt
  s_or_b32 s48, s48, 40960
  s_add_u32 s48, s48, 4096
  s_and_b32 s48, s48, 1003520
  v_dot2_f32_bf16 v20, v195, v19, v20
  v_dot2_f32_bf16 v21, v199, v19, v21
  v_dot2_f32_bf16 v22, v203, v19, v22
  v_dot2_f32_bf16 v23, v207, v19, v23
  s_waitcnt vmcnt(8)
  v_add_f32_dpp v20, v20, v20 row_ror:8 row_mask:0xf bank_mask:0x3
  v_add_f32_dpp v21, v21, v21 row_ror:8 row_mask:0xf bank_mask:0x3
  v_add_f32_dpp v20, v22, v22 row_ror:8 row_mask:0xf bank_mask:0xc
  v_add_f32_dpp v21, v23, v23 row_ror:8 row_mask:0xf bank_mask:0xc
  s_nop 0
  v_add_f32_dpp v26, v20, v20 row_half_mirror row_mask:0xf bank_mask:0x5
  v_add_f32_dpp v26, v21, v21 row_half_mirror row_mask:0xf bank_mask:0xa
  v_dot2_f32_bf16 v20, v208, v16, 0
  v_dot2_f32_bf16 v21, v212, v16, 0
  v_dot2_f32_bf16 v22, v216, v16, 0
  v_dot2_f32_bf16 v23, v220, v16, 0
  s_waitcnt vmcnt(7)
L_blk2:
  v_dot2_f32_bf16 v20, v209, v17, v20
  v_dot2_f32_bf16 v21, v213, v17, v21
  v_dot2_f32_bf16 v22, v217, v17, v22
  v_dot2_f32_bf16 v23, v221, v17, v23
  v_dot2_f32_bf16 v20, v210, v18, v20
  v_dot2_f32_bf16 v21, v214, v18, v21
  v_dot2_f32_bf16 v22, v218, v18, v22
  v_dot2_f32_bf16 v23, v222, v18, v23
  s_waitcnt vmcnt(6)
  v_dot2_f32_bf16 v20, v211, v19, v20
  v_dot2_f32_bf16 v21, v215, v19, v21
  v_dot2_f32_bf16 v22, v219, v19, v22
  v_dot2_f32_bf16 v23, v223, v19, v23
  v_add_f32_dpp v20, v20, v20 row_ror:8 row_mask:0xf bank_mask:0x3
  v_add_f32_dpp v21, v21, v21 row_ror:8 row_mask:0xf bank_mask:0x3
  v_add_f32_dpp v20, v22, v22 row_ror:8 row_mask:0xf bank_mask:0xc
  v_add_f32_dpp v21, v23, v23 row_ror:8 row_mask:0xf bank_mask:0xc
  s_nop 0
  v_add_f32_dpp v27, v20, v20 row_half_mirror row_mask:0xf bank_mask:0x5
  v_add_f32_dpp v27, v21, v21 row_half_mirror row_mask:0xf bank_mask:0xa
  s_waitcnt vmcnt(5)
  s_waitcnt vmcnt(4)
  buffer_load_dwordx4 v[116:119], v0, s[8:11], s48 offen offset:0 nt
  s_waitcnt vmcnt(4)
  buffer_load_dwordx4 v[120:123], v0, s[8:11], s48 offen offset:1024 nt
  v_add_f32_dpp v24, v24, v24 quad_perm:[1,0,3,2] row_mask:0xf bank_mask:0xf
  v_add_f32_dpp v25, v25, v25 quad_perm:[1,0,3,2] row_mask:0xf bank_mask:0xf
  v_add_f32_dpp v26, v26, v26 quad_perm:[1,0,3,2] row_mask:0xf bank_mask:0xf
  v_add_f32_dpp v27, v27, v27 quad_perm:[1,0,3,2] row_mask:0xf bank_mask:0xf
  v_cndmask_b32 v24, v24, v25, s[52:53]
  v_cndmask_b32 v26, v26, v27, s[52:53]
  s_nop 0
  v_add_f32_dpp v24, v24, v24 quad_perm:[2,3,0,1] row_mask:0xf bank_mask:0xf
  v_add_f32_dpp v26, v26, v26 quad_perm:[2,3,0,1] row_mask:0xf bank_mask:0xf
  v_cndmask_b32 v29, v24, v26, s[54:55]
  s_mov_b32 s82, L_blk5-L_pc
  s_load_dword s83, s[78:79], s82 offset:0
  s_load_dword s83, s[78:79], s82 offset:512
  s_load_dword s83, s[78:79], s82 offset:1024
  s_load_dword s83, s[78:79], s82 offset:1536
  s_waitcnt vmcnt(4)
  buffer_load_dwordx4 v[124:127], v0, s[8:11], s48 offen offset:2048 nt
  v_cvt_pk_bf16_f32 v29, v29, v29
  v_and_b32 v29, 0xffff0000, v29
  v_mul_f32 v29, s44, v29
  v_cvt_pk_bf16_f32 v29, v29, v29
  v_and_b32 v29, 0xffff0000, v29
  v_max_f32 v15, v15, v29
  v_dot2_f32_bf16 v20, v224, v16, 0
  v_dot2_f32_bf16 v21, v228, v16, 0
  v_dot2_f32_bf16 v22, v232, v16, 0
  v_dot2_f32_bf16 v23, v96, v16, 0
  s_waitcnt vmcnt(4)
  buffer_load_dwordx4 v[128:131], v0, s[8:11], s48 offen offset:3072 nt
  s_or_b32 s48, s48, 40960
  s_add_u32 s48, s48, 4096
  s_and_b32 s48, s48, 1003520
  v_dot2_f32_bf16 v20, v225, v17, v20
  v_dot2_f32_bf16 v21, v229, v17, v21
  v_dot2_f32_bf16 v22, v233, v17, v22
  v_dot2_f32_bf16 v23, v97, v17, v23
  s_waitcnt vmcnt(4)
  buffer_load_dwordx4 v[132:135], v0, s[8:11], s48 offen offset:0 nt
  v_dot2_f32_bf16 v20, v226, v18, v20
  v_dot2_f32_bf16 v21, v230, v18, v21
  v_dot2_f32_bf16 v22, v234, v18, v22
  v_dot2_f32_bf16 v23, v98, v18, v23
  s_waitcnt vmcnt(4)
  buffer_load_dwordx4 v[136:139], v0, s[8:11], s48 offen offset:1024 nt
  v_dot2_f32_bf16 v20, v227, v19, v20
  v_dot2_f32_bf16 v21, v231, v19, v21
  v_dot2_f32_bf16 v22, v235, v19, v22
  v_dot2_f32_bf16 v23, v99, v19, v23
  s_waitcnt vmcnt(4)
  buffer_load_dwordx4 v[140:143], v0, s[8:11], s48 offen offset:2048 nt
  v_add_f32_dpp v20, v20, v20 row_ror:8 row_mask:0xf bank_mask:0x3
  v_add_f32_dpp v21, v21, v21 row_ror:8 row_mask:0xf bank_mask:0x3
  v_add_f32_dpp v20, v22, v22 row_ror:8 row_mask:0xf bank_mask:0xc
  v_add_f32_dpp v21, v23, v23 row_ror:8 row_mask:0xf bank_mask:0xc
  s_nop 0
  v_add_f32_dpp v24, v20, v20 row_half_mirror row_mask:0xf bank_mask:0x5
  v_add_f32_dpp v24, v21, v21 row_half_mirror row_mask:0xf bank_mask:0xa
  v_dot2_f32_bf16 v20, v100, v16, 0
  v_dot2_f32_bf16 v21, v104, v16, 0
  v_dot2_f32_bf16 v22, v108, v16, 0
  v_dot2_f32_bf16 v23, v112, v16, 0
  s_waitcnt vmcnt(4)
  buffer_load_dwordx4 v[144:147], v0, s[8:11], s48 offen offset:3072 nt
  s_or_b32 s48, s48, 40960
  s_add_u32 s48, s48, 4096
  s_and_b32 s48, s48, 1003520
  s_and_b32 s50, s100, 1023
  buffer_load_dword v14, v87, s[40:43], s50 offen
  v_dot2_f32_bf16 v20, v101, v17, v20
  v_dot2_f32_bf16 v21, v105, v17, v21
  v_dot2_f32_bf16 v22, v109, v17, v22
  v_dot2_f32_bf16 v23, v113, v17, v23
  s_waitcnt vmcnt(5)
  buffer_load_dwordx4 v[148:151], v0, s[8:11], s48 offen offset:0 nt
  v_dot2_f32_bf16 v20, v102, v18, v20
  v_dot2_f32_bf16 v21, v106, v18, v21
  v_dot2_f32_bf16 v22, v110, v18, v22
  v_dot2_f32_bf16 v23, v114, v18, v23
  s_waitcnt vmcnt(5)
  buffer_load_dwordx4 v[152:155], v0, s[8:11], s48 offen offset:1024 nt
  s_mov_b32 s49, 0
  buffer_load_dwordx4 a[128:131], v4, s[20:23], s49 offen offset:0 nt
  v_dot2_f32_bf16 v20, v103, v19, v20
  v_dot2_f32_bf16 v21, v107, v19, v21
  v_dot2_f32_bf16 v22, v111, v19, v22
  v_dot2_f32_bf16 v23, v115, v19, v23
  s_waitcnt vmcnt(6)
  buffer_load_dwordx4 v[156:159], v0, s[8:11], s48 offen offset:2048 nt
  v_add_f32_dpp v20, v20, v20 row_ror:8 row_mask:0xf bank_mask:0x3
  v_add_f32_dpp v21, v21, v21 row_ror:8 row_mask:0xf bank_mask:0x3
  v_add_f32_dpp v20, v22, v22 row_ror:8 row_mask:0xf bank_mask:0xc
  v_add_f32_dpp v21, v23, v23 row_ror:8 row_mask:0xf bank_mask:0xc
  s_nop 0
  v_add_f32_dpp v25, v20, v20 row_half_mirror row_mask:0xf bank_mask:0x5
  v_add_f32_dpp v25, v21, v21 row_half_mirror row_mask:0xf bank_mask:0xa
  v_dot2_f32_bf16 v20, v116, v16, 0
  v_dot2_f32_bf16 v21, v120, v16, 0
  v_dot2_f32_bf16 v22, v124, v16, 0
  v_dot2_f32_bf16 v23, v128, v16, 0
  s_waitcnt vmcnt(6)
  buffer_load_dwordx4 v[160:163], v0, s[8:11], s48 offen offset:3072 nt
  s_or_b32 s48, s48, 40960
  s_add_u32 s48, s48, 4096
  s_and_b32 s48, s48, 1003520
  v_dot2_f32_bf16 v20, v117, v17, v20
  v_dot2_f32_bf16 v21, v121, v17, v21
  v_dot2_f32_bf16 v22, v125, v17, v22
  v_dot2_f32_bf16 v23, v129, v17, v23
  s_waitcnt vmcnt(6)
  buffer_load_dwordx4 v[164:167], v0, s[8:11], s48 offen offset:0 nt
  s_mov_b32 s49, 0
  buffer_load_dwordx4 a[132:135], v4, s[20:23], s49 offen offset:1024 nt
  v_dot2_f32_bf16 v20, v118, v18, v20
  v_dot2_f32_bf16 v21, v122, v18, v21
  v_dot2_f32_bf16 v22, v126, v18, v22
  v_dot2_f32_bf16 v23, v130, v18, v23
  s_waitcnt vmcnt(6)
  buffer_load_dwordx4 v[168:171], v0, s[8:11], s48 offen offset:1024 nt
  v_dot2_f32_bf16 v20, v119, v19, v20
  v_dot2_f32_bf16 v21, v123, v19, v21
  v_dot2_f32_bf16 v22, v127, v19, v22
  v_dot2_f32_bf16 v23, v131, v19, v23
  s_waitcnt vmcnt(6)
  buffer_load_dwordx4 v[172:175], v0, s[8:11], s48 offen offset:2048 nt
  s_mov_b32 s49, 0
  buffer_load_dwordx4 a[136:139], v4, s[20:23], s49 offen offset:2048 nt
  v_add_f32_dpp v20, v20, v20 row_ror:8 row_mask:0xf bank_mask:0x3
  v_add_f32_dpp v21, v21, v21 row_ror:8 row_mask:0xf bank_mask:0x3
  v_add_f32_dpp v20, v22, v22 row_ror:8 row_mask:0xf bank_mask:0xc
  v_add_f32_dpp v21, v23, v23 row_ror:8 row_mask:0xf bank_mask:0xc
  s_nop 0
  v_add_f32_dpp v26, v20, v20 row_half_mirror row_mask:0xf bank_mask:0x5
  v_add_f32_dpp v26, v21, v21 row_half_mirror row_mask:0xf bank_mask:0xa
  v_dot2_f32_bf16 v20, v132, v16, 0
  v_dot2_f32_bf16 v21, v136, v16, 0
  v_dot2_f32_bf16 v22, v140, v16, 0
  v_dot2_f32_bf16 v23, v144, v16, 0
  s_memrealtime s[80:81]
L_blk3:
  s_waitcnt vmcnt(6)
  buffer_load_dwordx4 v[176:179], v0, s[8:11], s48 offen offset:3072 nt
  s_or_b32 s48, s48, 40960
  s_add_u32 s48, s48, 4096
  s_and_b32 s48, s48, 1003520
  v_dot2_f32_bf16 v20, v133, v17, v20
  v_dot2_f32_bf16 v21, v137, v17, v21
  v_dot2_f32_bf16 v22, v141, v17, v22
  v_dot2_f32_bf16 v23, v145, v17, v23
  v_dot2_f32_bf16 v20, v134, v18, v20
  v_dot2_f32_bf16 v21, v138, v18, v21
  v_dot2_f32_bf16 v22, v142, v18, v22
  v_dot2_f32_bf16 v23, v146, v18, v23
  s_cmp_ge_i32 s101, 5
  s_cbranch_scc1 L_b49
  s_waitcnt vmcnt(6)
L_b49:
  buffer_load_dwordx4 v[180:183], v0, s[8:11], s48 offen offset:0 nt
  v_dot2_f32_bf16 v20, v135, v19, v20
  v_dot2_f32_bf16 v21, v139, v19, v21
  v_dot2_f32_bf16 v22, v143, v19, v22
  v_dot2_f32_bf16 v23, v147, v19, v23
  v_add_f32_dpp v20, v20, v20 row_ror:8 row_mask:0xf bank_mask:0x3
  v_add_f32_dpp v21, v21, v21 row_ror:8 row_mask:0xf bank_mask:0x3
  v_add_f32_dpp v20, v22, v22 row_ror:8 row_mask:0xf bank_mask:0xc
  v_add_f32_dpp v21, v23, v23 row_ror:8 row_mask:0xf bank_mask:0xc
  s_nop 0
  v_add_f32_dpp v27, v20, v20 row_half_mirror row_mask:0xf bank_mask:0x5
  v_add_f32_dpp v27, v21, v21 row_half_mirror row_mask:0xf bank_mask:0xa
  s_waitcnt lgkmcnt(0)
  s_sub_u32 s101, s80, s84
  s_sub_i32 s101, s101, 879
  s_mul_i32 s101, s101, 2184
  s_ashr_i32 s101, s101, 16
  s_cmp_ge_i32 s101, 7
  s_cbranch_scc1 L_b50
  s_waitcnt vmcnt(7)
  s_cmp_ge_i32 s101, 4
  s_cbranch_scc1 L_b50
  s_waitcnt vmcnt(6)
L_b50:
  buffer_load_dwordx4 v[184:187], v0, s[8:11], s48 offen offset:1024 nt
  s_mov_b32 s49, 0
  buffer_load_dwordx4 a[140:143], v4, s[20:23], s49 offen offset:3072 nt
  v_add_f32_dpp v24, v24, v24 quad_perm:[1,0,3,2] row_mask:0xf bank_mask:0xf
  v_add_f32_dpp v25, v25, v25 quad_perm:[1,0,3,2] row_mask:0xf bank_mask:0xf
  v_add_f32_dpp v26, v26, v26 quad_perm:[1,0,3,2] row_mask:0xf bank_mask:0xf
  v_add_f32_dpp v27, v27, v27 quad_perm:[1,0,3,2] row_mask:0xf bank_mask:0xf
  v_cndmask_b32 v24, v24, v25, s[52:53]
  v_cndmask_b32 v26, v26, v27, s[52:53]
  s_nop 0
  v_add_f32_dpp v24, v24, v24 quad_perm:[2,3,0,1] row_mask:0xf bank_mask:0xf
  v_add_f32_dpp v26, v26, v26 quad_perm:[2,3,0,1] row_mask:0xf bank_mask:0xf
  v_cndmask_b32 v30, v24, v26, s[54:55]
  s_waitcnt vmcnt(9)
  s_mov_b32 s82, L_blk6-L_pc
  s_load_dword s83, s[78:79], s82 offset:0
  s_load_dword s83, s[78:79], s82 offset:512
  s_load_dword s83, s[78:79], s82 offset:1024
  s_load_dword s83, s[78:79], s82 offset:1536
  s_cmp_ge_i32 s101, 8
  s_cbranch_scc1 L_b51
  s_waitcnt vmcnt(8)
  s_cmp_ge_i32 s101, 5
  s_cbranch_scc1 L_b51
  s_waitcnt vmcnt(6)
L_b51:
  buffer_load_dwordx4 v[188:191], v0, s[8:11], s48 offen offset:2048 nt
  v_cvt_pk_bf16_f32 v30, v30, v30
  v_and_b32 v30, 0xffff0000, v30
  v_mul_f32 v30, s44, v30
  v_cvt_pk_bf16_f32 v30, v30, v30
  v_and_b32 v30, 0xffff0000, v30
  v_max_f32 v15, v15, v30
  v_dot2_f32_bf16 v20, v148, v16, 0
  v_dot2_f32_bf16 v21, v152, v16, 0
  v_dot2_f32_bf16 v22, v156, v16, 0
  v_dot2_f32_bf16 v23, v160, v16, 0
  s_waitcnt vmcnt(9)
  s_cmp_ge_i32 s101, 6
  s_cbranch_scc1 L_b52
  s_waitcnt vmcnt(7)
  s_cmp_ge_i32 s101, 3
  s_cbranch_scc1 L_b52
  s_waitcnt vmcnt(6)
L_b52:
  buffer_load_dwordx4 v[96:99], v0, s[8:11], s48 offen offset:3072 nt
  s_or_b32 s48, s48, 40960
  s_add_u32 s48, s48, 4096
  s_and_b32 s48, s48, 1003520
  s_mov_b32 s49, 4096
  buffer_load_dwordx4 a[144:147], v4, s[20:23], s49 offen offset:0 nt
  v_dot2_f32_bf16 v20, v149, v17, v20
  v_dot2_f32_bf16 v21, v153, v17, v21
  v_dot2_f32_bf16 v22, v157, v17, v22
  v_dot2_f32_bf16 v23, v161, v17, v23
  s_waitcnt vmcnt(9)
  s_cmp_ge_i32 s101, 8
  s_cbranch_scc1 L_b53
  s_waitcnt vmcnt(8)
  s_cmp_ge_i32 s101, 5
  s_cbranch_scc1 L_b53
  s_waitcnt vmcnt(6)
L_b53:
  buffer_load_dwordx4 v[100:103], v0, s[8:11], s48 offen offset:0 nt
  v_dot2_f32_bf16 v20, v150, v18, v20
  v_dot2_f32_bf16 v21, v154, v18, v21
  v_dot2_f32_bf16 v22, v158, v18, v22
  v_dot2_f32_bf16 v23, v162, v18, v23
  s_waitcnt vmcnt(9)
  s_cmp_ge_i32 s101, 7
  s_cbranch_scc1 L_b54
  s_waitcnt vmcnt(7)
  s_cmp_ge_i32 s101, 4
  s_cbranch_scc1 L_b54
  s_waitcnt vmcnt(6)
L_b54:
  buffer_load_dwordx4 v[104:107], v0, s[8:11], s48 offen offset:1024 nt
  v_dot2_f32_bf16 v20, v151, v19, v20
  v_dot2_f32_bf16 v21, v155, v19, v21
  v_dot2_f32_bf16 v22, v159, v19, v22
  v_dot2_f32_bf16 v23, v163, v19, v23
  s_waitcnt vmcnt(8)
  s_cmp_ge_i32 s101, 8
  s_cbranch_scc1 L_b55
  s_waitcnt vmcnt(7)
  s_cmp_ge_i32 s101, 5
  s_cbranch_scc1 L_b55
  s_waitcnt vmcnt(6)
L_b55:
  buffer_load_dwordx4 v[108:111], v0, s[8:11], s48 offen offset:2048 nt
  s_mov_b32 s49, 4096
  buffer_load_dwordx4 a[148:151], v4, s[20:23], s49 offen offset:1024 nt
  v_add_f32_dpp v20, v20, v20 row_ror:8 row_mask:0xf bank_mask:0x3
  v_add_f32_dpp v21, v21, v21 row_ror:8 row_mask:0xf bank_mask:0x3
  v_add_f32_dpp v20, v22, v22 row_ror:8 row_mask:0xf bank_mask:0xc
  v_add_f32_dpp v21, v23, v23 row_ror:8 row_mask:0xf bank_mask:0xc
  s_nop 0
  v_add_f32_dpp v24, v20, v20 row_half_mirror row_mask:0xf bank_mask:0x5
  v_add_f32_dpp v24, v21, v21 row_half_mirror row_mask:0xf bank_mask:0xa
  v_dot2_f32_bf16 v20, v164, v16, 0
  v_dot2_f32_bf16 v21, v168, v16, 0
  v_dot2_f32_bf16 v22, v172, v16, 0
  v_dot2_f32_bf16 v23, v176, v16, 0
  s_waitcnt vmcnt(9)
  s_cmp_ge_i32 s101, 6
  s_cbranch_scc1 L_b56
  s_waitcnt vmcnt(8)
  s_cmp_ge_i32 s101, 2
  s_cbranch_scc1 L_b56
  s_waitcnt vmcnt(6)
L_b56:
  buffer_load_dwordx4 v[112:115], v0, s[8:11], s48 offen offset:3072 nt
  s_or_b32 s48, s48, 40960
  s_add_u32 s48, s48, 4096
  s_and_b32 s48, s48, 1003520
  v_dot2_f32_bf16 v20, v165, v17, v20
  v_dot2_f32_bf16 v21, v169, v17, v21
  v_dot2_f32_bf16 v22, v173, v17, v22
  v_dot2_f32_bf16 v23, v177, v17, v23
  s_waitcnt vmcnt(9)
  s_cmp_ge_i32 s101, 8
  s_cbranch_scc1 L_b57
  s_waitcnt vmcnt(7)
  s_cmp_ge_i32 s101, 5
  s_cbranch_scc1 L_b57
  s_waitcnt vmcnt(6)
L_b57:
  buffer_load_dwordx4 v[116:119], v2, s[8:11], s48 offen offset:0 nt
  v_dot2_f32_bf16 v20, v166, v18, v20
  v_dot2_f32_bf16 v21, v170, v18, v21
  v_dot2_f32_bf16 v22, v174, v18, v22
  v_dot2_f32_bf16 v23, v178, v18, v23
  s_waitcnt vmcnt(8)
  s_cmp_ge_i32 s101, 7
  s_cbranch_scc1 L_b58
  s_waitcnt vmcnt(7)
  s_cmp_ge_i32 s101, 4
  s_cbranch_scc1 L_b58
  s_waitcnt vmcnt(5)
L_b58:
  buffer_load_dwordx4 v[120:123], v2, s[8:11], s48 offen offset:1024 nt
  s_mov_b32 s49, 4096
  buffer_load_dwordx4 a[152:155], v4, s[20:23], s49 offen offset:2048 nt
  v_dot2_f32_bf16 v20, v167, v19, v20
  v_dot2_f32_bf16 v21, v171, v19, v21
  v_dot2_f32_bf16 v22, v175, v19, v22
  v_dot2_f32_bf16 v23, v179, v19, v23
  s_waitcnt vmcnt(9)
  s_cmp_ge_i32 s101, 8
  s_cbranch_scc1 L_b59
  s_waitcnt vmcnt(7)
  s_cmp_ge_i32 s101, 5
  s_cbranch_scc1 L_b59
  s_waitcnt vmcnt(6)
L_b59:
  buffer_load_dwordx4 v[124:127], v2, s[8:11], s48 offen offset:2048 nt
  v_add_f32_dpp v20, v20, v20 row_ror:8 row_mask:0xf bank_mask:0x3
  v_add_f32_dpp v21, v21, v21 row_ror:8 row_mask:0xf bank_mask:0x3
  v_add_f32_dpp v20, v22, v22 row_ror:8 row_mask:0xf bank_mask:0xc
  v_add_f32_dpp v21, v23, v23 row_ror:8 row_mask:0xf bank_mask:0xc
  s_nop 0
  v_add_f32_dpp v25, v20, v20 row_half_mirror row_mask:0xf bank_mask:0x5
  v_add_f32_dpp v25, v21, v21 row_half_mirror row_mask:0xf bank_mask:0xa
  v_dot2_f32_bf16 v20, v180, v16, 0
  v_dot2_f32_bf16 v21, v184, v16, 0
  v_dot2_f32_bf16 v22, v188, v16, 0
  v_dot2_f32_bf16 v23, v96, v16, 0
  s_waitcnt vmcnt(8)
  s_cmp_ge_i32 s101, 6
  s_cbranch_scc1 L_b60
  s_waitcnt vmcnt(7)
  s_cmp_ge_i32 s101, 3
  s_cbranch_scc1 L_b60
  s_waitcnt vmcnt(6)
L_b60:
  buffer_load_dwordx4 v[128:131], v2, s[8:11], s48 offen offset:3072 nt
  s_or_b32 s48, s48, 40960
  s_add_u32 s48, s48, 4096
  s_and_b32 s48, s48, 1003520
  s_mov_b32 s49, 4096
  buffer_load_dwordx4 a[156:159], v4, s[20:23], s49 offen offset:3072 nt
  v_dot2_f32_bf16 v20, v181, v17, v20
  v_dot2_f32_bf16 v21, v185, v17, v21
  v_dot2_f32_bf16 v22, v189, v17, v22
  v_dot2_f32_bf16 v23, v97, v17, v23
  s_waitcnt vmcnt(9)
  s_cmp_ge_i32 s101, 8
  s_cbranch_scc1 L_b61
  s_waitcnt vmcnt(8)
  s_cmp_ge_i32 s101, 5
  s_cbranch_scc1 L_b61
  s_waitcnt vmcnt(6)
L_b61:
  buffer_load_dwordx4 v[132:135], v2, s[8:11], s48 offen offset:0 nt
  v_dot2_f32_bf16 v20, v182, v18, v20
  v_dot2_f32_bf16 v21, v186, v18, v21
  v_dot2_f32_bf16 v22, v190, v18, v22
  v_dot2_f32_bf16 v23, v98, v18, v23
  s_waitcnt vmcnt(9)
  s_cmp_ge_i32 s101, 7
  s_cbranch_scc1 L_b62
  s_waitcnt vmcnt(7)
  s_cmp_ge_i32 s101, 4
  s_cbranch_scc1 L_b62
  s_waitcnt vmcnt(6)
L_b62:
  buffer_load_dwordx4 v[136:139], v2, s[8:11], s48 offen offset:1024 nt
  v_dot2_f32_bf16 v20, v183, v19, v20
  v_dot2_f32_bf16 v21, v187, v19, v21
  v_dot2_f32_bf16 v22, v191, v19, v22
  v_dot2_f32_bf16 v23, v99, v19, v23
  s_waitcnt vmcnt(8)
  s_cmp_ge_i32 s101, 8
  s_cbranch_scc1 L_b63
  s_waitcnt vmcnt(7)
  s_cmp_ge_i32 s101, 5
  s_cbranch_scc1 L_b63
  s_waitcnt vmcnt(6)
L_b63:
  buffer_load_dwordx4 v[140:143], v2, s[8:11], s48 offen offset:2048 nt
  s_mov_b32 s49, 8192
  buffer_load_dwordx4 a[160:163], v4, s[20:23], s49 offen offset:0 nt
  v_add_f32_dpp v20, v20, v20 row_ror:8 row_mask:0xf bank_mask:0x3
  v_add_f32_dpp v21, v21, v21 row_ror:8 row_mask:0xf bank_mask:0x3
  v_add_f32_dpp v20, v22, v22 row_ror:8 row_mask:0xf bank_mask:0xc
  v_add_f32_dpp v21, v23, v23 row_ror:8 row_mask:0xf bank_mask:0xc
  s_nop 0
  v_add_f32_dpp v26, v20, v20 row_half_mirror row_mask:0xf bank_mask:0x5
  v_add_f32_dpp v26, v21, v21 row_half_mirror row_mask:0xf bank_mask:0xa
  v_dot2_f32_bf16 v20, v100, v16, 0
  v_dot2_f32_bf16 v21, v104, v16, 0
  v_dot2_f32_bf16 v22, v108, v16, 0
  v_dot2_f32_bf16 v23, v112, v16, 0
  s_waitcnt vmcnt(9)
  s_memrealtime s[80:81]
L_blk4:
  s_cmp_ge_i32 s101, 6
  s_cbranch_scc1 L_b64
  s_waitcnt vmcnt(8)
  s_cmp_ge_i32 s101, 1
  s_cbranch_scc1 L_b64
  s_waitcnt vmcnt(6)
L_b64:
  buffer_load_dwordx4 v[144:147], v2, s[8:11], s48 offen offset:3072 nt
  s_or_b32 s48, s48, 40960
  s_add_u32 s48, s48, 4096
  s_and_b32 s48, s48, 1003520
  v_dot2_f32_bf16 v20, v101, v17, v20
  v_dot2_f32_bf16 v21, v105, v17, v21
  v_dot2_f32_bf16 v22, v109, v17, v22
  v_dot2_f32_bf16 v23, v113, v17, v23
  v_dot2_f32_bf16 v20, v102, v18, v20
  v_dot2_f32_bf16 v21, v106, v18, v21
  v_dot2_f32_bf16 v22, v110, v18, v22
  v_dot2_f32_bf16 v23, v114, v18, v23
  s_waitcnt vmcnt(9)
  s_cmp_ge_i32 s101, 8
  s_cbranch_scc1 L_b65
  s_waitcnt vmcnt(7)
  s_cmp_ge_i32 s101, 5
  s_cbranch_scc1 L_b65
  s_waitcnt vmcnt(6)
L_b65:
  buffer_load_dwordx4 v[148:151], v2, s[8:11], s48 offen offset:0 nt
  s_mov_b32 s49, 8192
  buffer_load_dwordx4 a[164:167], v4, s[20:23], s49 offen offset:1024 nt
  v_dot2_f32_bf16 v20, v103, v19, v20
  v_dot2_f32_bf16 v21, v107, v19, v21
  v_dot2_f32_bf16 v22, v111, v19, v22
  v_dot2_f32_bf16 v23, v115, v19, v23
  v_add_f32_dpp v20, v20, v20 row_ror:8 row_mask:0xf bank_mask:0x3
  v_add_f32_dpp v21, v21, v21 row_ror:8 row_mask:0xf bank_mask:0x3
  v_add_f32_dpp v20, v22, v22 row_ror:8 row_mask:0xf bank_mask:0xc
  v_add_f32_dpp v21, v23, v23 row_ror:8 row_mask:0xf bank_mask:0xc
  s_nop 0
  v_add_f32_dpp v27, v20, v20 row_half_mirror row_mask:0xf bank_mask:0x5
  v_add_f32_dpp v27, v21, v21 row_half_mirror row_mask:0xf bank_mask:0xa
  s_waitcnt vmcnt(9)
  s_waitcnt lgkmcnt(0)
  s_sub_u32 s101, s80, s84
  s_sub_i32 s101, s101, 1107
  s_mul_i32 s101, s101, 2184
  s_ashr_i32 s101, s101, 16
  s_cmp_ge_i32 s101, 7
  s_cbranch_scc1 L_b66
  s_waitcnt vmcnt(8)
  s_cmp_ge_i32 s101, 4
  s_cbranch_scc1 L_b66
  s_waitcnt vmcnt(6)
L_b66:
  buffer_load_dwordx4 v[152:155], v2, s[8:11], s48 offen offset:1024 nt
  v_add_f32_dpp v24, v24, v24 quad_perm:[1,0,3,2] row_mask:0xf bank_mask:0xf
  v_add_f32_dpp v25, v25, v25 quad_perm:[1,0,3,2] row_mask:0xf bank_mask:0xf
  v_add_f32_dpp v26, v26, v26 quad_perm:[1,0,3,2] row_mask:0xf bank_mask:0xf
  v_add_f32_dpp v27, v27, v27 quad_perm:[1,0,3,2] row_mask:0xf bank_mask:0xf
  v_cndmask_b32 v24, v24, v25, s[52:53]
  v_cndmask_b32 v26, v26, v27, s[52:53]
  s_nop 0
  v_add_f32_dpp v24, v24, v24 quad_perm:[2,3,0,1] row_mask:0xf bank_mask:0xf
  v_add_f32_dpp v26, v26, v26 quad_perm:[2,3,0,1] row_mask:0xf bank_mask:0xf
  v_cndmask_b32 v31, v24, v26, s[54:55]
  s_waitcnt vmcnt(9)
  s_mov_b32 s82, L_blk7-L_pc
  s_load_dword s83, s[78:79], s82 offset:0
  s_load_dword s83, s[78:79], s82 offset:512
  s_load_dword s83, s[78:79], s82 offset:1024
  s_load_dword s83, s[78:79], s82 offset:1536
  s_cmp_ge_i32 s101, 8
  s_cbranch_scc1 L_b67
  s_waitcnt vmcnt(7)
  s_cmp_ge_i32 s101, 5
  s_cbranch_scc1 L_b67
  s_waitcnt vmcnt(6)
L_b67:
  buffer_load_dwordx4 v[156:159], v2, s[8:11], s48 offen offset:2048 nt
  v_cvt_pk_bf16_f32 v31, v31, v31
  v_and_b32 v31, 0xffff0000, v31
  v_mul_f32 v31, s44, v31
  v_cvt_pk_bf16_f32 v31, v31, v31
  v_and_b32 v31, 0xffff0000, v31
  v_max_f32 v15, v15, v31
  v_dot2_f32_bf16 v20, v116, v16, 0
  v_dot2_f32_bf16 v21, v120, v16, 0
  v_dot2_f32_bf16 v22, v124, v16, 0
  v_dot2_f32_bf16 v23, v128, v16, 0
  s_waitcnt vmcnt(8)
  s_cmp_ge_i32 s101, 6
  s_cbranch_scc1 L_b68
  s_waitcnt vmcnt(7)
  s_cmp_ge_i32 s101, 3
  s_cbranch_scc1 L_b68
  s_waitcnt vmcnt(6)
L_b68:
  buffer_load_dwordx4 v[160:163], v2, s[8:11], s48 offen offset:3072 nt
  s_or_b32 s48, s48, 40960
  s_add_u32 s48, s48, 4096
  s_and_b32 s48, s48, 1003520
  s_mov_b32 s49, 8192
  buffer_load_dwordx4 a[168:171], v4, s[20:23], s49 offen offset:2048 nt
  v_dot2_f32_bf16 v20, v117, v17, v20
  v_dot2_f32_bf16 v21, v121, v17, v21
  v_dot2_f32_bf16 v22, v125, v17, v22
  v_dot2_f32_bf16 v23, v129, v17, v23
  s_waitcnt vmcnt(9)
  s_cmp_ge_i32 s101, 8
  s_cbranch_scc1 L_b69
  s_waitcnt vmcnt(8)
  s_cmp_ge_i32 s101, 5
  s_cbranch_scc1 L_b69
  s_waitcnt vmcnt(6)
L_b69:
  buffer_load_dwordx4 v[164:167], v2, s[8:11], s48 offen offset:0 nt
  v_dot2_f32_bf16 v20, v118, v18, v20
  v_dot2_f32_bf16 v21, v122, v18, v21
  v_dot2_f32_bf16 v22, v126, v18, v22
  v_dot2_f32_bf16 v23, v130, v18, v23
  s_waitcnt vmcnt(9)
  s_cmp_ge_i32 s101, 7
  s_cbranch_scc1 L_b70
  s_waitcnt vmcnt(7)
  s_cmp_ge_i32 s101, 4
  s_cbranch_scc1 L_b70
  s_waitcnt vmcnt(6)
L_b70:
  buffer_load_dwordx4 v[168:171], v2, s[8:11], s48 offen offset:1024 nt
  v_dot2_f32_bf16 v20, v119, v19, v20
  v_dot2_f32_bf16 v21, v123, v19, v21
  v_dot2_f32_bf16 v22, v127, v19, v22
  v_dot2_f32_bf16 v23, v131, v19, v23
  s_waitcnt vmcnt(8)
  s_cmp_ge_i32 s101, 8
  s_cbranch_scc1 L_b71
  s_waitcnt vmcnt(7)
  s_cmp_ge_i32 s101, 5
  s_cbranch_scc1 L_b71
  s_waitcnt vmcnt(5)
L_b71:
  buffer_load_dwordx4 v[172:175], v2, s[8:11], s48 offen offset:2048 nt
  s_mov_b32 s49, 8192
  buffer_load_dwordx4 a[172:175], v4, s[20:23], s49 offen offset:3072 nt
  v_add_f32_dpp v20, v20, v20 row_ror:8 row_mask:0xf bank_mask:0x3
  v_add_f32_dpp v21, v21, v21 row_ror:8 row_mask:0xf bank_mask:0x3
  v_add_f32_dpp v20, v22, v22 row_ror:8 row_mask:0xf bank_mask:0xc
  v_add_f32_dpp v21, v23, v23 row_ror:8 row_mask:0xf bank_mask:0xc
  s_nop 0
  v_add_f32_dpp v24, v20, v20 row_half_mirror row_mask:0xf bank_mask:0x5
  v_add_f32_dpp v24, v21, v21 row_half_mirror row_mask:0xf bank_mask:0xa
  v_dot2_f32_bf16 v20, v132, v16, 0
  v_dot2_f32_bf16 v21, v136, v16, 0
  v_dot2_f32_bf16 v22, v140, v16, 0
  v_dot2_f32_bf16 v23, v144, v16, 0
  s_waitcnt vmcnt(9)
  s_cmp_ge_i32 s101, 6
  s_cbranch_scc1 L_b72
  s_waitcnt vmcnt(7)
  s_cmp_ge_i32 s101, 2
  s_cbranch_scc1 L_b72
  s_waitcnt vmcnt(6)
L_b72:
  buffer_load_dwordx4 v[176:179], v2, s[8:11], s48 offen offset:3072 nt
  s_or_b32 s48, s48, 40960
  s_add_u32 s48, s48, 4096
  s_and_b32 s48, s48, 1003520
  v_dot2_f32_bf16 v20, v133, v17, v20
  v_dot2_f32_bf16 v21, v137, v17, v21
  v_dot2_f32_bf16 v22, v141, v17, v22
  v_dot2_f32_bf16 v23, v145, v17, v23
  s_waitcnt vmcnt(8)
  s_cmp_ge_i32 s101, 8
  s_cbranch_scc1 L_b73
  s_waitcnt vmcnt(7)
  s_cmp_ge_i32 s101, 5
  s_cbranch_scc1 L_b73
  s_waitcnt vmcnt(6)
L_b73:
  buffer_load_dwordx4 v[180:183], v2, s[8:11], s48 offen offset:0 nt
  s_mov_b32 s49, 12288
  buffer_load_dwordx4 a[176:179], v4, s[20:23], s49 offen offset:0 nt
  v_dot2_f32_bf16 v20, v134, v18, v20
  v_dot2_f32_bf16 v21, v138, v18, v21
  v_dot2_f32_bf16 v22, v142, v18, v22
  v_dot2_f32_bf16 v23, v146, v18, v23
  s_waitcnt vmcnt(9)
  s_cmp_ge_i32 s101, 7
  s_cbranch_scc1 L_b74
  s_waitcnt vmcnt(8)
  s_cmp_ge_i32 s101, 4
  s_cbranch_scc1 L_b74
  s_waitcnt vmcnt(6)
L_b74:
  buffer_load_dwordx4 v[184:187], v2, s[8:11], s48 offen offset:1024 nt
  v_dot2_f32_bf16 v20, v135, v19, v20
  v_dot2_f32_bf16 v21, v139, v19, v21
  v_dot2_f32_bf16 v22, v143, v19, v22
  v_dot2_f32_bf16 v23, v147, v19, v23
  s_waitcnt vmcnt(9)
  s_cmp_ge_i32 s101, 8
  s_cbranch_scc1 L_b75
  s_waitcnt vmcnt(7)
  s_cmp_ge_i32 s101, 5
  s_cbranch_scc1 L_b75
  s_waitcnt vmcnt(6)
L_b75:
  buffer_load_dwordx4 v[188:191], v2, s[8:11], s48 offen offset:2048 nt
  v_add_f32_dpp v20, v20, v20 row_ror:8 row_mask:0xf bank_mask:0x3
  v_add_f32_dpp v21, v21, v21 row_ror:8 row_mask:0xf bank_mask:0x3
  v_add_f32_dpp v20, v22, v22 row_ror:8 row_mask:0xf bank_mask:0xc
  v_add_f32_dpp v21, v23, v23 row_ror:8 row_mask:0xf bank_mask:0xc
  s_nop 0
  v_add_f32_dpp v25, v20, v20 row_half_mirror row_mask:0xf bank_mask:0x5
  v_add_f32_dpp v25, v21, v21 row_half_mirror row_mask:0xf bank_mask:0xa
  v_dot2_f32_bf16 v20, v148, v16, 0
  v_dot2_f32_bf16 v21, v152, v16, 0
  v_dot2_f32_bf16 v22, v156, v16, 0
  v_dot2_f32_bf16 v23, v160, v16, 0
  s_waitcnt vmcnt(8)
  s_cmp_ge_i32 s101, 6
  s_cbranch_scc1 L_b76
  s_waitcnt vmcnt(7)
  s_cmp_ge_i32 s101, 3
  s_cbranch_scc1 L_b76
  s_waitcnt vmcnt(6)
L_b76:
  buffer_load_dwordx4 v[96:99], v2, s[8:11], s48 offen offset:3072 nt
  s_or_b32 s48, s48, 40960
  s_add_u32 s48, s48, 4096
  s_and_b32 s48, s48, 1003520
  s_mov_b32 s49, 12288
  buffer_load_dwordx4 a[180:183], v4, s[20:23], s49 offen offset:1024 nt
  v_dot2_f32_bf16 v20, v149, v17, v20
  v_dot2_f32_bf16 v21, v153, v17, v21
  v_dot2_f32_bf16 v22, v157, v17, v22
  v_dot2_f32_bf16 v23, v161, v17, v23
  s_waitcnt vmcnt(9)
  s_cmp_ge_i32 s101, 8
  s_cbranch_scc1 L_b77
  s_waitcnt vmcnt(8)
  s_cmp_ge_i32 s101, 5
  s_cbranch_scc1 L_b77
  s_waitcnt vmcnt(6)
L_b77:
  buffer_load_dwordx4 v[100:103], v2, s[8:11], s48 offen offset:0 nt
  v_dot2_f32_bf16 v20, v150, v18, v20
  v_dot2_f32_bf16 v21, v154, v18, v21
  v_dot2_f32_bf16 v22, v158, v18, v22
  v_dot2_f32_bf16 v23, v162, v18, v23
  s_waitcnt vmcnt(9)
  s_cmp_ge_i32 s101, 7
  s_cbranch_scc1 L_b78
  s_waitcnt vmcnt(7)
  s_cmp_ge_i32 s101, 4
  s_cbranch_scc1 L_b78
  s_waitcnt vmcnt(6)
L_b78:
  buffer_load_dwordx4 v[104:107], v2, s[8:11], s48 offen offset:1024 nt
  s_mov_b32 s49, 12288
  buffer_load_dwordx4 a[184:187], v4, s[20:23], s49 offen offset:2048 nt
  v_dot2_f32_bf16 v20, v151, v19, v20
  v_dot2_f32_bf16 v21, v155, v19, v21
  v_dot2_f32_bf16 v22, v159, v19, v22
  v_dot2_f32_bf16 v23, v163, v19, v23
  s_waitcnt vmcnt(9)
  s_cmp_ge_i32 s101, 8
  s_cbranch_scc1 L_b79
  s_waitcnt vmcnt(8)
  s_cmp_ge_i32 s101, 5
  s_cbranch_scc1 L_b79
  s_waitcnt vmcnt(6)
L_b79:
  buffer_load_dwordx4 v[108:111], v2, s[8:11], s48 offen offset:2048 nt
  v_add_f32_dpp v20, v20, v20 row_ror:8 row_mask:0xf bank_mask:0x3
  v_add_f32_dpp v21, v21, v21 row_ror:8 row_mask:0xf bank_mask:0x3
  v_add_f32_dpp v20, v22, v22 row_ror:8 row_mask:0xf bank_mask:0xc
  v_add_f32_dpp v21, v23, v23 row_ror:8 row_mask:0xf bank_mask:0xc
  s_nop 0
  v_add_f32_dpp v26, v20, v20 row_half_mirror row_mask:0xf bank_mask:0x5
  v_add_f32_dpp v26, v21, v21 row_half_mirror row_mask:0xf bank_mask:0xa
  v_dot2_f32_bf16 v20, v164, v16, 0
  v_dot2_f32_bf16 v21, v168, v16, 0
  v_dot2_f32_bf16 v22, v172, v16, 0
  v_dot2_f32_bf16 v23, v176, v16, 0
  s_waitcnt vmcnt(9)
  s_memrealtime s[80:81]
L_blk5:
  s_cmp_ge_i32 s101, 6
  s_cbranch_scc1 L_b80
  s_waitcnt vmcnt(7)
  s_cmp_ge_i32 s101, 1
  s_cbranch_scc1 L_b80
  s_waitcnt vmcnt(6)
L_b80:
  buffer_load_dwordx4 v[112:115], v2, s[8:11], s48 offen offset:3072 nt
  s_or_b32 s48, s48, 40960
  s_add_u32 s48, s48, 4096
  s_and_b32 s48, s48, 1003520
  v_dot2_f32_bf16 v20, v165, v17, v20
  v_dot2_f32_bf16 v21, v169, v17, v21
  v_dot2_f32_bf16 v22, v173, v17, v22
  v_dot2_f32_bf16 v23, v177, v17, v23
  v_dot2_f32_bf16 v20, v166, v18, v20
  v_dot2_f32_bf16 v21, v170, v18, v21
  v_dot2_f32_bf16 v22, v174, v18, v22
  v_dot2_f32_bf16 v23, v178, v18, v23
  s_waitcnt vmcnt(8)
  s_cmp_ge_i32 s101, 8
  s_cbranch_scc1 L_b81
  s_waitcnt vmcnt(7)
  s_cmp_ge_i32 s101, 5
  s_cbranch_scc1 L_b81
  s_waitcnt vmcnt(6)
L_b81:
  buffer_load_dwordx4 v[116:119], v2, s[8:11], s48 offen offset:0 nt
  s_mov_b32 s49, 12288
  buffer_load_dwordx4 a[188:191], v4, s[20:23], s49 offen offset:3072 nt
  v_dot2_f32_bf16 v20, v167, v19, v20
  v_dot2_f32_bf16 v21, v171, v19, v21
  v_dot2_f32_bf16 v22, v175, v19, v22
  v_dot2_f32_bf16 v23, v179, v19, v23
  v_add_f32_dpp v20, v20, v20 row_ror:8 row_mask:0xf bank_mask:0x3
  v_add_f32_dpp v21, v21, v21 row_ror:8 row_mask:0xf bank_mask:0x3
  v_add_f32_dpp v20, v22, v22 row_ror:8 row_mask:0xf bank_mask:0xc
  v_add_f32_dpp v21, v23, v23 row_ror:8 row_mask:0xf bank_mask:0xc
  s_nop 0
  v_add_f32_dpp v27, v20, v20 row_half_mirror row_mask:0xf bank_mask:0x5
  v_add_f32_dpp v27, v21, v21 row_half_mirror row_mask:0xf bank_mask:0xa
  s_waitcnt vmcnt(9)
  s_waitcnt lgkmcnt(0)
  s_sub_u32 s101, s80, s84
  s_sub_i32 s101, s101, 1336
  s_mul_i32 s101, s101, 2184
  s_ashr_i32 s101, s101, 16
  s_cmp_ge_i32 s101, 7
  s_cbranch_scc1 L_b82
  s_waitcnt vmcnt(8)
  s_cmp_ge_i32 s101, 4
  s_cbranch_scc1 L_b82
  s_waitcnt vmcnt(6)
L_b82:
  buffer_load_dwordx4 v[120:123], v2, s[8:11], s48 offen offset:1024 nt
  v_add_f32_dpp v24, v24, v24 quad_perm:[1,0,3,2] row_mask:0xf bank_mask:0xf
  v_add_f32_dpp v25, v25, v25 quad_perm:[1,0,3,2] row_mask:0xf bank_mask:0xf
  v_add_f32_dpp v26, v26, v26 quad_perm:[1,0,3,2] row_mask:0xf bank_mask:0xf
  v_add_f32_dpp v27, v27, v27 quad_perm:[1,0,3,2] row_mask:0xf bank_mask:0xf
  v_cndmask_b32 v24, v24, v25, s[52:53]
  v_cndmask_b32 v26, v26, v27, s[52:53]
  s_nop 0
  v_add_f32_dpp v24, v24, v24 quad_perm:[2,3,0,1] row_mask:0xf bank_mask:0xf
  v_add_f32_dpp v26, v26, v26 quad_perm:[2,3,0,1] row_mask:0xf bank_mask:0xf
  v_cndmask_b32 v32, v24, v26, s[54:55]
  s_waitcnt vmcnt(9)
  s_mov_b32 s82, L_blk8-L_pc
  s_load_dword s83, s[78:79], s82 offset:0
  s_load_dword s83, s[78:79], s82 offset:512
  s_load_dword s83, s[78:79], s82 offset:1024
  s_load_dword s83, s[78:79], s82 offset:1536
  s_cmp_ge_i32 s101, 8
  s_cbranch_scc1 L_b83
  s_waitcnt vmcnt(7)
  s_cmp_ge_i32 s101, 5
  s_cbranch_scc1 L_b83
  s_waitcnt vmcnt(6)
L_b83:
  buffer_load_dwordx4 v[124:127], v2, s[8:11], s48 offen offset:2048 nt
  v_cvt_pk_bf16_f32 v32, v32, v32
  v_and_b32 v32, 0xffff0000, v32
  v_mul_f32 v32, s44, v32
  v_cvt_pk_bf16_f32 v32, v32, v32
  v_and_b32 v32, 0xffff0000, v32
  v_max_f32 v15, v15, v32
  v_dot2_f32_bf16 v20, v180, v16, 0
  v_dot2_f32_bf16 v21, v184, v16, 0
  v_dot2_f32_bf16 v22, v188, v16, 0
  v_dot2_f32_bf16 v23, v96, v16, 0
  s_waitcnt vmcnt(8)
  s_cmp_ge_i32 s101, 6
  s_cbranch_scc1 L_b84
  s_waitcnt vmcnt(7)
  s_cmp_ge_i32 s101, 3
  s_cbranch_scc1 L_b84
  s_waitcnt vmcnt(5)
L_b84:
  buffer_load_dwordx4 v[128:131], v2, s[8:11], s48 offen offset:3072 nt
  s_or_b32 s48, s48, 40960
  s_add_u32 s48, s48, 4096
  s_and_b32 s48, s48, 1003520
  s_mov_b32 s49, 16384
  buffer_load_dwordx4 a[192:195], v4, s[20:23], s49 offen offset:0 nt
  v_dot2_f32_bf16 v20, v181, v17, v20
  v_dot2_f32_bf16 v21, v185, v17, v21
  v_dot2_f32_bf16 v22, v189, v17, v22
  v_dot2_f32_bf16 v23, v97, v17, v23
  s_waitcnt vmcnt(9)
  s_cmp_ge_i32 s101, 8
  s_cbranch_scc1 L_b85
  s_waitcnt vmcnt(7)
  s_cmp_ge_i32 s101, 5
  s_cbranch_scc1 L_b85
  s_waitcnt vmcnt(6)
L_b85:
  buffer_load_dwordx4 v[132:135], v2, s[8:11], s48 offen offset:0 nt
  v_dot2_f32_bf16 v20, v182, v18, v20
  v_dot2_f32_bf16 v21, v186, v18, v21
  v_dot2_f32_bf16 v22, v190, v18, v22
  v_dot2_f32_bf16 v23, v98, v18, v23
  s_waitcnt vmcnt(8)
  s_cmp_ge_i32 s101, 7
  s_cbranch_scc1 L_b86
  s_waitcnt vmcnt(7)
  s_cmp_ge_i32 s101, 4
  s_cbranch_scc1 L_b86
  s_waitcnt vmcnt(6)
L_b86:
  buffer_load_dwordx4 v[136:139], v2, s[8:11], s48 offen offset:1024 nt
  s_mov_b32 s49, 16384
  buffer_load_dwordx4 a[196:199], v4, s[20:23], s49 offen offset:1024 nt
  v_dot2_f32_bf16 v20, v183, v19, v20
  v_dot2_f32_bf16 v21, v187, v19, v21
  v_dot2_f32_bf16 v22, v191, v19, v22
  v_dot2_f32_bf16 v23, v99, v19, v23
  s_waitcnt vmcnt(9)
  s_cmp_ge_i32 s101, 8
  s_cbranch_scc1 L_b87
  s_waitcnt vmcnt(8)
  s_cmp_ge_i32 s101, 5
  s_cbranch_scc1 L_b87
  s_waitcnt vmcnt(6)
L_b87:
  buffer_load_dwordx4 v[140:143], v2, s[8:11], s48 offen offset:2048 nt
  v_add_f32_dpp v20, v20, v20 row_ror:8 row_mask:0xf bank_mask:0x3
  v_add_f32_dpp v21, v21, v21 row_ror:8 row_mask:0xf bank_mask:0x3
  v_add_f32_dpp v20, v22, v22 row_ror:8 row_mask:0xf bank_mask:0xc
  v_add_f32_dpp v21, v23, v23 row_ror:8 row_mask:0xf bank_mask:0xc
  s_nop 0
  v_add_f32_dpp v24, v20, v20 row_half_mirror row_mask:0xf bank_mask:0x5
  v_add_f32_dpp v24, v21, v21 row_half_mirror row_mask:0xf bank_mask:0xa
  v_dot2_f32_bf16 v20, v100, v16, 0
  v_dot2_f32_bf16 v21, v104, v16, 0
  v_dot2_f32_bf16 v22, v108, v16, 0
  v_dot2_f32_bf16 v23, v112, v16, 0
  s_waitcnt vmcnt(9)
  s_cmp_ge_i32 s101, 6
  s_cbranch_scc1 L_b88
  s_waitcnt vmcnt(7)
  s_cmp_ge_i32 s101, 2
  s_cbranch_scc1 L_b88
  s_waitcnt vmcnt(6)
L_b88:
  buffer_load_dwordx4 v[144:147], v2, s[8:11], s48 offen offset:3072 nt
  s_or_b32 s48, s48, 40960
  s_add_u32 s48, s48, 4096
  s_and_b32 s48, s48, 1003520
  v_dot2_f32_bf16 v20, v101, v17, v20
  v_dot2_f32_bf16 v21, v105, v17, v21
  v_dot2_f32_bf16 v22, v109, v17, v22
  v_dot2_f32_bf16 v23, v113, v17, v23
  s_waitcnt vmcnt(8)
  s_cmp_ge_i32 s101, 8
  s_cbranch_scc1 L_b89
  s_waitcnt vmcnt(7)
  s_cmp_ge_i32 s101, 5
  s_cbranch_scc1 L_b89
  s_waitcnt vmcnt(6)
L_b89:
  buffer_load_dwordx4 v[148:151], v0, s[8:11], s48 offen offset:0 nt
  s_mov_b32 s49, 16384
  buffer_load_dwordx4 a[200:203], v4, s[20:23], s49 offen offset:2048 nt
  v_dot2_f32_bf16 v20, v102, v18, v20
  v_dot2_f32_bf16 v21, v106, v18, v21
  v_dot2_f32_bf16 v22, v110, v18, v22
  v_dot2_f32_bf16 v23, v114, v18, v23
  s_waitcnt vmcnt(9)
  s_cmp_ge_i32 s101, 7
  s_cbranch_scc1 L_b90
  s_waitcnt vmcnt(8)
  s_cmp_ge_i32 s101, 4
  s_cbranch_scc1 L_b90
  s_waitcnt vmcnt(6)
L_b90:
  buffer_load_dwordx4 v[152:155], v0, s[8:11], s48 offen offset:1024 nt
  v_dot2_f32_bf16 v20, v103, v19, v20
  v_dot2_f32_bf16 v21, v107, v19, v21
  v_dot2_f32_bf16 v22, v111, v19, v22
  v_dot2_f32_bf16 v23, v115, v19, v23
  s_waitcnt vmcnt(9)
  s_cmp_ge_i32 s101, 8
  s_cbranch_scc1 L_b91
  s_waitcnt vmcnt(7)
  s_cmp_ge_i32 s101, 5
  s_cbranch_scc1 L_b91
  s_waitcnt vmcnt(6)
L_b91:
  buffer_load_dwordx4 v[156:159], v0, s[8:11], s48 offen offset:2048 nt
  s_mov_b32 s49, 16384
  buffer_load_dwordx4 a[204:207], v4, s[20:23], s49 offen offset:3072 nt
  v_add_f32_dpp v20, v20, v20 row_ror:8 row_mask:0xf bank_mask:0x3
  v_add_f32_dpp v21, v21, v21 row_ror:8 row_mask:0xf bank_mask:0x3
  v_add_f32_dpp v20, v22, v22 row_ror:8 row_mask:0xf bank_mask:0xc
  v_add_f32_dpp v21, v23, v23 row_ror:8 row_mask:0xf bank_mask:0xc
  s_nop 0
  v_add_f32_dpp v25, v20, v20 row_half_mirror row_mask:0xf bank_mask:0x5
  v_add_f32_dpp v25, v21, v21 row_half_mirror row_mask:0xf bank_mask:0xa
  v_dot2_f32_bf16 v20, v116, v16, 0
  v_dot2_f32_bf16 v21, v120, v16, 0
  v_dot2_f32_bf16 v22, v124, v16, 0
  v_dot2_f32_bf16 v23, v128, v16, 0
  s_waitcnt vmcnt(9)
  s_cmp_ge_i32 s101, 6
  s_cbranch_scc1 L_b92
  s_waitcnt vmcnt(8)
  s_cmp_ge_i32 s101, 3
  s_cbranch_scc1 L_b92
  s_waitcnt vmcnt(6)
L_b92:
  buffer_load_dwordx4 v[160:163], v0, s[8:11], s48 offen offset:3072 nt
  s_or_b32 s48, s48, 40960
  s_add_u32 s48, s48, 4096
  s_and_b32 s48, s48, 1003520
  v_dot2_f32_bf16 v20, v117, v17, v20
  v_dot2_f32_bf16 v21, v121, v17, v21
  v_dot2_f32_bf16 v22, v125, v17, v22
  v_dot2_f32_bf16 v23, v129, v17, v23
  s_waitcnt vmcnt(9)
  s_cmp_ge_i32 s101, 8
  s_cbranch_scc1 L_b93
  s_waitcnt vmcnt(7)
  s_cmp_ge_i32 s101, 5
  s_cbranch_scc1 L_b93
  s_waitcnt vmcnt(6)
L_b93:
  buffer_load_dwordx4 v[164:167], v0, s[8:11], s48 offen offset:0 nt
  v_dot2_f32_bf16 v20, v118, v18, v20
  v_dot2_f32_bf16 v21, v122, v18, v21
  v_dot2_f32_bf16 v22, v126, v18, v22
  v_dot2_f32_bf16 v23, v130, v18, v23
  s_waitcnt vmcnt(8)
  s_cmp_ge_i32 s101, 7
  s_cbranch_scc1 L_b94
  s_waitcnt vmcnt(7)
  s_cmp_ge_i32 s101, 4
  s_cbranch_scc1 L_b94
  s_waitcnt vmcnt(6)
L_b94:
  buffer_load_dwordx4 v[168:171], v0, s[8:11], s48 offen offset:1024 nt
  s_mov_b32 s49, 20480
  buffer_load_dwordx4 a[208:211], v4, s[20:23], s49 offen offset:0 nt
  v_dot2_f32_bf16 v20, v119, v19, v20
  v_dot2_f32_bf16 v21, v123, v19, v21
  v_dot2_f32_bf16 v22, v127, v19, v22
  v_dot2_f32_bf16 v23, v131, v19, v23
  s_waitcnt vmcnt(9)
  s_cmp_ge_i32 s101, 8
  s_cbranch_scc1 L_b95
  s_waitcnt vmcnt(8)
  s_cmp_ge_i32 s101, 5
  s_cbranch_scc1 L_b95
  s_waitcnt vmcnt(6)
L_b95:
  buffer_load_dwordx4 v[172:175], v0, s[8:11], s48 offen offset:2048 nt
  v_add_f32_dpp v20, v20, v20 row_ror:8 row_mask:0xf bank_mask:0x3
  v_add_f32_dpp v21, v21, v21 row_ror:8 row_mask:0xf bank_mask:0x3
  v_add_f32_dpp v20, v22, v22 row_ror:8 row_mask:0xf bank_mask:0xc
  v_add_f32_dpp v21, v23, v23 row_ror:8 row_mask:0xf bank_mask:0xc
  s_nop 0
  v_add_f32_dpp v26, v20, v20 row_half_mirror row_mask:0xf bank_mask:0x5
  v_add_f32_dpp v26, v21, v21 row_half_mirror row_mask:0xf bank_mask:0xa
  v_dot2_f32_bf16 v20, v132, v16, 0
  v_dot2_f32_bf16 v21, v136, v16, 0
  v_dot2_f32_bf16 v22, v140, v16, 0
  v_dot2_f32_bf16 v23, v144, v16, 0
  s_waitcnt vmcnt(9)
  s_memrealtime s[80:81]
L_blk6:
  s_cmp_ge_i32 s101, 6
  s_cbranch_scc1 L_b96
  s_waitcnt vmcnt(7)
  s_cmp_ge_i32 s101, 1
  s_cbranch_scc1 L_b96
  s_waitcnt vmcnt(6)
L_b96:
  buffer_load_dwordx4 v[176:179], v0, s[8:11], s48 offen offset:3072 nt
  s_or_b32 s48, s48, 40960
  s_add_u32 s48, s48, 4096
  s_and_b32 s48, s48, 1003520
  v_dot2_f32_bf16 v20, v133, v17, v20
  v_dot2_f32_bf16 v21, v137, v17, v21
  v_dot2_f32_bf16 v22, v141, v17, v22
  v_dot2_f32_bf16 v23, v145, v17, v23
  v_dot2_f32_bf16 v20, v134, v18, v20
  v_dot2_f32_bf16 v21, v138, v18, v21
  v_dot2_f32_bf16 v22, v142, v18, v22
  v_dot2_f32_bf16 v23, v146, v18, v23
  s_waitcnt vmcnt(8)
  s_cmp_ge_i32 s101, 8
  s_cbranch_scc1 L_b97
  s_waitcnt vmcnt(7)
  s_cmp_ge_i32 s101, 5
  s_cbranch_scc1 L_b97
  s_waitcnt vmcnt(5)
L_b97:
  buffer_load_dwordx4 v[180:183], v0, s[8:11], s48 offen offset:0 nt
  s_mov_b32 s49, 20480
  buffer_load_dwordx4 a[212:215], v4, s[20:23], s49 offen offset:1024 nt
  v_dot2_f32_bf16 v20, v135, v19, v20
  v_dot2_f32_bf16 v21, v139, v19, v21
  v_dot2_f32_bf16 v22, v143, v19, v22
  v_dot2_f32_bf16 v23, v147, v19, v23
  v_add_f32_dpp v20, v20, v20 row_ror:8 row_mask:0xf bank_mask:0x3
  v_add_f32_dpp v21, v21, v21 row_ror:8 row_mask:0xf bank_mask:0x3
  v_add_f32_dpp v20, v22, v22 row_ror:8 row_mask:0xf bank_mask:0xc
  v_add_f32_dpp v21, v23, v23 row_ror:8 row_mask:0xf bank_mask:0xc
  s_nop 0
  v_add_f32_dpp v27, v20, v20 row_half_mirror row_mask:0xf bank_mask:0x5
  v_add_f32_dpp v27, v21, v21 row_half_mirror row_mask:0xf bank_mask:0xa
  s_waitcnt vmcnt(9)
  s_waitcnt lgkmcnt(0)
  s_sub_u32 s101, s80, s84
  s_sub_i32 s101, s101, 1564
  s_mul_i32 s101, s101, 2184
  s_ashr_i32 s101, s101, 16
  s_cmp_ge_i32 s101, 7
  s_cbranch_scc1 L_b98
  s_waitcnt vmcnt(7)
  s_cmp_ge_i32 s101, 4
  s_cbranch_scc1 L_b98
  s_waitcnt vmcnt(6)
L_b98:
  buffer_load_dwordx4 v[184:187], v0, s[8:11], s48 offen offset:1024 nt
  v_add_f32_dpp v24, v24, v24 quad_perm:[1,0,3,2] row_mask:0xf bank_mask:0xf
  v_add_f32_dpp v25, v25, v25 quad_perm:[1,0,3,2] row_mask:0xf bank_mask:0xf
  v_add_f32_dpp v26, v26, v26 quad_perm:[1,0,3,2] row_mask:0xf bank_mask:0xf
  v_add_f32_dpp v27, v27, v27 quad_perm:[1,0,3,2] row_mask:0xf bank_mask:0xf
  v_cndmask_b32 v24, v24, v25, s[52:53]
  v_cndmask_b32 v26, v26, v27, s[52:53]
  s_nop 0
  v_add_f32_dpp v24, v24, v24 quad_perm:[2,3,0,1] row_mask:0xf bank_mask:0xf
  v_add_f32_dpp v26, v26, v26 quad_perm:[2,3,0,1] row_mask:0xf bank_mask:0xf
  v_cndmask_b32 v33, v24, v26, s[54:55]
  s_waitcnt vmcnt(8)
  s_mov_b32 s82, L_blk9-L_pc
  s_load_dword s83, s[78:79], s82 offset:0
  s_load_dword s83, s[78:79], s82 offset:512
  s_load_dword s83, s[78:79], s82 offset:1024
  s_load_dword s83, s[78:79], s82 offset:1536
  s_cmp_ge_i32 s101, 8
  s_cbranch_scc1 L_b99
  s_waitcnt vmcnt(7)
  s_cmp_ge_i32 s101, 5
  s_cbranch_scc1 L_b99
  s_waitcnt vmcnt(6)
L_b99:
  buffer_load_dwordx4 v[188:191], v0, s[8:11], s48 offen offset:2048 nt
  s_mov_b32 s49, 20480
  buffer_load_dwordx4 a[216:219], v4, s[20:23], s49 offen offset:2048 nt
  v_cvt_pk_bf16_f32 v33, v33, v33
  v_and_b32 v33, 0xffff0000, v33
  v_mul_f32 v33, s44, v33
  v_cvt_pk_bf16_f32 v33, v33, v33
  v_and_b32 v33, 0xffff0000, v33
  v_max_f32 v15, v15, v33
  v_dot2_f32_bf16 v20, v148, v16, 0
  v_dot2_f32_bf16 v21, v152, v16, 0
  v_dot2_f32_bf16 v22, v156, v16, 0
  v_dot2_f32_bf16 v23, v160, v16, 0
  s_waitcnt vmcnt(9)
  s_cmp_ge_i32 s101, 6
  s_cbranch_scc1 L_b100
  s_waitcnt vmcnt(8)
  s_cmp_ge_i32 s101, 3
  s_cbranch_scc1 L_b100
  s_waitcnt vmcnt(6)
L_b100:
  buffer_load_dwordx4 v[96:99], v0, s[8:11], s48 offen offset:3072 nt
  s_or_b32 s48, s48, 40960
  s_add_u32 s48, s48, 4096
  s_and_b32 s48, s48, 1003520
  v_dot2_f32_bf16 v20, v149, v17, v20
  v_dot2_f32_bf16 v21, v153, v17, v21
  v_dot2_f32_bf16 v22, v157, v17, v22
  v_dot2_f32_bf16 v23, v161, v17, v23
  s_waitcnt vmcnt(9)
  s_cmp_ge_i32 s101, 8
  s_cbranch_scc1 L_b101
  s_waitcnt vmcnt(7)
  s_cmp_ge_i32 s101, 5
  s_cbranch_scc1 L_b101
  s_waitcnt vmcnt(6)
L_b101:
  buffer_load_dwordx4 v[100:103], v0, s[8:11], s48 offen offset:0 nt
  v_dot2_f32_bf16 v20, v150, v18, v20
  v_dot2_f32_bf16 v21, v154, v18, v21
  v_dot2_f32_bf16 v22, v158, v18, v22
  v_dot2_f32_bf16 v23, v162, v18, v23
  s_waitcnt vmcnt(8)
  s_cmp_ge_i32 s101, 7
  s_cbranch_scc1 L_b102
  s_waitcnt vmcnt(7)
  s_cmp_ge_i32 s101, 4
  s_cbranch_scc1 L_b102
  s_waitcnt vmcnt(6)
L_b102:
  buffer_load_dwordx4 v[104:107], v0, s[8:11], s48 offen offset:1024 nt
  s_mov_b32 s49, 20480
  buffer_load_dwordx4 a[220:223], v4, s[20:23], s49 offen offset:3072 nt
  v_dot2_f32_bf16 v20, v151, v19, v20
  v_dot2_f32_bf16 v21, v155, v19, v21
  v_dot2_f32_bf16 v22, v159, v19, v22
  v_dot2_f32_bf16 v23, v163, v19, v23
  s_waitcnt vmcnt(9)
  s_cmp_ge_i32 s101, 8
  s_cbranch_scc1 L_b103
  s_waitcnt vmcnt(8)
  s_cmp_ge_i32 s101, 5
  s_cbranch_scc1 L_b103
  s_waitcnt vmcnt(6)
L_b103:
  buffer_load_dwordx4 v[108:111], v0, s[8:11], s48 offen offset:2048 nt
  v_add_f32_dpp v20, v20, v20 row_ror:8 row_mask:0xf bank_mask:0x3
  v_add_f32_dpp v21, v21, v21 row_ror:8 row_mask:0xf bank_mask:0x3
  v_add_f32_dpp v20, v22, v22 row_ror:8 row_mask:0xf bank_mask:0xc
  v_add_f32_dpp v21, v23, v23 row_ror:8 row_mask:0xf bank_mask:0xc
  s_nop 0
  v_add_f32_dpp v24, v20, v20 row_half_mirror row_mask:0xf bank_mask:0x5
  v_add_f32_dpp v24, v21, v21 row_half_mirror row_mask:0xf bank_mask:0xa
  v_dot2_f32_bf16 v20, v164, v16, 0
  v_dot2_f32_bf16 v21, v168, v16, 0
  v_dot2_f32_bf16 v22, v172, v16, 0
  v_dot2_f32_bf16 v23, v176, v16, 0
  s_waitcnt vmcnt(9)
  s_cmp_ge_i32 s101, 6
  s_cbranch_scc1 L_b104
  s_waitcnt vmcnt(7)
  s_cmp_ge_i32 s101, 2
  s_cbranch_scc1 L_b104
  s_waitcnt vmcnt(6)
L_b104:
  buffer_load_dwordx4 v[112:115], v0, s[8:11], s48 offen offset:3072 nt
  s_or_b32 s48, s48, 40960
  s_add_u32 s48, s48, 4096
  s_and_b32 s48, s48, 1003520
  s_mov_b32 s49, 24576
  buffer_load_dwordx4 a[224:227], v4, s[20:23], s49 offen offset:0 nt
  v_dot2_f32_bf16 v20, v165, v17, v20
  v_dot2_f32_bf16 v21, v169, v17, v21
  v_dot2_f32_bf16 v22, v173, v17, v22
  v_dot2_f32_bf16 v23, v177, v17, v23
  s_waitcnt vmcnt(9)
  s_cmp_ge_i32 s101, 8
  s_cbranch_scc1 L_b105
  s_waitcnt vmcnt(8)
  s_cmp_ge_i32 s101, 5
  s_cbranch_scc1 L_b105
  s_waitcnt vmcnt(6)
L_b105:
  buffer_load_dwordx4 v[116:119], v0, s[8:11], s48 offen offset:0 nt
  v_dot2_f32_bf16 v20, v166, v18, v20
  v_dot2_f32_bf16 v21, v170, v18, v21
  v_dot2_f32_bf16 v22, v174, v18, v22
  v_dot2_f32_bf16 v23, v178, v18, v23
  s_waitcnt vmcnt(9)
  s_cmp_ge_i32 s101, 7
  s_cbranch_scc1 L_b106
  s_waitcnt vmcnt(7)
  s_cmp_ge_i32 s101, 4
  s_cbranch_scc1 L_b106
  s_waitcnt vmcnt(6)
L_b106:
  buffer_load_dwordx4 v[120:123], v0, s[8:11], s48 offen offset:1024 nt
  v_dot2_f32_bf16 v20, v167, v19, v20
  v_dot2_f32_bf16 v21, v171, v19, v21
  v_dot2_f32_bf16 v22, v175, v19, v22
  v_dot2_f32_bf16 v23, v179, v19, v23
  s_waitcnt vmcnt(8)
  s_cmp_ge_i32 s101, 8
  s_cbranch_scc1 L_b107
  s_waitcnt vmcnt(7)
  s_cmp_ge_i32 s101, 5
  s_cbranch_scc1 L_b107
  s_waitcnt vmcnt(6)
L_b107:
  buffer_load_dwordx4 v[124:127], v0, s[8:11], s48 offen offset:2048 nt
  s_mov_b32 s49, 24576
  buffer_load_dwordx4 a[228:231], v4, s[20:23], s49 offen offset:1024 nt
  v_add_f32_dpp v20, v20, v20 row_ror:8 row_mask:0xf bank_mask:0x3
  v_add_f32_dpp v21, v21, v21 row_ror:8 row_mask:0xf bank_mask:0x3
  v_add_f32_dpp v20, v22, v22 row_ror:8 row_mask:0xf bank_mask:0xc
  v_add_f32_dpp v21, v23, v23 row_ror:8 row_mask:0xf bank_mask:0xc
  s_nop 0
  v_add_f32_dpp v25, v20, v20 row_half_mirror row_mask:0xf bank_mask:0x5
  v_add_f32_dpp v25, v21, v21 row_half_mirror row_mask:0xf bank_mask:0xa
  v_dot2_f32_bf16 v20, v180, v16, 0
  v_dot2_f32_bf16 v21, v184, v16, 0
  v_dot2_f32_bf16 v22, v188, v16, 0
  v_dot2_f32_bf16 v23, v96, v16, 0
  s_waitcnt vmcnt(9)
  s_cmp_ge_i32 s101, 6
  s_cbranch_scc1 L_b108
  s_waitcnt vmcnt(8)
  s_cmp_ge_i32 s101, 3
  s_cbranch_scc1 L_b108
  s_waitcnt vmcnt(6)
L_b108:
  buffer_load_dwordx4 v[128:131], v0, s[8:11], s48 offen offset:3072 nt
  s_or_b32 s48, s48, 40960
  s_add_u32 s48, s48, 4096
  s_and_b32 s48, s48, 1003520
  v_dot2_f32_bf16 v20, v181, v17, v20
  v_dot2_f32_bf16 v21, v185, v17, v21
  v_dot2_f32_bf16 v22, v189, v17, v22
  v_dot2_f32_bf16 v23, v97, v17, v23
  s_waitcnt vmcnt(9)
  s_cmp_ge_i32 s101, 8
  s_cbranch_scc1 L_b109
  s_waitcnt vmcnt(7)
  s_cmp_ge_i32 s101, 5
  s_cbranch_scc1 L_b109
  s_waitcnt vmcnt(6)
L_b109:
  buffer_load_dwordx4 v[132:135], v0, s[8:11], s48 offen offset:0 nt
  v_dot2_f32_bf16 v20, v182, v18, v20
  v_dot2_f32_bf16 v21, v186, v18, v21
  v_dot2_f32_bf16 v22, v190, v18, v22
  v_dot2_f32_bf16 v23, v98, v18, v23
  s_waitcnt vmcnt(8)
  s_cmp_ge_i32 s101, 7
  s_cbranch_scc1 L_b110
  s_waitcnt vmcnt(7)
  s_cmp_ge_i32 s101, 4
  s_cbranch_scc1 L_b110
  s_waitcnt vmcnt(5)
L_b110:
  buffer_load_dwordx4 v[136:139], v0, s[8:11], s48 offen offset:1024 nt
  s_mov_b32 s49, 24576
  buffer_load_dwordx4 a[232:235], v4, s[20:23], s49 offen offset:2048 nt
  v_dot2_f32_bf16 v20, v183, v19, v20
  v_dot2_f32_bf16 v21, v187, v19, v21
  v_dot2_f32_bf16 v22, v191, v19, v22
  v_dot2_f32_bf16 v23, v99, v19, v23
  s_waitcnt vmcnt(9)
  s_cmp_ge_i32 s101, 8
  s_cbranch_scc1 L_b111
  s_waitcnt vmcnt(7)
  s_cmp_ge_i32 s101, 5
  s_cbranch_scc1 L_b111
  s_waitcnt vmcnt(6)
L_b111:
  buffer_load_dwordx4 v[140:143], v0, s[8:11], s48 offen offset:2048 nt
  v_add_f32_dpp v20, v20, v20 row_ror:8 row_mask:0xf bank_mask:0x3
  v_add_f32_dpp v21, v21, v21 row_ror:8 row_mask:0xf bank_mask:0x3
  v_add_f32_dpp v20, v22, v22 row_ror:8 row_mask:0xf bank_mask:0xc
  v_add_f32_dpp v21, v23, v23 row_ror:8 row_mask:0xf bank_mask:0xc
  s_nop 0
  v_add_f32_dpp v26, v20, v20 row_half_mirror row_mask:0xf bank_mask:0x5
  v_add_f32_dpp v26, v21, v21 row_half_mirror row_mask:0xf bank_mask:0xa
  v_dot2_f32_bf16 v20, v100, v16, 0
  v_dot2_f32_bf16 v21, v104, v16, 0
  v_dot2_f32_bf16 v22, v108, v16, 0
  v_dot2_f32_bf16 v23, v112, v16, 0
  s_waitcnt vmcnt(8)
  s_memrealtime s[80:81]
L_blk7:
  s_cmp_ge_i32 s101, 6
  s_cbranch_scc1 L_b112
  s_waitcnt vmcnt(7)
  s_cmp_ge_i32 s101, 1
  s_cbranch_scc1 L_b112
  s_waitcnt vmcnt(6)
L_b112:
  buffer_load_dwordx4 v[144:147], v0, s[8:11], s48 offen offset:3072 nt
  s_or_b32 s48, s48, 40960
  s_add_u32 s48, s48, 4096
  s_and_b32 s48, s48, 1003520
  s_mov_b32 s49, 24576
  buffer_load_dwordx4 a[236:239], v4, s[20:23], s49 offen offset:3072 nt
  v_dot2_f32_bf16 v20, v101, v17, v20
  v_dot2_f32_bf16 v21, v105, v17, v21
  v_dot2_f32_bf16 v22, v109, v17, v22
  v_dot2_f32_bf16 v23, v113, v17, v23
  v_dot2_f32_bf16 v20, v102, v18, v20
  v_dot2_f32_bf16 v21, v106, v18, v21
  v_dot2_f32_bf16 v22, v110, v18, v22
  v_dot2_f32_bf16 v23, v114, v18, v23
  s_waitcnt vmcnt(9)
  s_cmp_ge_i32 s101, 8
  s_cbranch_scc1 L_b113
  s_waitcnt vmcnt(8)
  s_cmp_ge_i32 s101, 5
  s_cbranch_scc1 L_b113
  s_waitcnt vmcnt(6)
L_b113:
  buffer_load_dwordx4 v[148:151], v0, s[8:11], s48 offen offset:0 nt
  v_dot2_f32_bf16 v20, v103, v19, v20
  v_dot2_f32_bf16 v21, v107, v19, v21
  v_dot2_f32_bf16 v22, v111, v19, v22
  v_dot2_f32_bf16 v23, v115, v19, v23
  v_add_f32_dpp v20, v20, v20 row_ror:8 row_mask:0xf bank_mask:0x3
  v_add_f32_dpp v21, v21, v21 row_ror:8 row_mask:0xf bank_mask:0x3
  v_add_f32_dpp v20, v22, v22 row_ror:8 row_mask:0xf bank_mask:0xc
  v_add_f32_dpp v21, v23, v23 row_ror:8 row_mask:0xf bank_mask:0xc
  s_nop 0
  v_add_f32_dpp v27, v20, v20 row_half_mirror row_mask:0xf bank_mask:0x5
  v_add_f32_dpp v27, v21, v21 row_half_mirror row_mask:0xf bank_mask:0xa
  s_waitcnt vmcnt(9)
  s_waitcnt lgkmcnt(0)
  s_sub_u32 s101, s80, s84
  s_sub_i32 s101, s101, 1792
  s_mul_i32 s101, s101, 2184
  s_ashr_i32 s101, s101, 16
  s_cmp_ge_i32 s101, 7
  s_cbranch_scc1 L_b114
  s_waitcnt vmcnt(7)
  s_cmp_ge_i32 s101, 4
  s_cbranch_scc1 L_b114
  s_waitcnt vmcnt(6)
L_b114:
  buffer_load_dwordx4 v[152:155], v0, s[8:11], s48 offen offset:1024 nt
  v_add_f32_dpp v24, v24, v24 quad_perm:[1,0,3,2] row_mask:0xf bank_mask:0xf
  v_add_f32_dpp v25, v25, v25 quad_perm:[1,0,3,2] row_mask:0xf bank_mask:0xf
  v_add_f32_dpp v26, v26, v26 quad_perm:[1,0,3,2] row_mask:0xf bank_mask:0xf
  v_add_f32_dpp v27, v27, v27 quad_perm:[1,0,3,2] row_mask:0xf bank_mask:0xf
  v_cndmask_b32 v24, v24, v25, s[52:53]
  v_cndmask_b32 v26, v26, v27, s[52:53]
  s_nop 0
  v_add_f32_dpp v24, v24, v24 quad_perm:[2,3,0,1] row_mask:0xf bank_mask:0xf
  v_add_f32_dpp v26, v26, v26 quad_perm:[2,3,0,1] row_mask:0xf bank_mask:0xf
  v_cndmask_b32 v34, v24, v26, s[54:55]
  s_waitcnt vmcnt(8)
  s_mov_b32 s82, L_blk10-L_pc
  s_load_dword s83, s[78:79], s82 offset:0
  s_load_dword s83, s[78:79], s82 offset:512
  s_load_dword s83, s[78:79], s82 offset:1024
  s_load_dword s83, s[78:79], s82 offset:1536
  s_cmp_ge_i32 s101, 8
  s_cbranch_scc1 L_b115
  s_waitcnt vmcnt(7)
  s_cmp_ge_i32 s101, 5
  s_cbranch_scc1 L_b115
  s_waitcnt vmcnt(6)
L_b115:
  buffer_load_dwordx4 v[156:159], v0, s[8:11], s48 offen offset:2048 nt
  s_mov_b32 s49, 28672
  buffer_load_dwordx4 a[240:243], v4, s[20:23], s49 offen offset:0 nt
  v_cvt_pk_bf16_f32 v34, v34, v34
  v_and_b32 v34, 0xffff0000, v34
  v_mul_f32 v34, s44, v34
  v_cvt_pk_bf16_f32 v34, v34, v34
  v_and_b32 v34, 0xffff0000, v34
  v_max_f32 v15, v15, v34
  v_dot2_f32_bf16 v20, v116, v16, 0
  v_dot2_f32_bf16 v21, v120, v16, 0
  v_dot2_f32_bf16 v22, v124, v16, 0
  v_dot2_f32_bf16 v23, v128, v16, 0
  s_waitcnt vmcnt(9)
  s_cmp_ge_i32 s101, 6
  s_cbranch_scc1 L_b116
  s_waitcnt vmcnt(8)
  s_cmp_ge_i32 s101, 3
  s_cbranch_scc1 L_b116
  s_waitcnt vmcnt(6)
L_b116:
  buffer_load_dwordx4 v[160:163], v0, s[8:11], s48 offen offset:3072 nt
  s_or_b32 s48, s48, 40960
  s_add_u32 s48, s48, 4096
  s_and_b32 s48, s48, 1003520
  v_dot2_f32_bf16 v20, v117, v17, v20
  v_dot2_f32_bf16 v21, v121, v17, v21
  v_dot2_f32_bf16 v22, v125, v17, v22
  v_dot2_f32_bf16 v23, v129, v17, v23
  s_waitcnt vmcnt(9)
  s_cmp_ge_i32 s101, 8
  s_cbranch_scc1 L_b117
  s_waitcnt vmcnt(7)
  s_cmp_ge_i32 s101, 5
  s_cbranch_scc1 L_b117
  s_waitcnt vmcnt(6)
L_b117:
  buffer_load_dwordx4 v[164:167], v0, s[8:11], s48 offen offset:0 nt
  s_mov_b32 s49, 28672
  buffer_load_dwordx4 a[244:247], v4, s[20:23], s49 offen offset:1024 nt
  v_dot2_f32_bf16 v20, v118, v18, v20
  v_dot2_f32_bf16 v21, v122, v18, v21
  v_dot2_f32_bf16 v22, v126, v18, v22
  v_dot2_f32_bf16 v23, v130, v18, v23
  s_waitcnt vmcnt(9)
  s_cmp_ge_i32 s101, 7
  s_cbranch_scc1 L_b118
  s_waitcnt vmcnt(8)
  s_cmp_ge_i32 s101, 4
  s_cbranch_scc1 L_b118
  s_waitcnt vmcnt(6)
L_b118:
  buffer_load_dwordx4 v[168:171], v0, s[8:11], s48 offen offset:1024 nt
  v_dot2_f32_bf16 v20, v119, v19, v20
  v_dot2_f32_bf16 v21, v123, v19, v21
  v_dot2_f32_bf16 v22, v127, v19, v22
  v_dot2_f32_bf16 v23, v131, v19, v23
  s_waitcnt vmcnt(9)
  s_cmp_ge_i32 s101, 8
  s_cbranch_scc1 L_b119
  s_waitcnt vmcnt(7)
  s_cmp_ge_i32 s101, 5
  s_cbranch_scc1 L_b119
  s_waitcnt vmcnt(6)
L_b119:
  buffer_load_dwordx4 v[172:175], v0, s[8:11], s48 offen offset:2048 nt
  v_add_f32_dpp v20, v20, v20 row_ror:8 row_mask:0xf bank_mask:0x3
  v_add_f32_dpp v21, v21, v21 row_ror:8 row_mask:0xf bank_mask:0x3
  v_add_f32_dpp v20, v22, v22 row_ror:8 row_mask:0xf bank_mask:0xc
  v_add_f32_dpp v21, v23, v23 row_ror:8 row_mask:0xf bank_mask:0xc
  s_nop 0
  v_add_f32_dpp v24, v20, v20 row_half_mirror row_mask:0xf bank_mask:0x5
  v_add_f32_dpp v24, v21, v21 row_half_mirror row_mask:0xf bank_mask:0xa
  v_dot2_f32_bf16 v20, v132, v16, 0
  v_dot2_f32_bf16 v21, v136, v16, 0
  v_dot2_f32_bf16 v22, v140, v16, 0
  v_dot2_f32_bf16 v23, v144, v16, 0
  s_waitcnt vmcnt(8)
  s_cmp_ge_i32 s101, 6
  s_cbranch_scc1 L_b120
  s_waitcnt vmcnt(7)
  s_cmp_ge_i32 s101, 2
  s_cbranch_scc1 L_b120
  s_waitcnt vmcnt(6)
L_b120:
  buffer_load_dwordx4 v[176:179], v0, s[8:11], s48 offen offset:3072 nt
  s_or_b32 s48, s48, 40960
  s_add_u32 s48, s48, 4096
  s_and_b32 s48, s48, 1003520
  s_mov_b32 s49, 28672
  buffer_load_dwordx4 a[248:251], v4, s[20:23], s49 offen offset:2048 nt
  v_dot2_f32_bf16 v20, v133, v17, v20
  v_dot2_f32_bf16 v21, v137, v17, v21
  v_dot2_f32_bf16 v22, v141, v17, v22
  v_dot2_f32_bf16 v23, v145, v17, v23
  s_waitcnt vmcnt(9)
  s_cmp_ge_i32 s101, 8
  s_cbranch_scc1 L_b121
  s_waitcnt vmcnt(8)
  s_cmp_ge_i32 s101, 5
  s_cbranch_scc1 L_b121
  s_waitcnt vmcnt(6)
L_b121:
  buffer_load_dwordx4 v[180:183], v2, s[8:11], s48 offen offset:0 nt
  v_dot2_f32_bf16 v20, v134, v18, v20
  v_dot2_f32_bf16 v21, v138, v18, v21
  v_dot2_f32_bf16 v22, v142, v18, v22
  v_dot2_f32_bf16 v23, v146, v18, v23
  s_waitcnt vmcnt(9)
  s_cmp_ge_i32 s101, 7
  s_cbranch_scc1 L_b122
  s_waitcnt vmcnt(7)
  s_cmp_ge_i32 s101, 4
  s_cbranch_scc1 L_b122
  s_waitcnt vmcnt(6)
L_b122:
  buffer_load_dwordx4 v[184:187], v2, s[8:11], s48 offen offset:1024 nt
  s_mov_b32 s49, 28672
  buffer_load_dwordx4 a[252:255], v4, s[20:23], s49 offen offset:3072 nt
  v_dot2_f32_bf16 v20, v135, v19, v20
  v_dot2_f32_bf16 v21, v139, v19, v21
  v_dot2_f32_bf16 v22, v143, v19, v22
  v_dot2_f32_bf16 v23, v147, v19, v23
  s_waitcnt vmcnt(9)
  s_cmp_ge_i32 s101, 8
  s_cbranch_scc1 L_b123
  s_waitcnt vmcnt(8)
  s_cmp_ge_i32 s101, 5
  s_cbranch_scc1 L_b123
  s_waitcnt vmcnt(6)
L_b123:
  buffer_load_dwordx4 v[188:191], v2, s[8:11], s48 offen offset:2048 nt
  v_add_f32_dpp v20, v20, v20 row_ror:8 row_mask:0xf bank_mask:0x3
  v_add_f32_dpp v21, v21, v21 row_ror:8 row_mask:0xf bank_mask:0x3
  v_add_f32_dpp v20, v22, v22 row_ror:8 row_mask:0xf bank_mask:0xc
  v_add_f32_dpp v21, v23, v23 row_ror:8 row_mask:0xf bank_mask:0xc
  s_nop 0
  v_add_f32_dpp v25, v20, v20 row_half_mirror row_mask:0xf bank_mask:0x5
  v_add_f32_dpp v25, v21, v21 row_half_mirror row_mask:0xf bank_mask:0xa
  v_dot2_f32_bf16 v20, v148, v16, 0
  v_dot2_f32_bf16 v21, v152, v16, 0
  v_dot2_f32_bf16 v22, v156, v16, 0
  v_dot2_f32_bf16 v23, v160, v16, 0
  s_waitcnt vmcnt(9)
  s_cmp_ge_i32 s101, 6
  s_cbranch_scc1 L_b124
  s_waitcnt vmcnt(7)
  s_cmp_ge_i32 s101, 3
  s_cbranch_scc1 L_b124
  s_waitcnt vmcnt(6)
L_b124:
  buffer_load_dwordx4 v[96:99], v2, s[8:11], s48 offen offset:3072 nt
  s_or_b32 s48, s48, 40960
  s_add_u32 s48, s48, 4096
  s_and_b32 s48, s48, 1003520
  v_dot2_f32_bf16 v20, v149, v17, v20
  v_dot2_f32_bf16 v21, v153, v17, v21
  v_dot2_f32_bf16 v22, v157, v17, v22
  v_dot2_f32_bf16 v23, v161, v17, v23
  s_waitcnt vmcnt(8)
  s_cmp_ge_i32 s101, 8
  s_cbranch_scc1 L_b125
  s_waitcnt vmcnt(7)
  s_cmp_ge_i32 s101, 5
  s_cbranch_scc1 L_b125
  s_waitcnt vmcnt(6)
L_b125:
  buffer_load_dwordx4 v[100:103], v2, s[8:11], s48 offen offset:0 nt
  global_load_dwordx4 a[0:3], v[6:7], off offset:0 nt
  v_dot2_f32_bf16 v20, v150, v18, v20
  v_dot2_f32_bf16 v21, v154, v18, v21
  v_dot2_f32_bf16 v22, v158, v18, v22
  v_dot2_f32_bf16 v23, v162, v18, v23
  s_waitcnt vmcnt(9)
  s_cmp_ge_i32 s101, 7
  s_cbranch_scc1 L_b126
  s_waitcnt vmcnt(8)
  s_cmp_ge_i32 s101, 4
  s_cbranch_scc1 L_b126
  s_waitcnt vmcnt(6)
L_b126:
  buffer_load_dwordx4 v[104:107], v2, s[8:11], s48 offen offset:1024 nt
  v_dot2_f32_bf16 v20, v151, v19, v20
  v_dot2_f32_bf16 v21, v155, v19, v21
  v_dot2_f32_bf16 v22, v159, v19, v22
  v_dot2_f32_bf16 v23, v163, v19, v23
  s_waitcnt vmcnt(9)
  s_cmp_ge_i32 s101, 8
  s_cbranch_scc1 L_b127
  s_waitcnt vmcnt(7)
  s_cmp_ge_i32 s101, 5
  s_cbranch_scc1 L_b127
  s_waitcnt vmcnt(6)
L_b127:
  buffer_load_dwordx4 v[108:111], v2, s[8:11], s48 offen offset:2048 nt
  v_add_f32_dpp v20, v20, v20 row_ror:8 row_mask:0xf bank_mask:0x3
  v_add_f32_dpp v21, v21, v21 row_ror:8 row_mask:0xf bank_mask:0x3
  v_add_f32_dpp v20, v22, v22 row_ror:8 row_mask:0xf bank_mask:0xc
  v_add_f32_dpp v21, v23, v23 row_ror:8 row_mask:0xf bank_mask:0xc
  s_nop 0
  v_add_f32_dpp v26, v20, v20 row_half_mirror row_mask:0xf bank_mask:0x5
  v_add_f32_dpp v26, v21, v21 row_half_mirror row_mask:0xf bank_mask:0xa
  v_dot2_f32_bf16 v20, v164, v16, 0
  v_dot2_f32_bf16 v21, v168, v16, 0
  v_dot2_f32_bf16 v22, v172, v16, 0
  v_dot2_f32_bf16 v23, v176, v16, 0
  s_waitcnt vmcnt(8)
  s_memrealtime s[80:81]
L_blk8:
  s_cmp_ge_i32 s101, 6
  s_cbranch_scc1 L_b128
  s_waitcnt vmcnt(7)
  s_cmp_ge_i32 s101, 1
  s_cbranch_scc1 L_b128
  s_waitcnt vmcnt(5)
L_b128:
  buffer_load_dwordx4 v[112:115], v2, s[8:11], s48 offen offset:3072 nt
  s_or_b32 s48, s48, 40960
  s_add_u32 s48, s48, 4096
  s_and_b32 s48, s48, 1003520
  global_load_dwordx4 a[4:7], v[6:7], off offset:3584 nt
  v_lshl_add_u64 v[6:7], v[6:7], 0, s[98:99]
  v_dot2_f32_bf16 v20, v165, v17, v20
  v_dot2_f32_bf16 v21, v169, v17, v21
  v_dot2_f32_bf16 v22, v173, v17, v22
  v_dot2_f32_bf16 v23, v177, v17, v23
  v_dot2_f32_bf16 v20, v166, v18, v20
  v_dot2_f32_bf16 v21, v170, v18, v21
  v_dot2_f32_bf16 v22, v174, v18, v22
  v_dot2_f32_bf16 v23, v178, v18, v23
  s_waitcnt vmcnt(9)
  s_cmp_ge_i32 s101, 8
  s_cbranch_scc1 L_b129
  s_waitcnt vmcnt(7)
  s_cmp_ge_i32 s101, 5
  s_cbranch_scc1 L_b129
  s_waitcnt vmcnt(6)
L_b129:
  buffer_load_dwordx4 v[116:119], v2, s[8:11], s48 offen offset:0 nt
  v_dot2_f32_bf16 v20, v167, v19, v20
  v_dot2_f32_bf16 v21, v171, v19, v21
  v_dot2_f32_bf16 v22, v175, v19, v22
  v_dot2_f32_bf16 v23, v179, v19, v23
  v_add_f32_dpp v20, v20, v20 row_ror:8 row_mask:0xf bank_mask:0x3
  v_add_f32_dpp v21, v21, v21 row_ror:8 row_mask:0xf bank_mask:0x3
  v_add_f32_dpp v20, v22, v22 row_ror:8 row_mask:0xf bank_mask:0xc
  v_add_f32_dpp v21, v23, v23 row_ror:8 row_mask:0xf bank_mask:0xc
  s_nop 0
  v_add_f32_dpp v27, v20, v20 row_half_mirror row_mask:0xf bank_mask:0x5
  v_add_f32_dpp v27, v21, v21 row_half_mirror row_mask:0xf bank_mask:0xa
  s_waitcnt vmcnt(8)
  s_waitcnt lgkmcnt(0)
  s_sub_u32 s101, s80, s84
  s_sub_i32 s101, s101, 2020
  s_mul_i32 s101, s101, 2184
  s_ashr_i32 s101, s101, 16
  s_cmp_ge_i32 s101, 7
  s_cbranch_scc1 L_b130
  s_waitcnt vmcnt(7)
  s_cmp_ge_i32 s101, 4
  s_cbranch_scc1 L_b130
  s_waitcnt vmcnt(6)
L_b130:
  buffer_load_dwordx4 v[120:123], v2, s[8:11], s48 offen offset:1024 nt
  global_load_dwordx4 a[8:11], v[6:7], off offset:0 nt
  v_add_f32_dpp v24, v24, v24 quad_perm:[1,0,3,2] row_mask:0xf bank_mask:0xf
  v_add_f32_dpp v25, v25, v25 quad_perm:[1,0,3,2] row_mask:0xf bank_mask:0xf
  v_add_f32_dpp v26, v26, v26 quad_perm:[1,0,3,2] row_mask:0xf bank_mask:0xf
  v_add_f32_dpp v27, v27, v27 quad_perm:[1,0,3,2] row_mask:0xf bank_mask:0xf
  v_cndmask_b32 v24, v24, v25, s[52:53]
  v_cndmask_b32 v26, v26, v27, s[52:53]
  s_nop 0
  v_add_f32_dpp v24, v24, v24 quad_perm:[2,3,0,1] row_mask:0xf bank_mask:0xf
  v_add_f32_dpp v26, v26, v26 quad_perm:[2,3,0,1] row_mask:0xf bank_mask:0xf
  v_cndmask_b32 v35, v24, v26, s[54:55]
  s_waitcnt vmcnt(9)
  s_mov_b32 s82, L_blk11-L_pc
  s_load_dword s83, s[78:79], s82 offset:0
  s_load_dword s83, s[78:79], s82 offset:512
  s_load_dword s83, s[78:79], s82 offset:1024
  s_load_dword s83, s[78:79], s82 offset:1536
  s_cmp_ge_i32 s101, 8
  s_cbranch_scc1 L_b131
  s_waitcnt vmcnt(8)
  s_cmp_ge_i32 s101, 5
  s_cbranch_scc1 L_b131
  s_waitcnt vmcnt(6)
L_b131:
  buffer_load_dwordx4 v[124:127], v2, s[8:11], s48 offen offset:2048 nt
  v_cvt_pk_bf16_f32 v35, v35, v35
  v_and_b32 v35, 0xffff0000, v35
  v_mul_f32 v35, s44, v35
  v_cvt_pk_bf16_f32 v35, v35, v35
  v_and_b32 v35, 0xffff0000, v35
  v_max_f32 v15, v15, v35
  v_dot2_f32_bf16 v20, v180, v16, 0
  v_dot2_f32_bf16 v21, v184, v16, 0
  v_dot2_f32_bf16 v22, v188, v16, 0
  v_dot2_f32_bf16 v23, v96, v16, 0
  s_waitcnt vmcnt(9)
  s_cmp_ge_i32 s101, 6
  s_cbranch_scc1 L_b132
  s_waitcnt vmcnt(7)
  s_cmp_ge_i32 s101, 3
  s_cbranch_scc1 L_b132
  s_waitcnt vmcnt(6)
L_b132:
  buffer_load_dwordx4 v[128:131], v2, s[8:11], s48 offen offset:3072 nt
  s_or_b32 s48, s48, 40960
  s_add_u32 s48, s48, 4096
  s_and_b32 s48, s48, 1003520
  v_dot2_f32_bf16 v20, v181, v17, v20
  v_dot2_f32_bf16 v21, v185, v17, v21
  v_dot2_f32_bf16 v22, v189, v17, v22
  v_dot2_f32_bf16 v23, v97, v17, v23
  s_waitcnt vmcnt(8)
  s_cmp_ge_i32 s101, 8
  s_cbranch_scc1 L_b133
  s_waitcnt vmcnt(7)
  s_cmp_ge_i32 s101, 5
  s_cbranch_scc1 L_b133
  s_waitcnt vmcnt(6)
L_b133:
  buffer_load_dwordx4 v[132:135], v2, s[8:11], s48 offen offset:0 nt
  global_load_dwordx4 a[12:15], v[6:7], off offset:3584 nt
  v_lshl_add_u64 v[6:7], v[6:7], 0, s[98:99]
  v_dot2_f32_bf16 v20, v182, v18, v20
  v_dot2_f32_bf16 v21, v186, v18, v21
  v_dot2_f32_bf16 v22, v190, v18, v22
  v_dot2_f32_bf16 v23, v98, v18, v23
  s_waitcnt vmcnt(9)
  s_cmp_ge_i32 s101, 7
  s_cbranch_scc1 L_b134
  s_waitcnt vmcnt(8)
  s_cmp_ge_i32 s101, 4
  s_cbranch_scc1 L_b134
  s_waitcnt vmcnt(6)
L_b134:
  buffer_load_dwordx4 v[136:139], v2, s[8:11], s48 offen offset:1024 nt
  v_dot2_f32_bf16 v20, v183, v19, v20
  v_dot2_f32_bf16 v21, v187, v19, v21
  v_dot2_f32_bf16 v22, v191, v19, v22
  v_dot2_f32_bf16 v23, v99, v19, v23
  s_waitcnt vmcnt(9)
  s_cmp_ge_i32 s101, 8
  s_cbranch_scc1 L_b135
  s_waitcnt vmcnt(7)
  s_cmp_ge_i32 s101, 5
  s_cbranch_scc1 L_b135
  s_waitcnt vmcnt(6)
L_b135:
  buffer_load_dwordx4 v[140:143], v2, s[8:11], s48 offen offset:2048 nt
  global_load_dwordx4 a[16:19], v[6:7], off offset:0 nt
  v_add_f32_dpp v20, v20, v20 row_ror:8 row_mask:0xf bank_mask:0x3
  v_add_f32_dpp v21, v21, v21 row_ror:8 row_mask:0xf bank_mask:0x3
  v_add_f32_dpp v20, v22, v22 row_ror:8 row_mask:0xf bank_mask:0xc
  v_add_f32_dpp v21, v23, v23 row_ror:8 row_mask:0xf bank_mask:0xc
  s_nop 0
  v_add_f32_dpp v24, v20, v20 row_half_mirror row_mask:0xf bank_mask:0x5
  v_add_f32_dpp v24, v21, v21 row_half_mirror row_mask:0xf bank_mask:0xa
  v_dot2_f32_bf16 v20, v100, v16, 0
  v_dot2_f32_bf16 v21, v104, v16, 0
  v_dot2_f32_bf16 v22, v108, v16, 0
  v_dot2_f32_bf16 v23, v112, v16, 0
  s_waitcnt vmcnt(9)
  s_cmp_ge_i32 s101, 6
  s_cbranch_scc1 L_b136
  s_waitcnt vmcnt(8)
  s_cmp_ge_i32 s101, 2
  s_cbranch_scc1 L_b136
  s_waitcnt vmcnt(6)
L_b136:
  buffer_load_dwordx4 v[144:147], v2, s[8:11], s48 offen offset:3072 nt
  s_or_b32 s48, s48, 40960
  s_add_u32 s48, s48, 4096
  s_and_b32 s48, s48, 1003520
  v_dot2_f32_bf16 v20, v101, v17, v20
  v_dot2_f32_bf16 v21, v105, v17, v21
  v_dot2_f32_bf16 v22, v109, v17, v22
  v_dot2_f32_bf16 v23, v113, v17, v23
  s_waitcnt vmcnt(9)
  s_cmp_ge_i32 s101, 8
  s_cbranch_scc1 L_b137
  s_waitcnt vmcnt(7)
  s_cmp_ge_i32 s101, 5
  s_cbranch_scc1 L_b137
  s_waitcnt vmcnt(6)
L_b137:
  buffer_load_dwordx4 v[148:151], v2, s[8:11], s48 offen offset:0 nt
  v_dot2_f32_bf16 v20, v102, v18, v20
  v_dot2_f32_bf16 v21, v106, v18, v21
  v_dot2_f32_bf16 v22, v110, v18, v22
  v_dot2_f32_bf16 v23, v114, v18, v23
  s_waitcnt vmcnt(8)
  s_cmp_ge_i32 s101, 7
  s_cbranch_scc1 L_b138
  s_waitcnt vmcnt(7)
  s_cmp_ge_i32 s101, 4
  s_cbranch_scc1 L_b138
  s_waitcnt vmcnt(6)
L_b138:
  buffer_load_dwordx4 v[152:155], v2, s[8:11], s48 offen offset:1024 nt
  global_load_dwordx4 a[20:23], v[6:7], off offset:3584 nt
  v_lshl_add_u64 v[6:7], v[6:7], 0, s[98:99]
  v_dot2_f32_bf16 v20, v103, v19, v20
  v_dot2_f32_bf16 v21, v107, v19, v21
  v_dot2_f32_bf16 v22, v111, v19, v22
  v_dot2_f32_bf16 v23, v115, v19, v23
  s_waitcnt vmcnt(9)
  s_cmp_ge_i32 s101, 8
  s_cbranch_scc1 L_b139
  s_waitcnt vmcnt(8)
  s_cmp_ge_i32 s101, 5
  s_cbranch_scc1 L_b139
  s_waitcnt vmcnt(6)
L_b139:
  buffer_load_dwordx4 v[156:159], v2, s[8:11], s48 offen offset:2048 nt
  v_add_f32_dpp v20, v20, v20 row_ror:8 row_mask:0xf bank_mask:0x3
  v_add_f32_dpp v21, v21, v21 row_ror:8 row_mask:0xf bank_mask:0x3
  v_add_f32_dpp v20, v22, v22 row_ror:8 row_mask:0xf bank_mask:0xc
  v_add_f32_dpp v21, v23, v23 row_ror:8 row_mask:0xf bank_mask:0xc
  s_nop 0
  v_add_f32_dpp v25, v20, v20 row_half_mirror row_mask:0xf bank_mask:0x5
  v_add_f32_dpp v25, v21, v21 row_half_mirror row_mask:0xf bank_mask:0xa
  v_dot2_f32_bf16 v20, v116, v16, 0
  v_dot2_f32_bf16 v21, v120, v16, 0
  v_dot2_f32_bf16 v22, v124, v16, 0
  v_dot2_f32_bf16 v23, v128, v16, 0
  s_waitcnt vmcnt(9)
  s_cmp_ge_i32 s101, 6
  s_cbranch_scc1 L_b140
  s_waitcnt vmcnt(7)
  s_cmp_ge_i32 s101, 3
  s_cbranch_scc1 L_b140
  s_waitcnt vmcnt(6)
L_b140:
  buffer_load_dwordx4 v[160:163], v2, s[8:11], s48 offen offset:3072 nt
  s_or_b32 s48, s48, 40960
  s_add_u32 s48, s48, 4096
  s_and_b32 s48, s48, 1003520
  v_dot2_f32_bf16 v20, v117, v17, v20
  v_dot2_f32_bf16 v21, v121, v17, v21
  v_dot2_f32_bf16 v22, v125, v17, v22
  v_dot2_f32_bf16 v23, v129, v17, v23
  s_waitcnt vmcnt(8)
  s_cmp_ge_i32 s101, 8
  s_cbranch_scc1 L_b141
  s_waitcnt vmcnt(7)
  s_cmp_ge_i32 s101, 5
  s_cbranch_scc1 L_b141
  s_waitcnt vmcnt(5)
L_b141:
  buffer_load_dwordx4 v[164:167], v2, s[8:11], s48 offen offset:0 nt
  global_load_dwordx4 a[24:27], v[6:7], off offset:0 nt
  v_dot2_f32_bf16 v20, v118, v18, v20
  v_dot2_f32_bf16 v21, v122, v18, v21
  v_dot2_f32_bf16 v22, v126, v18, v22
  v_dot2_f32_bf16 v23, v130, v18, v23
  s_waitcnt vmcnt(9)
  s_cmp_ge_i32 s101, 7
  s_cbranch_scc1 L_b142
  s_waitcnt vmcnt(7)
  s_cmp_ge_i32 s101, 4
  s_cbranch_scc1 L_b142
  s_waitcnt vmcnt(6)
L_b142:
  buffer_load_dwordx4 v[168:171], v2, s[8:11], s48 offen offset:1024 nt
  v_dot2_f32_bf16 v20, v119, v19, v20
  v_dot2_f32_bf16 v21, v123, v19, v21
  v_dot2_f32_bf16 v22, v127, v19, v22
  v_dot2_f32_bf16 v23, v131, v19, v23
  s_waitcnt vmcnt(8)
  s_cmp_ge_i32 s101, 8
  s_cbranch_scc1 L_b143
  s_waitcnt vmcnt(7)
  s_cmp_ge_i32 s101, 5
  s_cbranch_scc1 L_b143
  s_waitcnt vmcnt(6)
L_b143:
  buffer_load_dwordx4 v[172:175], v2, s[8:11], s48 offen offset:2048 nt
  global_load_dwordx4 a[28:31], v[6:7], off offset:3584 nt
  v_lshl_add_u64 v[6:7], v[6:7], 0, s[98:99]
  v_add_f32_dpp v20, v20, v20 row_ror:8 row_mask:0xf bank_mask:0x3
  v_add_f32_dpp v21, v21, v21 row_ror:8 row_mask:0xf bank_mask:0x3
  v_add_f32_dpp v20, v22, v22 row_ror:8 row_mask:0xf bank_mask:0xc
  v_add_f32_dpp v21, v23, v23 row_ror:8 row_mask:0xf bank_mask:0xc
  s_nop 0
  v_add_f32_dpp v26, v20, v20 row_half_mirror row_mask:0xf bank_mask:0x5
  v_add_f32_dpp v26, v21, v21 row_half_mirror row_mask:0xf bank_mask:0xa
  v_dot2_f32_bf16 v20, v132, v16, 0
  v_dot2_f32_bf16 v21, v136, v16, 0
  v_dot2_f32_bf16 v22, v140, v16, 0
  v_dot2_f32_bf16 v23, v144, v16, 0
  s_waitcnt vmcnt(9)
  s_memrealtime s[80:81]
L_blk9:
  s_cmp_ge_i32 s101, 6
  s_cbranch_scc1 L_b144
  s_waitcnt vmcnt(8)
  s_cmp_ge_i32 s101, 1
  s_cbranch_scc1 L_b144
  s_waitcnt vmcnt(6)
L_b144:
  buffer_load_dwordx4 v[176:179], v2, s[8:11], s48 offen offset:3072 nt
  s_or_b32 s48, s48, 40960
  s_add_u32 s48, s48, 4096
  s_and_b32 s48, s48, 1003520
  v_dot2_f32_bf16 v20, v133, v17, v20
  v_dot2_f32_bf16 v21, v137, v17, v21
  v_dot2_f32_bf16 v22, v141, v17, v22
  v_dot2_f32_bf16 v23, v145, v17, v23
  v_dot2_f32_bf16 v20, v134, v18, v20
  v_dot2_f32_bf16 v21, v138, v18, v21
  v_dot2_f32_bf16 v22, v142, v18, v22
  v_dot2_f32_bf16 v23, v146, v18, v23
  s_waitcnt vmcnt(9)
  s_cmp_ge_i32 s101, 8
  s_cbranch_scc1 L_b145
  s_waitcnt vmcnt(7)
  s_cmp_ge_i32 s101, 5
  s_cbranch_scc1 L_b145
  s_waitcnt vmcnt(6)
L_b145:
  buffer_load_dwordx4 v[180:183], v2, s[8:11], s48 offen offset:0 nt
  v_dot2_f32_bf16 v20, v135, v19, v20
  v_dot2_f32_bf16 v21, v139, v19, v21
  v_dot2_f32_bf16 v22, v143, v19, v22
  v_dot2_f32_bf16 v23, v147, v19, v23
  v_add_f32_dpp v20, v20, v20 row_ror:8 row_mask:0xf bank_mask:0x3
  v_add_f32_dpp v21, v21, v21 row_ror:8 row_mask:0xf bank_mask:0x3
  v_add_f32_dpp v20, v22, v22 row_ror:8 row_mask:0xf bank_mask:0xc
  v_add_f32_dpp v21, v23, v23 row_ror:8 row_mask:0xf bank_mask:0xc
  s_nop 0
  v_add_f32_dpp v27, v20, v20 row_half_mirror row_mask:0xf bank_mask:0x5
  v_add_f32_dpp v27, v21, v21 row_half_mirror row_mask:0xf bank_mask:0xa
  s_waitcnt vmcnt(8)
  s_waitcnt lgkmcnt(0)
  s_sub_u32 s101, s80, s84
  s_sub_i32 s101, s101, 2250
  s_mul_i32 s101, s101, 2184
  s_ashr_i32 s101, s101, 16
  s_cmp_ge_i32 s101, 7
  s_cbranch_scc1 L_b146
  s_waitcnt vmcnt(7)
  s_cmp_ge_i32 s101, 4
  s_cbranch_scc1 L_b146
  s_waitcnt vmcnt(6)
L_b146:
  buffer_load_dwordx4 v[184:187], v2, s[8:11], s48 offen offset:1024 nt
  global_load_dwordx4 a[32:35], v[6:7], off offset:0 nt
  v_add_f32_dpp v24, v24, v24 quad_perm:[1,0,3,2] row_mask:0xf bank_mask:0xf
  v_add_f32_dpp v25, v25, v25 quad_perm:[1,0,3,2] row_mask:0xf bank_mask:0xf
  v_add_f32_dpp v26, v26, v26 quad_perm:[1,0,3,2] row_mask:0xf bank_mask:0xf
  v_add_f32_dpp v27, v27, v27 quad_perm:[1,0,3,2] row_mask:0xf bank_mask:0xf
  v_cndmask_b32 v24, v24, v25, s[52:53]
  v_cndmask_b32 v26, v26, v27, s[52:53]
  s_nop 0
  v_add_f32_dpp v24, v24, v24 quad_perm:[2,3,0,1] row_mask:0xf bank_mask:0xf
  v_add_f32_dpp v26, v26, v26 quad_perm:[2,3,0,1] row_mask:0xf bank_mask:0xf
  v_cndmask_b32 v36, v24, v26, s[54:55]
  s_waitcnt vmcnt(9)
  s_mov_b32 s82, L_blk12-L_pc
  s_load_dword s83, s[78:79], s82 offset:0
  s_load_dword s83, s[78:79], s82 offset:512
  s_load_dword s83, s[78:79], s82 offset:1024
  s_load_dword s83, s[78:79], s82 offset:1536
  s_cmp_ge_i32 s101, 8
  s_cbranch_scc1 L_b147
  s_waitcnt vmcnt(8)
  s_cmp_ge_i32 s101, 5
  s_cbranch_scc1 L_b147
  s_waitcnt vmcnt(6)
L_b147:
  buffer_load_dwordx4 v[188:191], v2, s[8:11], s48 offen offset:2048 nt
  v_cvt_pk_bf16_f32 v36, v36, v36
  v_and_b32 v36, 0xffff0000, v36
  v_mul_f32 v36, s44, v36
  v_cvt_pk_bf16_f32 v36, v36, v36
  v_and_b32 v36, 0xffff0000, v36
  v_max_f32 v15, v15, v36
  v_dot2_f32_bf16 v20, v148, v16, 0
  v_dot2_f32_bf16 v21, v152, v16, 0
  v_dot2_f32_bf16 v22, v156, v16, 0
  v_dot2_f32_bf16 v23, v160, v16, 0
  s_waitcnt vmcnt(9)
  s_cmp_ge_i32 s101, 6
  s_cbranch_scc1 L_b148
  s_waitcnt vmcnt(7)
  s_cmp_ge_i32 s101, 3
  s_cbranch_scc1 L_b148
  s_waitcnt vmcnt(6)
L_b148:
  buffer_load_dwordx4 v[96:99], v2, s[8:11], s48 offen offset:3072 nt
  s_or_b32 s48, s48, 40960
  s_add_u32 s48, s48, 4096
  s_and_b32 s48, s48, 1003520
  global_load_dwordx4 a[36:39], v[6:7], off offset:3584 nt
  v_lshl_add_u64 v[6:7], v[6:7], 0, s[98:99]
  v_dot2_f32_bf16 v20, v149, v17, v20
  v_dot2_f32_bf16 v21, v153, v17, v21
  v_dot2_f32_bf16 v22, v157, v17, v22
  v_dot2_f32_bf16 v23, v161, v17, v23
  s_waitcnt vmcnt(9)
  s_cmp_ge_i32 s101, 8
  s_cbranch_scc1 L_b149
  s_waitcnt vmcnt(8)
  s_cmp_ge_i32 s101, 5
  s_cbranch_scc1 L_b149
  s_waitcnt vmcnt(6)
L_b149:
  buffer_load_dwordx4 v[100:103], v2, s[8:11], s48 offen offset:0 nt
  v_dot2_f32_bf16 v20, v150, v18, v20
  v_dot2_f32_bf16 v21, v154, v18, v21
  v_dot2_f32_bf16 v22, v158, v18, v22
  v_dot2_f32_bf16 v23, v162, v18, v23
  s_waitcnt vmcnt(9)
  s_cmp_ge_i32 s101, 7
  s_cbranch_scc1 L_b150
  s_waitcnt vmcnt(7)
  s_cmp_ge_i32 s101, 4
  s_cbranch_scc1 L_b150
  s_waitcnt vmcnt(6)
L_b150:
  buffer_load_dwordx4 v[104:107], v2, s[8:11], s48 offen offset:1024 nt
  v_dot2_f32_bf16 v20, v151, v19, v20
  v_dot2_f32_bf16 v21, v155, v19, v21
  v_dot2_f32_bf16 v22, v159, v19, v22
  v_dot2_f32_bf16 v23, v163, v19, v23
  s_waitcnt vmcnt(8)
  s_cmp_ge_i32 s101, 8
  s_cbranch_scc1 L_b151
  s_waitcnt vmcnt(7)
  s_cmp_ge_i32 s101, 5
  s_cbranch_scc1 L_b151
  s_waitcnt vmcnt(6)
L_b151:
  buffer_load_dwordx4 v[108:111], v2, s[8:11], s48 offen offset:2048 nt
  global_load_dwordx4 a[40:43], v[6:7], off offset:0 nt
  v_add_f32_dpp v20, v20, v20 row_ror:8 row_mask:0xf bank_mask:0x3
  v_add_f32_dpp v21, v21, v21 row_ror:8 row_mask:0xf bank_mask:0x3
  v_add_f32_dpp v20, v22, v22 row_ror:8 row_mask:0xf bank_mask:0xc
  v_add_f32_dpp v21, v23, v23 row_ror:8 row_mask:0xf bank_mask:0xc
  s_nop 0
  v_add_f32_dpp v24, v20, v20 row_half_mirror row_mask:0xf bank_mask:0x5
  v_add_f32_dpp v24, v21, v21 row_half_mirror row_mask:0xf bank_mask:0xa
  v_dot2_f32_bf16 v20, v164, v16, 0
  v_dot2_f32_bf16 v21, v168, v16, 0
  v_dot2_f32_bf16 v22, v172, v16, 0
  v_dot2_f32_bf16 v23, v176, v16, 0
  s_waitcnt vmcnt(9)
  s_cmp_ge_i32 s101, 6
  s_cbranch_scc1 L_b152
  s_waitcnt vmcnt(8)
  s_cmp_ge_i32 s101, 2
  s_cbranch_scc1 L_b152
  s_waitcnt vmcnt(6)
L_b152:
  buffer_load_dwordx4 v[112:115], v2, s[8:11], s48 offen offset:3072 nt
  s_or_b32 s48, s48, 40960
  s_add_u32 s48, s48, 4096
  s_and_b32 s48, s48, 1003520
  v_dot2_f32_bf16 v20, v165, v17, v20
  v_dot2_f32_bf16 v21, v169, v17, v21
  v_dot2_f32_bf16 v22, v173, v17, v22
  v_dot2_f32_bf16 v23, v177, v17, v23
  s_waitcnt vmcnt(9)
  s_cmp_ge_i32 s101, 8
  s_cbranch_scc1 L_b153
  s_waitcnt vmcnt(7)
  s_cmp_ge_i32 s101, 5
  s_cbranch_scc1 L_b153
  s_waitcnt vmcnt(6)
L_b153:
  buffer_load_dwordx4 v[116:119], v0, s[8:11], s48 offen offset:0 nt
  v_dot2_f32_bf16 v20, v166, v18, v20
  v_dot2_f32_bf16 v21, v170, v18, v21
  v_dot2_f32_bf16 v22, v174, v18, v22
  v_dot2_f32_bf16 v23, v178, v18, v23
  s_waitcnt vmcnt(8)
  s_cmp_ge_i32 s101, 7
  s_cbranch_scc1 L_b154
  s_waitcnt vmcnt(7)
  s_cmp_ge_i32 s101, 4
  s_cbranch_scc1 L_b154
  s_waitcnt vmcnt(5)
L_b154:
  buffer_load_dwordx4 v[120:123], v0, s[8:11], s48 offen offset:1024 nt
  global_load_dwordx4 a[44:47], v[6:7], off offset:3584 nt
  v_lshl_add_u64 v[6:7], v[6:7], 0, s[98:99]
  v_dot2_f32_bf16 v20, v167, v19, v20
  v_dot2_f32_bf16 v21, v171, v19, v21
  v_dot2_f32_bf16 v22, v175, v19, v22
  v_dot2_f32_bf16 v23, v179, v19, v23
  s_waitcnt vmcnt(9)
  s_cmp_ge_i32 s101, 8
  s_cbranch_scc1 L_b155
  s_waitcnt vmcnt(7)
  s_cmp_ge_i32 s101, 5
  s_cbranch_scc1 L_b155
  s_waitcnt vmcnt(6)
L_b155:
  buffer_load_dwordx4 v[124:127], v0, s[8:11], s48 offen offset:2048 nt
  v_add_f32_dpp v20, v20, v20 row_ror:8 row_mask:0xf bank_mask:0x3
  v_add_f32_dpp v21, v21, v21 row_ror:8 row_mask:0xf bank_mask:0x3
  v_add_f32_dpp v20, v22, v22 row_ror:8 row_mask:0xf bank_mask:0xc
  v_add_f32_dpp v21, v23, v23 row_ror:8 row_mask:0xf bank_mask:0xc
  s_nop 0
  v_add_f32_dpp v25, v20, v20 row_half_mirror row_mask:0xf bank_mask:0x5
  v_add_f32_dpp v25, v21, v21 row_half_mirror row_mask:0xf bank_mask:0xa
  v_dot2_f32_bf16 v20, v180, v16, 0
  v_dot2_f32_bf16 v21, v184, v16, 0
  v_dot2_f32_bf16 v22, v188, v16, 0
  v_dot2_f32_bf16 v23, v96, v16, 0
  s_waitcnt vmcnt(8)
  s_cmp_ge_i32 s101, 6
  s_cbranch_scc1 L_b156
  s_waitcnt vmcnt(7)
  s_cmp_ge_i32 s101, 3
  s_cbranch_scc1 L_b156
  s_waitcnt vmcnt(6)
L_b156:
  buffer_load_dwordx4 v[128:131], v0, s[8:11], s48 offen offset:3072 nt
  s_or_b32 s48, s48, 40960
  s_add_u32 s48, s48, 4096
  s_and_b32 s48, s48, 1003520
  global_load_dwordx4 a[48:51], v[6:7], off offset:0 nt
  v_dot2_f32_bf16 v20, v181, v17, v20
  v_dot2_f32_bf16 v21, v185, v17, v21
  v_dot2_f32_bf16 v22, v189, v17, v22
  v_dot2_f32_bf16 v23, v97, v17, v23
  s_waitcnt vmcnt(9)
  s_cmp_ge_i32 s101, 8
  s_cbranch_scc1 L_b157
  s_waitcnt vmcnt(8)
  s_cmp_ge_i32 s101, 5
  s_cbranch_scc1 L_b157
  s_waitcnt vmcnt(6)
L_b157:
  buffer_load_dwordx4 v[132:135], v0, s[8:11], s48 offen offset:0 nt
  v_dot2_f32_bf16 v20, v182, v18, v20
  v_dot2_f32_bf16 v21, v186, v18, v21
  v_dot2_f32_bf16 v22, v190, v18, v22
  v_dot2_f32_bf16 v23, v98, v18, v23
  s_waitcnt vmcnt(9)
  s_cmp_ge_i32 s101, 7
  s_cbranch_scc1 L_b158
  s_waitcnt vmcnt(7)
  s_cmp_ge_i32 s101, 4
  s_cbranch_scc1 L_b158
  s_waitcnt vmcnt(6)
L_b158:
  buffer_load_dwordx4 v[136:139], v0, s[8:11], s48 offen offset:1024 nt
  v_dot2_f32_bf16 v20, v183, v19, v20
  v_dot2_f32_bf16 v21, v187, v19, v21
  v_dot2_f32_bf16 v22, v191, v19, v22
  v_dot2_f32_bf16 v23, v99, v19, v23
  s_waitcnt vmcnt(8)
  s_cmp_ge_i32 s101, 8
  s_cbranch_scc1 L_b159
  s_waitcnt vmcnt(7)
  s_cmp_ge_i32 s101, 5
  s_cbranch_scc1 L_b159
  s_waitcnt vmcnt(6)
L_b159:
  buffer_load_dwordx4 v[140:143], v0, s[8:11], s48 offen offset:2048 nt
  global_load_dwordx4 a[52:55], v[6:7], off offset:3584 nt
  v_lshl_add_u64 v[6:7], v[6:7], 0, s[98:99]
  v_add_f32_dpp v20, v20, v20 row_ror:8 row_mask:0xf bank_mask:0x3
  v_add_f32_dpp v21, v21, v21 row_ror:8 row_mask:0xf bank_mask:0x3
  v_add_f32_dpp v20, v22, v22 row_ror:8 row_mask:0xf bank_mask:0xc
  v_add_f32_dpp v21, v23, v23 row_ror:8 row_mask:0xf bank_mask:0xc
  s_nop 0
  v_add_f32_dpp v26, v20, v20 row_half_mirror row_mask:0xf bank_mask:0x5
  v_add_f32_dpp v26, v21, v21 row_half_mirror row_mask:0xf bank_mask:0xa
  v_dot2_f32_bf16 v20, v100, v16, 0
  v_dot2_f32_bf16 v21, v104, v16, 0
  v_dot2_f32_bf16 v22, v108, v16, 0
  v_dot2_f32_bf16 v23, v112, v16, 0
  s_waitcnt vmcnt(9)
  s_memrealtime s[80:81]
L_blk10:
  s_cmp_ge_i32 s101, 6
  s_cbranch_scc1 L_b160
  s_waitcnt vmcnt(8)
  s_cmp_ge_i32 s101, 1
  s_cbranch_scc1 L_b160
  s_waitcnt vmcnt(6)
L_b160:
  buffer_load_dwordx4 v[144:147], v0, s[8:11], s48 offen offset:3072 nt
  s_or_b32 s48, s48, 40960
  s_add_u32 s48, s48, 4096
  s_and_b32 s48, s48, 1003520
  v_dot2_f32_bf16 v20, v101, v17, v20
  v_dot2_f32_bf16 v21, v105, v17, v21
  v_dot2_f32_bf16 v22, v109, v17, v22
  v_dot2_f32_bf16 v23, v113, v17, v23
  v_dot2_f32_bf16 v20, v102, v18, v20
  v_dot2_f32_bf16 v21, v106, v18, v21
  v_dot2_f32_bf16 v22, v110, v18, v22
  v_dot2_f32_bf16 v23, v114, v18, v23
  s_waitcnt vmcnt(9)
  s_cmp_ge_i32 s101, 8
  s_cbranch_scc1 L_b161
  s_waitcnt vmcnt(7)
  s_cmp_ge_i32 s101, 5
  s_cbranch_scc1 L_b161
  s_waitcnt vmcnt(6)
L_b161:
  buffer_load_dwordx4 v[148:151], v0, s[8:11], s48 offen offset:0 nt
  global_load_dwordx4 a[56:59], v[6:7], off offset:0 nt
  v_dot2_f32_bf16 v20, v103, v19, v20
  v_dot2_f32_bf16 v21, v107, v19, v21
  v_dot2_f32_bf16 v22, v111, v19, v22
  v_dot2_f32_bf16 v23, v115, v19, v23
  v_add_f32_dpp v20, v20, v20 row_ror:8 row_mask:0xf bank_mask:0x3
  v_add_f32_dpp v21, v21, v21 row_ror:8 row_mask:0xf bank_mask:0x3
  v_add_f32_dpp v20, v22, v22 row_ror:8 row_mask:0xf bank_mask:0xc
  v_add_f32_dpp v21, v23, v23 row_ror:8 row_mask:0xf bank_mask:0xc
  s_nop 0
  v_add_f32_dpp v27, v20, v20 row_half_mirror row_mask:0xf bank_mask:0x5
  v_add_f32_dpp v27, v21, v21 row_half_mirror row_mask:0xf bank_mask:0xa
  s_waitcnt vmcnt(9)
  s_waitcnt lgkmcnt(0)
  s_sub_u32 s101, s80, s84
  s_sub_i32 s101, s101, 2478
  s_mul_i32 s101, s101, 2184
  s_ashr_i32 s101, s101, 16
  s_cmp_ge_i32 s101, 7
  s_cbranch_scc1 L_b162
  s_waitcnt vmcnt(8)
  s_cmp_ge_i32 s101, 4
  s_cbranch_scc1 L_b162
  s_waitcnt vmcnt(6)
L_b162:
  buffer_load_dwordx4 v[152:155], v0, s[8:11], s48 offen offset:1024 nt
  v_add_f32_dpp v24, v24, v24 quad_perm:[1,0,3,2] row_mask:0xf bank_mask:0xf
  v_add_f32_dpp v25, v25, v25 quad_perm:[1,0,3,2] row_mask:0xf bank_mask:0xf
  v_add_f32_dpp v26, v26, v26 quad_perm:[1,0,3,2] row_mask:0xf bank_mask:0xf
  v_add_f32_dpp v27, v27, v27 quad_perm:[1,0,3,2] row_mask:0xf bank_mask:0xf
  v_cndmask_b32 v24, v24, v25, s[52:53]
  v_cndmask_b32 v26, v26, v27, s[52:53]
  s_nop 0
  v_add_f32_dpp v24, v24, v24 quad_perm:[2,3,0,1] row_mask:0xf bank_mask:0xf
  v_add_f32_dpp v26, v26, v26 quad_perm:[2,3,0,1] row_mask:0xf bank_mask:0xf
  v_cndmask_b32 v37, v24, v26, s[54:55]
  s_waitcnt vmcnt(9)
  s_mov_b32 s82, L_blk13-L_pc
  s_load_dword s83, s[78:79], s82 offset:0
  s_load_dword s83, s[78:79], s82 offset:512
  s_load_dword s83, s[78:79], s82 offset:1024
  s_load_dword s83, s[78:79], s82 offset:1536
  s_cmp_ge_i32 s101, 8
  s_cbranch_scc1 L_b163
  s_waitcnt vmcnt(7)
  s_cmp_ge_i32 s101, 5
  s_cbranch_scc1 L_b163
  s_waitcnt vmcnt(6)
L_b163:
  buffer_load_dwordx4 v[156:159], v0, s[8:11], s48 offen offset:2048 nt
  v_cvt_pk_bf16_f32 v37, v37, v37
  v_and_b32 v37, 0xffff0000, v37
  v_mul_f32 v37, s44, v37
  v_cvt_pk_bf16_f32 v37, v37, v37
  v_and_b32 v37, 0xffff0000, v37
  v_max_f32 v15, v15, v37
  v_dot2_f32_bf16 v20, v116, v16, 0
  v_dot2_f32_bf16 v21, v120, v16, 0
  v_dot2_f32_bf16 v22, v124, v16, 0
  v_dot2_f32_bf16 v23, v128, v16, 0
  s_waitcnt vmcnt(8)
  s_cmp_ge_i32 s101, 6
  s_cbranch_scc1 L_b164
  s_waitcnt vmcnt(7)
  s_cmp_ge_i32 s101, 3
  s_cbranch_scc1 L_b164
  s_waitcnt vmcnt(6)
L_b164:
  buffer_load_dwordx4 v[160:163], v0, s[8:11], s48 offen offset:3072 nt
  s_or_b32 s48, s48, 40960
  s_add_u32 s48, s48, 4096
  s_and_b32 s48, s48, 1003520
  global_load_dwordx4 a[60:63], v[6:7], off offset:3584 nt
  v_lshl_add_u64 v[6:7], v[6:7], 0, s[98:99]
  v_dot2_f32_bf16 v20, v117, v17, v20
  v_dot2_f32_bf16 v21, v121, v17, v21
  v_dot2_f32_bf16 v22, v125, v17, v22
  v_dot2_f32_bf16 v23, v129, v17, v23
  s_waitcnt vmcnt(9)
  s_cmp_ge_i32 s101, 8
  s_cbranch_scc1 L_b165
  s_waitcnt vmcnt(8)
  s_cmp_ge_i32 s101, 5
  s_cbranch_scc1 L_b165
  s_waitcnt vmcnt(6)
L_b165:
  buffer_load_dwordx4 v[164:167], v0, s[8:11], s48 offen offset:0 nt
  v_dot2_f32_bf16 v20, v118, v18, v20
  v_dot2_f32_bf16 v21, v122, v18, v21
  v_dot2_f32_bf16 v22, v126, v18, v22
  v_dot2_f32_bf16 v23, v130, v18, v23
  s_waitcnt vmcnt(9)
  s_cmp_ge_i32 s101, 7
  s_cbranch_scc1 L_b166
  s_waitcnt vmcnt(7)
  s_cmp_ge_i32 s101, 4
  s_cbranch_scc1 L_b166
  s_waitcnt vmcnt(6)
L_b166:
  buffer_load_dwordx4 v[168:171], v0, s[8:11], s48 offen offset:1024 nt
  v_dot2_f32_bf16 v20, v119, v19, v20
  v_dot2_f32_bf16 v21, v123, v19, v21
  v_dot2_f32_bf16 v22, v127, v19, v22
  v_dot2_f32_bf16 v23, v131, v19, v23
  s_waitcnt vmcnt(8)
  s_cmp_ge_i32 s101, 8
  s_cbranch_scc1 L_b167
  s_waitcnt vmcnt(7)
  s_cmp_ge_i32 s101, 5
  s_cbranch_scc1 L_b167
  s_waitcnt vmcnt(5)
L_b167:
  buffer_load_dwordx4 v[172:175], v0, s[8:11], s48 offen offset:2048 nt
  global_load_dwordx4 a[64:67], v[6:7], off offset:0 nt
  v_add_f32_dpp v20, v20, v20 row_ror:8 row_mask:0xf bank_mask:0x3
  v_add_f32_dpp v21, v21, v21 row_ror:8 row_mask:0xf bank_mask:0x3
  v_add_f32_dpp v20, v22, v22 row_ror:8 row_mask:0xf bank_mask:0xc
  v_add_f32_dpp v21, v23, v23 row_ror:8 row_mask:0xf bank_mask:0xc
  s_nop 0
  v_add_f32_dpp v24, v20, v20 row_half_mirror row_mask:0xf bank_mask:0x5
  v_add_f32_dpp v24, v21, v21 row_half_mirror row_mask:0xf bank_mask:0xa
  v_dot2_f32_bf16 v20, v132, v16, 0
  v_dot2_f32_bf16 v21, v136, v16, 0
  v_dot2_f32_bf16 v22, v140, v16, 0
  v_dot2_f32_bf16 v23, v144, v16, 0
  s_waitcnt vmcnt(9)
  s_cmp_ge_i32 s101, 6
  s_cbranch_scc1 L_b168
  s_waitcnt vmcnt(7)
  s_cmp_ge_i32 s101, 2
  s_cbranch_scc1 L_b168
  s_waitcnt vmcnt(6)
L_b168:
  buffer_load_dwordx4 v[176:179], v0, s[8:11], s48 offen offset:3072 nt
  s_or_b32 s48, s48, 40960
  s_add_u32 s48, s48, 4096
  s_and_b32 s48, s48, 1003520
  v_dot2_f32_bf16 v20, v133, v17, v20
  v_dot2_f32_bf16 v21, v137, v17, v21
  v_dot2_f32_bf16 v22, v141, v17, v22
  v_dot2_f32_bf16 v23, v145, v17, v23
  s_waitcnt vmcnt(8)
  s_cmp_ge_i32 s101, 8
  s_cbranch_scc1 L_b169
  s_waitcnt vmcnt(7)
  s_cmp_ge_i32 s101, 5
  s_cbranch_scc1 L_b169
  s_waitcnt vmcnt(6)
L_b169:
  buffer_load_dwordx4 v[180:183], v0, s[8:11], s48 offen offset:0 nt
  global_load_dwordx4 a[68:71], v[6:7], off offset:3584 nt
  v_lshl_add_u64 v[6:7], v[6:7], 0, s[98:99]
  v_dot2_f32_bf16 v20, v134, v18, v20
  v_dot2_f32_bf16 v21, v138, v18, v21
  v_dot2_f32_bf16 v22, v142, v18, v22
  v_dot2_f32_bf16 v23, v146, v18, v23
  s_waitcnt vmcnt(9)
  s_cmp_ge_i32 s101, 7
  s_cbranch_scc1 L_b170
  s_waitcnt vmcnt(8)
  s_cmp_ge_i32 s101, 4
  s_cbranch_scc1 L_b170
  s_waitcnt vmcnt(6)
L_b170:
  buffer_load_dwordx4 v[184:187], v0, s[8:11], s48 offen offset:1024 nt
  v_dot2_f32_bf16 v20, v135, v19, v20
  v_dot2_f32_bf16 v21, v139, v19, v21
  v_dot2_f32_bf16 v22, v143, v19, v22
  v_dot2_f32_bf16 v23, v147, v19, v23
  s_waitcnt vmcnt(9)
  s_cmp_ge_i32 s101, 8
  s_cbranch_scc1 L_b171
  s_waitcnt vmcnt(7)
  s_cmp_ge_i32 s101, 5
  s_cbranch_scc1 L_b171
  s_waitcnt vmcnt(6)
L_b171:
  buffer_load_dwordx4 v[188:191], v0, s[8:11], s48 offen offset:2048 nt
  v_add_f32_dpp v20, v20, v20 row_ror:8 row_mask:0xf bank_mask:0x3
  v_add_f32_dpp v21, v21, v21 row_ror:8 row_mask:0xf bank_mask:0x3
  v_add_f32_dpp v20, v22, v22 row_ror:8 row_mask:0xf bank_mask:0xc
  v_add_f32_dpp v21, v23, v23 row_ror:8 row_mask:0xf bank_mask:0xc
  s_nop 0
  v_add_f32_dpp v25, v20, v20 row_half_mirror row_mask:0xf bank_mask:0x5
  v_add_f32_dpp v25, v21, v21 row_half_mirror row_mask:0xf bank_mask:0xa
  v_dot2_f32_bf16 v20, v148, v16, 0
  v_dot2_f32_bf16 v21, v152, v16, 0
  v_dot2_f32_bf16 v22, v156, v16, 0
  v_dot2_f32_bf16 v23, v160, v16, 0
  s_waitcnt vmcnt(8)
  s_cmp_ge_i32 s101, 6
  s_cbranch_scc1 L_b172
  s_waitcnt vmcnt(7)
  s_cmp_ge_i32 s101, 3
  s_cbranch_scc1 L_b172
  s_waitcnt vmcnt(6)
L_b172:
  buffer_load_dwordx4 v[96:99], v0, s[8:11], s48 offen offset:3072 nt
  s_or_b32 s48, s48, 40960
  s_add_u32 s48, s48, 4096
  s_and_b32 s48, s48, 1003520
  global_load_dwordx4 a[72:75], v[6:7], off offset:0 nt
  v_dot2_f32_bf16 v20, v149, v17, v20
  v_dot2_f32_bf16 v21, v153, v17, v21
  v_dot2_f32_bf16 v22, v157, v17, v22
  v_dot2_f32_bf16 v23, v161, v17, v23
  s_waitcnt vmcnt(9)
  s_cmp_ge_i32 s101, 8
  s_cbranch_scc1 L_b173
  s_waitcnt vmcnt(8)
  s_cmp_ge_i32 s101, 5
  s_cbranch_scc1 L_b173
  s_waitcnt vmcnt(6)
L_b173:
  buffer_load_dwordx4 v[100:103], v0, s[8:11], s48 offen offset:0 nt
  v_dot2_f32_bf16 v20, v150, v18, v20
  v_dot2_f32_bf16 v21, v154, v18, v21
  v_dot2_f32_bf16 v22, v158, v18, v22
  v_dot2_f32_bf16 v23, v162, v18, v23
  s_waitcnt vmcnt(9)
  s_cmp_ge_i32 s101, 7
  s_cbranch_scc1 L_b174
  s_waitcnt vmcnt(7)
  s_cmp_ge_i32 s101, 4
  s_cbranch_scc1 L_b174
  s_waitcnt vmcnt(6)
L_b174:
  buffer_load_dwordx4 v[104:107], v0, s[8:11], s48 offen offset:1024 nt
  global_load_dwordx4 a[76:79], v[6:7], off offset:3584 nt
  v_lshl_add_u64 v[6:7], v[6:7], 0, s[98:99]
  v_dot2_f32_bf16 v20, v151, v19, v20
  v_dot2_f32_bf16 v21, v155, v19, v21
  v_dot2_f32_bf16 v22, v159, v19, v22
  v_dot2_f32_bf16 v23, v163, v19, v23
  s_waitcnt vmcnt(9)
  s_cmp_ge_i32 s101, 8
  s_cbranch_scc1 L_b175
  s_waitcnt vmcnt(8)
  s_cmp_ge_i32 s101, 5
  s_cbranch_scc1 L_b175
  s_waitcnt vmcnt(6)
L_b175:
  buffer_load_dwordx4 v[108:111], v0, s[8:11], s48 offen offset:2048 nt
  v_add_f32_dpp v20, v20, v20 row_ror:8 row_mask:0xf bank_mask:0x3
  v_add_f32_dpp v21, v21, v21 row_ror:8 row_mask:0xf bank_mask:0x3
  v_add_f32_dpp v20, v22, v22 row_ror:8 row_mask:0xf bank_mask:0xc
  v_add_f32_dpp v21, v23, v23 row_ror:8 row_mask:0xf bank_mask:0xc
  s_nop 0
  v_add_f32_dpp v26, v20, v20 row_half_mirror row_mask:0xf bank_mask:0x5
  v_add_f32_dpp v26, v21, v21 row_half_mirror row_mask:0xf bank_mask:0xa
  v_dot2_f32_bf16 v20, v164, v16, 0
  v_dot2_f32_bf16 v21, v168, v16, 0
  v_dot2_f32_bf16 v22, v172, v16, 0
  v_dot2_f32_bf16 v23, v176, v16, 0
  s_waitcnt vmcnt(9)
  s_memrealtime s[80:81]
L_blk11:
  s_cmp_ge_i32 s101, 6
  s_cbranch_scc1 L_b176
  s_waitcnt vmcnt(7)
  s_cmp_ge_i32 s101, 1
  s_cbranch_scc1 L_b176
  s_waitcnt vmcnt(6)
L_b176:
  buffer_load_dwordx4 v[112:115], v0, s[8:11], s48 offen offset:3072 nt
  s_or_b32 s48, s48, 40960
  s_add_u32 s48, s48, 4096
  s_and_b32 s48, s48, 1003520
  v_dot2_f32_bf16 v20, v165, v17, v20
  v_dot2_f32_bf16 v21, v169, v17, v21
  v_dot2_f32_bf16 v22, v173, v17, v22
  v_dot2_f32_bf16 v23, v177, v17, v23
  v_dot2_f32_bf16 v20, v166, v18, v20
  v_dot2_f32_bf16 v21, v170, v18, v21
  v_dot2_f32_bf16 v22, v174, v18, v22
  v_dot2_f32_bf16 v23, v178, v18, v23
  s_waitcnt vmcnt(8)
  s_cmp_ge_i32 s101, 8
  s_cbranch_scc1 L_b177
  s_waitcnt vmcnt(7)
  s_cmp_ge_i32 s101, 5
  s_cbranch_scc1 L_b177
  s_waitcnt vmcnt(6)
L_b177:
  buffer_load_dwordx4 v[116:119], v0, s[8:11], s48 offen offset:0 nt
  global_load_dwordx4 a[80:83], v[6:7], off offset:0 nt
  v_dot2_f32_bf16 v20, v167, v19, v20
  v_dot2_f32_bf16 v21, v171, v19, v21
  v_dot2_f32_bf16 v22, v175, v19, v22
  v_dot2_f32_bf16 v23, v179, v19, v23
  v_add_f32_dpp v20, v20, v20 row_ror:8 row_mask:0xf bank_mask:0x3
  v_add_f32_dpp v21, v21, v21 row_ror:8 row_mask:0xf bank_mask:0x3
  v_add_f32_dpp v20, v22, v22 row_ror:8 row_mask:0xf bank_mask:0xc
  v_add_f32_dpp v21, v23, v23 row_ror:8 row_mask:0xf bank_mask:0xc
  s_nop 0
  v_add_f32_dpp v27, v20, v20 row_half_mirror row_mask:0xf bank_mask:0x5
  v_add_f32_dpp v27, v21, v21 row_half_mirror row_mask:0xf bank_mask:0xa
  s_waitcnt vmcnt(9)
  s_waitcnt lgkmcnt(0)
  s_sub_u32 s101, s80, s84
  s_sub_i32 s101, s101, 2706
  s_mul_i32 s101, s101, 2184
  s_ashr_i32 s101, s101, 16
  s_cmp_ge_i32 s101, 7
  s_cbranch_scc1 L_b178
  s_waitcnt vmcnt(8)
  s_cmp_ge_i32 s101, 4
  s_cbranch_scc1 L_b178
  s_waitcnt vmcnt(6)
L_b178:
  buffer_load_dwordx4 v[120:123], v0, s[8:11], s48 offen offset:1024 nt
  v_add_f32_dpp v24, v24, v24 quad_perm:[1,0,3,2] row_mask:0xf bank_mask:0xf
  v_add_f32_dpp v25, v25, v25 quad_perm:[1,0,3,2] row_mask:0xf bank_mask:0xf
  v_add_f32_dpp v26, v26, v26 quad_perm:[1,0,3,2] row_mask:0xf bank_mask:0xf
  v_add_f32_dpp v27, v27, v27 quad_perm:[1,0,3,2] row_mask:0xf bank_mask:0xf
  v_cndmask_b32 v24, v24, v25, s[52:53]
  v_cndmask_b32 v26, v26, v27, s[52:53]
  s_nop 0
  v_add_f32_dpp v24, v24, v24 quad_perm:[2,3,0,1] row_mask:0xf bank_mask:0xf
  v_add_f32_dpp v26, v26, v26 quad_perm:[2,3,0,1] row_mask:0xf bank_mask:0xf
  v_cndmask_b32 v38, v24, v26, s[54:55]
  s_waitcnt vmcnt(9)
  s_mov_b32 s82, L_blk14-L_pc
  s_load_dword s83, s[78:79], s82 offset:0
  s_load_dword s83, s[78:79], s82 offset:512
  s_load_dword s83, s[78:79], s82 offset:1024
  s_load_dword s83, s[78:79], s82 offset:1536
  s_cmp_ge_i32 s101, 8
  s_cbranch_scc1 L_b179
  s_waitcnt vmcnt(7)
  s_cmp_ge_i32 s101, 5
  s_cbranch_scc1 L_b179
  s_waitcnt vmcnt(6)
L_b179:
  buffer_load_dwordx4 v[124:127], v0, s[8:11], s48 offen offset:2048 nt
  v_cvt_pk_bf16_f32 v38, v38, v38
  v_and_b32 v38, 0xffff0000, v38
  v_mul_f32 v38, s44, v38
  v_cvt_pk_bf16_f32 v38, v38, v38
  v_and_b32 v38, 0xffff0000, v38
  v_max_f32 v15, v15, v38
  v_dot2_f32_bf16 v20, v180, v16, 0
  v_dot2_f32_bf16 v21, v184, v16, 0
  v_dot2_f32_bf16 v22, v188, v16, 0
  v_dot2_f32_bf16 v23, v96, v16, 0
  s_waitcnt vmcnt(8)
  s_cmp_ge_i32 s101, 6
  s_cbranch_scc1 L_b180
  s_waitcnt vmcnt(7)
  s_cmp_ge_i32 s101, 3
  s_cbranch_scc1 L_b180
  s_waitcnt vmcnt(5)
L_b180:
  buffer_load_dwordx4 v[128:131], v0, s[8:11], s48 offen offset:3072 nt
  s_or_b32 s48, s48, 40960
  s_add_u32 s48, s48, 4096
  s_and_b32 s48, s48, 1003520
  global_load_dwordx4 a[84:87], v[6:7], off offset:3584 nt
  v_lshl_add_u64 v[6:7], v[6:7], 0, s[98:99]
  v_dot2_f32_bf16 v20, v181, v17, v20
  v_dot2_f32_bf16 v21, v185, v17, v21
  v_dot2_f32_bf16 v22, v189, v17, v22
  v_dot2_f32_bf16 v23, v97, v17, v23
  s_waitcnt vmcnt(9)
  s_cmp_ge_i32 s101, 8
  s_cbranch_scc1 L_b181
  s_waitcnt vmcnt(7)
  s_cmp_ge_i32 s101, 5
  s_cbranch_scc1 L_b181
  s_waitcnt vmcnt(6)
L_b181:
  buffer_load_dwordx4 v[132:135], v0, s[8:11], s48 offen offset:0 nt
  v_dot2_f32_bf16 v20, v182, v18, v20
  v_dot2_f32_bf16 v21, v186, v18, v21
  v_dot2_f32_bf16 v22, v190, v18, v22
  v_dot2_f32_bf16 v23, v98, v18, v23
  s_waitcnt vmcnt(8)
  s_cmp_ge_i32 s101, 7
  s_cbranch_scc1 L_b182
  s_waitcnt vmcnt(7)
  s_cmp_ge_i32 s101, 4
  s_cbranch_scc1 L_b182
  s_waitcnt vmcnt(6)
L_b182:
  buffer_load_dwordx4 v[136:139], v0, s[8:11], s48 offen offset:1024 nt
  global_load_dwordx4 a[88:91], v[6:7], off offset:0 nt
  v_dot2_f32_bf16 v20, v183, v19, v20
  v_dot2_f32_bf16 v21, v187, v19, v21
  v_dot2_f32_bf16 v22, v191, v19, v22
  v_dot2_f32_bf16 v23, v99, v19, v23
  s_waitcnt vmcnt(9)
  s_cmp_ge_i32 s101, 8
  s_cbranch_scc1 L_b183
  s_waitcnt vmcnt(8)
  s_cmp_ge_i32 s101, 5
  s_cbranch_scc1 L_b183
  s_waitcnt vmcnt(6)
L_b183:
  buffer_load_dwordx4 v[140:143], v0, s[8:11], s48 offen offset:2048 nt
  v_add_f32_dpp v20, v20, v20 row_ror:8 row_mask:0xf bank_mask:0x3
  v_add_f32_dpp v21, v21, v21 row_ror:8 row_mask:0xf bank_mask:0x3
  v_add_f32_dpp v20, v22, v22 row_ror:8 row_mask:0xf bank_mask:0xc
  v_add_f32_dpp v21, v23, v23 row_ror:8 row_mask:0xf bank_mask:0xc
  s_nop 0
  v_add_f32_dpp v24, v20, v20 row_half_mirror row_mask:0xf bank_mask:0x5
  v_add_f32_dpp v24, v21, v21 row_half_mirror row_mask:0xf bank_mask:0xa
  v_dot2_f32_bf16 v20, v100, v16, 0
  v_dot2_f32_bf16 v21, v104, v16, 0
  v_dot2_f32_bf16 v22, v108, v16, 0
  v_dot2_f32_bf16 v23, v112, v16, 0
  s_waitcnt vmcnt(9)
  s_cmp_ge_i32 s101, 6
  s_cbranch_scc1 L_b184
  s_waitcnt vmcnt(7)
  s_cmp_ge_i32 s101, 2
  s_cbranch_scc1 L_b184
  s_waitcnt vmcnt(6)
L_b184:
  buffer_load_dwordx4 v[144:147], v0, s[8:11], s48 offen offset:3072 nt
  s_or_b32 s48, s48, 40960
  s_add_u32 s48, s48, 4096
  s_and_b32 s48, s48, 1003520
  v_dot2_f32_bf16 v20, v101, v17, v20
  v_dot2_f32_bf16 v21, v105, v17, v21
  v_dot2_f32_bf16 v22, v109, v17, v22
  v_dot2_f32_bf16 v23, v113, v17, v23
  s_waitcnt vmcnt(8)
  s_cmp_ge_i32 s101, 8
  s_cbranch_scc1 L_b185
  s_waitcnt vmcnt(7)
  s_cmp_ge_i32 s101, 5
  s_cbranch_scc1 L_b185
  s_waitcnt vmcnt(6)
L_b185:
  buffer_load_dwordx4 v[148:151], v2, s[8:11], s48 offen offset:0 nt
  global_load_dwordx4 a[92:95], v[6:7], off offset:3584 nt
  v_lshl_add_u64 v[6:7], v[6:7], 0, s[98:99]
  v_dot2_f32_bf16 v20, v102, v18, v20
  v_dot2_f32_bf16 v21, v106, v18, v21
  v_dot2_f32_bf16 v22, v110, v18, v22
  v_dot2_f32_bf16 v23, v114, v18, v23
  s_waitcnt vmcnt(9)
  s_cmp_ge_i32 s101, 7
  s_cbranch_scc1 L_b186
  s_waitcnt vmcnt(8)
  s_cmp_ge_i32 s101, 4
  s_cbranch_scc1 L_b186
  s_waitcnt vmcnt(6)
L_b186:
  buffer_load_dwordx4 v[152:155], v2, s[8:11], s48 offen offset:1024 nt
  v_dot2_f32_bf16 v20, v103, v19, v20
  v_dot2_f32_bf16 v21, v107, v19, v21
  v_dot2_f32_bf16 v22, v111, v19, v22
  v_dot2_f32_bf16 v23, v115, v19, v23
  s_waitcnt vmcnt(9)
  s_cmp_ge_i32 s101, 8
  s_cbranch_scc1 L_b187
  s_waitcnt vmcnt(7)
  s_cmp_ge_i32 s101, 5
  s_cbranch_scc1 L_b187
  s_waitcnt vmcnt(6)
L_b187:
  buffer_load_dwordx4 v[156:159], v2, s[8:11], s48 offen offset:2048 nt
  global_load_dwordx4 a[96:99], v[6:7], off offset:0 nt
  v_add_f32_dpp v20, v20, v20 row_ror:8 row_mask:0xf bank_mask:0x3
  v_add_f32_dpp v21, v21, v21 row_ror:8 row_mask:0xf bank_mask:0x3
  v_add_f32_dpp v20, v22, v22 row_ror:8 row_mask:0xf bank_mask:0xc
  v_add_f32_dpp v21, v23, v23 row_ror:8 row_mask:0xf bank_mask:0xc
  s_nop 0
  v_add_f32_dpp v25, v20, v20 row_half_mirror row_mask:0xf bank_mask:0x5
  v_add_f32_dpp v25, v21, v21 row_half_mirror row_mask:0xf bank_mask:0xa
  v_dot2_f32_bf16 v20, v116, v16, 0
  v_dot2_f32_bf16 v21, v120, v16, 0
  v_dot2_f32_bf16 v22, v124, v16, 0
  v_dot2_f32_bf16 v23, v128, v16, 0
  s_waitcnt vmcnt(9)
  s_cmp_ge_i32 s101, 6
  s_cbranch_scc1 L_b188
  s_waitcnt vmcnt(8)
  s_cmp_ge_i32 s101, 3
  s_cbranch_scc1 L_b188
  s_waitcnt vmcnt(6)
L_b188:
  buffer_load_dwordx4 v[160:163], v2, s[8:11], s48 offen offset:3072 nt
  s_or_b32 s48, s48, 40960
  s_add_u32 s48, s48, 4096
  s_and_b32 s48, s48, 1003520
  v_dot2_f32_bf16 v20, v117, v17, v20
  v_dot2_f32_bf16 v21, v121, v17, v21
  v_dot2_f32_bf16 v22, v125, v17, v22
  v_dot2_f32_bf16 v23, v129, v17, v23
  s_waitcnt vmcnt(9)
  s_cmp_ge_i32 s101, 8
  s_cbranch_scc1 L_b189
  s_waitcnt vmcnt(7)
  s_cmp_ge_i32 s101, 5
  s_cbranch_scc1 L_b189
  s_waitcnt vmcnt(6)
L_b189:
  buffer_load_dwordx4 v[164:167], v2, s[8:11], s48 offen offset:0 nt
  v_dot2_f32_bf16 v20, v118, v18, v20
  v_dot2_f32_bf16 v21, v122, v18, v21
  v_dot2_f32_bf16 v22, v126, v18, v22
  v_dot2_f32_bf16 v23, v130, v18, v23
  s_waitcnt vmcnt(8)
  s_cmp_ge_i32 s101, 7
  s_cbranch_scc1 L_b190
  s_waitcnt vmcnt(7)
  s_cmp_ge_i32 s101, 4
  s_cbranch_scc1 L_b190
  s_waitcnt vmcnt(6)
L_b190:
  buffer_load_dwordx4 v[168:171], v2, s[8:11], s48 offen offset:1024 nt
  global_load_dwordx4 a[100:103], v[6:7], off offset:3584 nt
  v_lshl_add_u64 v[6:7], v[6:7], 0, s[98:99]
  v_dot2_f32_bf16 v20, v119, v19, v20
  v_dot2_f32_bf16 v21, v123, v19, v21
  v_dot2_f32_bf16 v22, v127, v19, v22
  v_dot2_f32_bf16 v23, v131, v19, v23
  s_waitcnt vmcnt(9)
  s_cmp_ge_i32 s101, 8
  s_cbranch_scc1 L_b191
  s_waitcnt vmcnt(8)
  s_cmp_ge_i32 s101, 5
  s_cbranch_scc1 L_b191
  s_waitcnt vmcnt(6)
L_b191:
  buffer_load_dwordx4 v[172:175], v2, s[8:11], s48 offen offset:2048 nt
  v_add_f32_dpp v20, v20, v20 row_ror:8 row_mask:0xf bank_mask:0x3
  v_add_f32_dpp v21, v21, v21 row_ror:8 row_mask:0xf bank_mask:0x3
  v_add_f32_dpp v20, v22, v22 row_ror:8 row_mask:0xf bank_mask:0xc
  v_add_f32_dpp v21, v23, v23 row_ror:8 row_mask:0xf bank_mask:0xc
  s_nop 0
  v_add_f32_dpp v26, v20, v20 row_half_mirror row_mask:0xf bank_mask:0x5
  v_add_f32_dpp v26, v21, v21 row_half_mirror row_mask:0xf bank_mask:0xa
  v_dot2_f32_bf16 v20, v132, v16, 0
  v_dot2_f32_bf16 v21, v136, v16, 0
  v_dot2_f32_bf16 v22, v140, v16, 0
  v_dot2_f32_bf16 v23, v144, v16, 0
  s_waitcnt vmcnt(9)
  s_memrealtime s[80:81]
L_blk12:
  s_cmp_ge_i32 s101, 6
  s_cbranch_scc1 L_b192
  s_waitcnt vmcnt(7)
  s_cmp_ge_i32 s101, 1
  s_cbranch_scc1 L_b192
  s_waitcnt vmcnt(6)
L_b192:
  buffer_load_dwordx4 v[176:179], v2, s[8:11], s48 offen offset:3072 nt
  s_or_b32 s48, s48, 40960
  s_add_u32 s48, s48, 4096
  s_and_b32 s48, s48, 1003520
  global_load_dwordx4 a[104:107], v[6:7], off offset:0 nt
  v_dot2_f32_bf16 v20, v133, v17, v20
  v_dot2_f32_bf16 v21, v137, v17, v21
  v_dot2_f32_bf16 v22, v141, v17, v22
  v_dot2_f32_bf16 v23, v145, v17, v23
  v_dot2_f32_bf16 v20, v134, v18, v20
  v_dot2_f32_bf16 v21, v138, v18, v21
  v_dot2_f32_bf16 v22, v142, v18, v22
  v_dot2_f32_bf16 v23, v146, v18, v23
  s_waitcnt vmcnt(9)
  s_cmp_ge_i32 s101, 8
  s_cbranch_scc1 L_b193
  s_waitcnt vmcnt(8)
  s_cmp_ge_i32 s101, 5
  s_cbranch_scc1 L_b193
  s_waitcnt vmcnt(6)
L_b193:
  buffer_load_dwordx4 v[180:183], v2, s[8:11], s48 offen offset:0 nt
  v_dot2_f32_bf16 v20, v135, v19, v20
  v_dot2_f32_bf16 v21, v139, v19, v21
  v_dot2_f32_bf16 v22, v143, v19, v22
  v_dot2_f32_bf16 v23, v147, v19, v23
  v_add_f32_dpp v20, v20, v20 row_ror:8 row_mask:0xf bank_mask:0x3
  v_add_f32_dpp v21, v21, v21 row_ror:8 row_mask:0xf bank_mask:0x3
  v_add_f32_dpp v20, v22, v22 row_ror:8 row_mask:0xf bank_mask:0xc
  v_add_f32_dpp v21, v23, v23 row_ror:8 row_mask:0xf bank_mask:0xc
  s_nop 0
  v_add_f32_dpp v27, v20, v20 row_half_mirror row_mask:0xf bank_mask:0x5
  v_add_f32_dpp v27, v21, v21 row_half_mirror row_mask:0xf bank_mask:0xa
  s_waitcnt vmcnt(9)
  s_waitcnt lgkmcnt(0)
  s_sub_u32 s101, s80, s84
  s_sub_i32 s101, s101, 2934
  s_mul_i32 s101, s101, 2184
  s_ashr_i32 s101, s101, 16
  s_cmp_ge_i32 s101, 7
  s_cbranch_scc1 L_b194
  s_waitcnt vmcnt(7)
  s_cmp_ge_i32 s101, 4
  s_cbranch_scc1 L_b194
  s_waitcnt vmcnt(6)
L_b194:
  buffer_load_dwordx4 v[184:187], v2, s[8:11], s48 offen offset:1024 nt
  v_add_f32_dpp v24, v24, v24 quad_perm:[1,0,3,2] row_mask:0xf bank_mask:0xf
  v_add_f32_dpp v25, v25, v25 quad_perm:[1,0,3,2] row_mask:0xf bank_mask:0xf
  v_add_f32_dpp v26, v26, v26 quad_perm:[1,0,3,2] row_mask:0xf bank_mask:0xf
  v_add_f32_dpp v27, v27, v27 quad_perm:[1,0,3,2] row_mask:0xf bank_mask:0xf
  v_cndmask_b32 v24, v24, v25, s[52:53]
  v_cndmask_b32 v26, v26, v27, s[52:53]
  s_nop 0
  v_add_f32_dpp v24, v24, v24 quad_perm:[2,3,0,1] row_mask:0xf bank_mask:0xf
  v_add_f32_dpp v26, v26, v26 quad_perm:[2,3,0,1] row_mask:0xf bank_mask:0xf
  v_cndmask_b32 v39, v24, v26, s[54:55]
  s_waitcnt vmcnt(8)
  s_mov_b32 s82, L_blk15-L_pc
  s_load_dword s83, s[78:79], s82 offset:0
  s_load_dword s83, s[78:79], s82 offset:512
  s_load_dword s83, s[78:79], s82 offset:1024
  s_load_dword s83, s[78:79], s82 offset:1536
  s_cmp_ge_i32 s101, 8
  s_cbranch_scc1 L_b195
  s_waitcnt vmcnt(7)
  s_cmp_ge_i32 s101, 5
  s_cbranch_scc1 L_b195
  s_waitcnt vmcnt(6)
L_b195:
  buffer_load_dwordx4 v[188:191], v2, s[8:11], s48 offen offset:2048 nt
  global_load_dwordx4 a[108:111], v[6:7], off offset:3584 nt
  v_lshl_add_u64 v[6:7], v[6:7], 0, s[98:99]
  v_cvt_pk_bf16_f32 v39, v39, v39
  v_and_b32 v39, 0xffff0000, v39
  v_mul_f32 v39, s44, v39
  v_cvt_pk_bf16_f32 v39, v39, v39
  v_and_b32 v39, 0xffff0000, v39
  v_max_f32 v15, v15, v39
  v_dot2_f32_bf16 v20, v148, v16, 0
  v_dot2_f32_bf16 v21, v152, v16, 0
  v_dot2_f32_bf16 v22, v156, v16, 0
  v_dot2_f32_bf16 v23, v160, v16, 0
  s_waitcnt vmcnt(9)
  s_cmp_ge_i32 s101, 6
  s_cbranch_scc1 L_b196
  s_waitcnt vmcnt(8)
  s_cmp_ge_i32 s101, 3
  s_cbranch_scc1 L_b196
  s_waitcnt vmcnt(6)
L_b196:
  buffer_load_dwordx4 v[96:99], v2, s[8:11], s48 offen offset:3072 nt
  s_or_b32 s48, s48, 40960
  s_add_u32 s48, s48, 4096
  s_and_b32 s48, s48, 1003520
  v_dot2_f32_bf16 v20, v149, v17, v20
  v_dot2_f32_bf16 v21, v153, v17, v21
  v_dot2_f32_bf16 v22, v157, v17, v22
  v_dot2_f32_bf16 v23, v161, v17, v23
  s_waitcnt vmcnt(9)
  s_cmp_ge_i32 s101, 8
  s_cbranch_scc1 L_b197
  s_waitcnt vmcnt(7)
  s_cmp_ge_i32 s101, 5
  s_cbranch_scc1 L_b197
  s_waitcnt vmcnt(6)
L_b197:
  buffer_load_dwordx4 v[100:103], v2, s[8:11], s48 offen offset:0 nt
  v_dot2_f32_bf16 v20, v150, v18, v20
  v_dot2_f32_bf16 v21, v154, v18, v21
  v_dot2_f32_bf16 v22, v158, v18, v22
  v_dot2_f32_bf16 v23, v162, v18, v23
  s_waitcnt vmcnt(8)
  s_cmp_ge_i32 s101, 7
  s_cbranch_scc1 L_b198
  s_waitcnt vmcnt(7)
  s_cmp_ge_i32 s101, 4
  s_cbranch_scc1 L_b198
  s_waitcnt vmcnt(5)
L_b198:
  buffer_load_dwordx4 v[104:107], v2, s[8:11], s48 offen offset:1024 nt
  global_load_dwordx4 a[112:115], v[6:7], off offset:0 nt
  v_dot2_f32_bf16 v20, v151, v19, v20
  v_dot2_f32_bf16 v21, v155, v19, v21
  v_dot2_f32_bf16 v22, v159, v19, v22
  v_dot2_f32_bf16 v23, v163, v19, v23
  s_waitcnt vmcnt(9)
  s_cmp_ge_i32 s101, 8
  s_cbranch_scc1 L_b199
  s_waitcnt vmcnt(7)
  s_cmp_ge_i32 s101, 5
  s_cbranch_scc1 L_b199
  s_waitcnt vmcnt(6)
L_b199:
  buffer_load_dwordx4 v[108:111], v2, s[8:11], s48 offen offset:2048 nt
  v_add_f32_dpp v20, v20, v20 row_ror:8 row_mask:0xf bank_mask:0x3
  v_add_f32_dpp v21, v21, v21 row_ror:8 row_mask:0xf bank_mask:0x3
  v_add_f32_dpp v20, v22, v22 row_ror:8 row_mask:0xf bank_mask:0xc
  v_add_f32_dpp v21, v23, v23 row_ror:8 row_mask:0xf bank_mask:0xc
  s_nop 0
  v_add_f32_dpp v24, v20, v20 row_half_mirror row_mask:0xf bank_mask:0x5
  v_add_f32_dpp v24, v21, v21 row_half_mirror row_mask:0xf bank_mask:0xa
  v_dot2_f32_bf16 v20, v164, v16, 0
  v_dot2_f32_bf16 v21, v168, v16, 0
  v_dot2_f32_bf16 v22, v172, v16, 0
  v_dot2_f32_bf16 v23, v176, v16, 0
  s_waitcnt vmcnt(8)
  s_cmp_ge_i32 s101, 6
  s_cbranch_scc1 L_b200
  s_waitcnt vmcnt(7)
  s_cmp_ge_i32 s101, 2
  s_cbranch_scc1 L_b200
  s_waitcnt vmcnt(6)
L_b200:
  buffer_load_dwordx4 v[112:115], v2, s[8:11], s48 offen offset:3072 nt
  s_or_b32 s48, s48, 40960
  s_add_u32 s48, s48, 4096
  s_and_b32 s48, s48, 1003520
  global_load_dwordx4 a[116:119], v[6:7], off offset:3584 nt
  v_lshl_add_u64 v[6:7], v[6:7], 0, s[98:99]
  v_dot2_f32_bf16 v20, v165, v17, v20
  v_dot2_f32_bf16 v21, v169, v17, v21
  v_dot2_f32_bf16 v22, v173, v17, v22
  v_dot2_f32_bf16 v23, v177, v17, v23
  s_waitcnt vmcnt(9)
  s_cmp_ge_i32 s101, 8
  s_cbranch_scc1 L_b201
  s_waitcnt vmcnt(8)
  s_cmp_ge_i32 s101, 5
  s_cbranch_scc1 L_b201
  s_waitcnt vmcnt(6)
L_b201:
  buffer_load_dwordx4 v[116:119], v2, s[8:11], s48 offen offset:0 nt
  v_dot2_f32_bf16 v20, v166, v18, v20
  v_dot2_f32_bf16 v21, v170, v18, v21
  v_dot2_f32_bf16 v22, v174, v18, v22
  v_dot2_f32_bf16 v23, v178, v18, v23
  s_waitcnt vmcnt(9)
  s_cmp_ge_i32 s101, 7
  s_cbranch_scc1 L_b202
  s_waitcnt vmcnt(7)
  s_cmp_ge_i32 s101, 4
  s_cbranch_scc1 L_b202
  s_waitcnt vmcnt(6)
L_b202:
  buffer_load_dwordx4 v[120:123], v2, s[8:11], s48 offen offset:1024 nt
  v_dot2_f32_bf16 v20, v167, v19, v20
  v_dot2_f32_bf16 v21, v171, v19, v21
  v_dot2_f32_bf16 v22, v175, v19, v22
  v_dot2_f32_bf16 v23, v179, v19, v23
  s_waitcnt vmcnt(8)
  s_cmp_ge_i32 s101, 8
  s_cbranch_scc1 L_b203
  s_waitcnt vmcnt(7)
  s_cmp_ge_i32 s101, 5
  s_cbranch_scc1 L_b203
  s_waitcnt vmcnt(6)
L_b203:
  buffer_load_dwordx4 v[124:127], v2, s[8:11], s48 offen offset:2048 nt
  global_load_dwordx4 a[120:123], v[6:7], off offset:0 nt
  v_add_f32_dpp v20, v20, v20 row_ror:8 row_mask:0xf bank_mask:0x3
  v_add_f32_dpp v21, v21, v21 row_ror:8 row_mask:0xf bank_mask:0x3
  v_add_f32_dpp v20, v22, v22 row_ror:8 row_mask:0xf bank_mask:0xc
  v_add_f32_dpp v21, v23, v23 row_ror:8 row_mask:0xf bank_mask:0xc
  s_nop 0
  v_add_f32_dpp v25, v20, v20 row_half_mirror row_mask:0xf bank_mask:0x5
  v_add_f32_dpp v25, v21, v21 row_half_mirror row_mask:0xf bank_mask:0xa
  v_dot2_f32_bf16 v20, v180, v16, 0
  v_dot2_f32_bf16 v21, v184, v16, 0
  v_dot2_f32_bf16 v22, v188, v16, 0
  v_dot2_f32_bf16 v23, v96, v16, 0
  s_waitcnt vmcnt(9)
  s_cmp_ge_i32 s101, 6
  s_cbranch_scc1 L_b204
  s_waitcnt vmcnt(8)
  s_cmp_ge_i32 s101, 3
  s_cbranch_scc1 L_b204
  s_waitcnt vmcnt(6)
L_b204:
  buffer_load_dwordx4 v[128:131], v2, s[8:11], s48 offen offset:3072 nt
  s_or_b32 s48, s48, 40960
  s_add_u32 s48, s48, 4096
  s_and_b32 s48, s48, 1003520
  v_dot2_f32_bf16 v20, v181, v17, v20
  v_dot2_f32_bf16 v21, v185, v17, v21
  v_dot2_f32_bf16 v22, v189, v17, v22
  v_dot2_f32_bf16 v23, v97, v17, v23
  s_waitcnt vmcnt(9)
  s_cmp_ge_i32 s101, 8
  s_cbranch_scc1 L_b205
  s_waitcnt vmcnt(7)
  s_cmp_ge_i32 s101, 5
  s_cbranch_scc1 L_b205
  s_waitcnt vmcnt(6)
L_b205:
  buffer_load_dwordx4 v[132:135], v2, s[8:11], s48 offen offset:0 nt
  global_load_dwordx4 a[124:127], v[6:7], off offset:3584 nt
  v_lshl_add_u64 v[6:7], v[6:7], 0, s[98:99]
  v_dot2_f32_bf16 v20, v182, v18, v20
  v_dot2_f32_bf16 v21, v186, v18, v21
  v_dot2_f32_bf16 v22, v190, v18, v22
  v_dot2_f32_bf16 v23, v98, v18, v23
  s_waitcnt vmcnt(9)
  s_cmp_ge_i32 s101, 7
  s_cbranch_scc1 L_b206
  s_waitcnt vmcnt(8)
  s_cmp_ge_i32 s101, 4
  s_cbranch_scc1 L_b206
  s_waitcnt vmcnt(6)
L_b206:
  buffer_load_dwordx4 v[136:139], v2, s[8:11], s48 offen offset:1024 nt
  v_dot2_f32_bf16 v20, v183, v19, v20
  v_dot2_f32_bf16 v21, v187, v19, v21
  v_dot2_f32_bf16 v22, v191, v19, v22
  v_dot2_f32_bf16 v23, v99, v19, v23
  s_waitcnt vmcnt(9)
  s_cmp_ge_i32 s101, 8
  s_cbranch_scc1 L_b207
  s_waitcnt vmcnt(7)
  s_cmp_ge_i32 s101, 5
  s_cbranch_scc1 L_b207
  s_waitcnt vmcnt(6)
L_b207:
  buffer_load_dwordx4 v[140:143], v2, s[8:11], s48 offen offset:2048 nt
  v_add_f32_dpp v20, v20, v20 row_ror:8 row_mask:0xf bank_mask:0x3
  v_add_f32_dpp v21, v21, v21 row_ror:8 row_mask:0xf bank_mask:0x3
  v_add_f32_dpp v20, v22, v22 row_ror:8 row_mask:0xf bank_mask:0xc
  v_add_f32_dpp v21, v23, v23 row_ror:8 row_mask:0xf bank_mask:0xc
  s_nop 0
  v_add_f32_dpp v26, v20, v20 row_half_mirror row_mask:0xf bank_mask:0x5
  v_add_f32_dpp v26, v21, v21 row_half_mirror row_mask:0xf bank_mask:0xa
  v_dot2_f32_bf16 v20, v100, v16, 0
  v_dot2_f32_bf16 v21, v104, v16, 0
  v_dot2_f32_bf16 v22, v108, v16, 0
  v_dot2_f32_bf16 v23, v112, v16, 0
  s_waitcnt vmcnt(8)
  s_memrealtime s[80:81]
L_blk13:
  s_cmp_ge_i32 s101, 6
  s_cbranch_scc1 L_b208
  s_waitcnt vmcnt(7)
  s_cmp_ge_i32 s101, 1
  s_cbranch_scc1 L_b208
  s_waitcnt vmcnt(6)
L_b208:
  buffer_load_dwordx4 v[144:147], v2, s[8:11], s48 offen offset:3072 nt
  s_or_b32 s48, s48, 40960
  s_add_u32 s48, s48, 4096
  s_and_b32 s48, s48, 1003520
  s_mov_b32 s49, 0
  buffer_load_dwordx4 v[192:195], v5, s[24:27], s49 offen offset:0 nt
  v_dot2_f32_bf16 v20, v101, v17, v20
  v_dot2_f32_bf16 v21, v105, v17, v21
  v_dot2_f32_bf16 v22, v109, v17, v22
  v_dot2_f32_bf16 v23, v113, v17, v23
  v_dot2_f32_bf16 v20, v102, v18, v20
  v_dot2_f32_bf16 v21, v106, v18, v21
  v_dot2_f32_bf16 v22, v110, v18, v22
  v_dot2_f32_bf16 v23, v114, v18, v23
  s_waitcnt vmcnt(9)
  s_cmp_ge_i32 s101, 8
  s_cbranch_scc1 L_b209
  s_waitcnt vmcnt(8)
  s_cmp_ge_i32 s101, 5
  s_cbranch_scc1 L_b209
  s_waitcnt vmcnt(6)
L_b209:
  buffer_load_dwordx4 v[148:151], v2, s[8:11], s48 offen offset:0 nt
  v_dot2_f32_bf16 v20, v103, v19, v20
  v_dot2_f32_bf16 v21, v107, v19, v21
  v_dot2_f32_bf16 v22, v111, v19, v22
  v_dot2_f32_bf16 v23, v115, v19, v23
  v_add_f32_dpp v20, v20, v20 row_ror:8 row_mask:0xf bank_mask:0x3
  v_add_f32_dpp v21, v21, v21 row_ror:8 row_mask:0xf bank_mask:0x3
  v_add_f32_dpp v20, v22, v22 row_ror:8 row_mask:0xf bank_mask:0xc
  v_add_f32_dpp v21, v23, v23 row_ror:8 row_mask:0xf bank_mask:0xc
  s_nop 0
  v_add_f32_dpp v27, v20, v20 row_half_mirror row_mask:0xf bank_mask:0x5
  v_add_f32_dpp v27, v21, v21 row_half_mirror row_mask:0xf bank_mask:0xa
  s_waitcnt vmcnt(9)
  s_waitcnt lgkmcnt(0)
  s_sub_u32 s101, s80, s84
  s_sub_i32 s101, s101, 3162
  s_mul_i32 s101, s101, 2184
  s_ashr_i32 s101, s101, 16
  s_cmp_ge_i32 s101, 7
  s_cbranch_scc1 L_b210
  s_waitcnt vmcnt(7)
  s_cmp_ge_i32 s101, 4
  s_cbranch_scc1 L_b210
  s_waitcnt vmcnt(6)
L_b210:
  buffer_load_dwordx4 v[152:155], v2, s[8:11], s48 offen offset:1024 nt
  v_add_f32_dpp v24, v24, v24 quad_perm:[1,0,3,2] row_mask:0xf bank_mask:0xf
  v_add_f32_dpp v25, v25, v25 quad_perm:[1,0,3,2] row_mask:0xf bank_mask:0xf
  v_add_f32_dpp v26, v26, v26 quad_perm:[1,0,3,2] row_mask:0xf bank_mask:0xf
  v_add_f32_dpp v27, v27, v27 quad_perm:[1,0,3,2] row_mask:0xf bank_mask:0xf
  v_cndmask_b32 v24, v24, v25, s[52:53]
  v_cndmask_b32 v26, v26, v27, s[52:53]
  s_nop 0
  v_add_f32_dpp v24, v24, v24 quad_perm:[2,3,0,1] row_mask:0xf bank_mask:0xf
  v_add_f32_dpp v26, v26, v26 quad_perm:[2,3,0,1] row_mask:0xf bank_mask:0xf
  v_cndmask_b32 v40, v24, v26, s[54:55]
  s_waitcnt vmcnt(8)
  s_mov_b32 s82, L_blk16-L_pc
  s_load_dword s83, s[78:79], s82 offset:0
  s_load_dword s83, s[78:79], s82 offset:512
  s_load_dword s83, s[78:79], s82 offset:1024
  s_load_dword s83, s[78:79], s82 offset:1536
  s_cmp_ge_i32 s101, 8
  s_cbranch_scc1 L_b211
  s_waitcnt vmcnt(7)
  s_cmp_ge_i32 s101, 5
  s_cbranch_scc1 L_b211
  s_waitcnt vmcnt(5)
L_b211:
  buffer_load_dwordx4 v[156:159], v2, s[8:11], s48 offen offset:2048 nt
  s_mov_b32 s49, 0
  buffer_load_dwordx4 v[196:199], v5, s[24:27], s49 offen offset:1024 nt
  v_cvt_pk_bf16_f32 v40, v40, v40
  v_and_b32 v40, 0xffff0000, v40
  v_mul_f32 v40, s44, v40
  v_cvt_pk_bf16_f32 v40, v40, v40
  v_and_b32 v40, 0xffff0000, v40
  v_max_f32 v15, v15, v40
  v_dot2_f32_bf16 v20, v116, v16, 0
  v_dot2_f32_bf16 v21, v120, v16, 0
  v_dot2_f32_bf16 v22, v124, v16, 0
  v_dot2_f32_bf16 v23, v128, v16, 0
  s_waitcnt vmcnt(9)
  s_cmp_ge_i32 s101, 6
  s_cbranch_scc1 L_b212
  s_waitcnt vmcnt(7)
  s_cmp_ge_i32 s101, 3
  s_cbranch_scc1 L_b212
  s_waitcnt vmcnt(6)
L_b212:
  buffer_load_dwordx4 v[160:163], v2, s[8:11], s48 offen offset:3072 nt
  s_or_b32 s48, s48, 40960
  s_add_u32 s48, s48, 4096
  s_and_b32 s48, s48, 1003520
  v_dot2_f32_bf16 v20, v117, v17, v20
  v_dot2_f32_bf16 v21, v121, v17, v21
  v_dot2_f32_bf16 v22, v125, v17, v22
  v_dot2_f32_bf16 v23, v129, v17, v23
  s_waitcnt vmcnt(8)
  s_cmp_ge_i32 s101, 8
  s_cbranch_scc1 L_b213
  s_waitcnt vmcnt(7)
  s_cmp_ge_i32 s101, 5
  s_cbranch_scc1 L_b213
  s_waitcnt vmcnt(6)
L_b213:
  buffer_load_dwordx4 v[164:167], v2, s[8:11], s48 offen offset:0 nt
  s_mov_b32 s49, 0
  buffer_load_dwordx4 v[200:203], v5, s[24:27], s49 offen offset:2048 nt
  v_dot2_f32_bf16 v20, v118, v18, v20
  v_dot2_f32_bf16 v21, v122, v18, v21
  v_dot2_f32_bf16 v22, v126, v18, v22
  v_dot2_f32_bf16 v23, v130, v18, v23
  s_waitcnt vmcnt(9)
  s_cmp_ge_i32 s101, 7
  s_cbranch_scc1 L_b214
  s_waitcnt vmcnt(8)
  s_cmp_ge_i32 s101, 4
  s_cbranch_scc1 L_b214
  s_waitcnt vmcnt(6)
L_b214:
  buffer_load_dwordx4 v[168:171], v2, s[8:11], s48 offen offset:1024 nt
  v_dot2_f32_bf16 v20, v119, v19, v20
  v_dot2_f32_bf16 v21, v123, v19, v21
  v_dot2_f32_bf16 v22, v127, v19, v22
  v_dot2_f32_bf16 v23, v131, v19, v23
  s_waitcnt vmcnt(9)
  s_cmp_ge_i32 s101, 8
  s_cbranch_scc1 L_b215
  s_waitcnt vmcnt(7)
  s_cmp_ge_i32 s101, 5
  s_cbranch_scc1 L_b215
  s_waitcnt vmcnt(6)
L_b215:
  buffer_load_dwordx4 v[172:175], v2, s[8:11], s48 offen offset:2048 nt
  v_add_f32_dpp v20, v20, v20 row_ror:8 row_mask:0xf bank_mask:0x3
  v_add_f32_dpp v21, v21, v21 row_ror:8 row_mask:0xf bank_mask:0x3
  v_add_f32_dpp v20, v22, v22 row_ror:8 row_mask:0xf bank_mask:0xc
  v_add_f32_dpp v21, v23, v23 row_ror:8 row_mask:0xf bank_mask:0xc
  s_nop 0
  v_add_f32_dpp v24, v20, v20 row_half_mirror row_mask:0xf bank_mask:0x5
  v_add_f32_dpp v24, v21, v21 row_half_mirror row_mask:0xf bank_mask:0xa
  v_dot2_f32_bf16 v20, v132, v16, 0
  v_dot2_f32_bf16 v21, v136, v16, 0
  v_dot2_f32_bf16 v22, v140, v16, 0
  v_dot2_f32_bf16 v23, v144, v16, 0
  s_waitcnt vmcnt(8)
  s_cmp_ge_i32 s101, 6
  s_cbranch_scc1 L_b216
  s_waitcnt vmcnt(7)
  s_cmp_ge_i32 s101, 2
  s_cbranch_scc1 L_b216
  s_waitcnt vmcnt(6)
L_b216:
  buffer_load_dwordx4 v[176:179], v2, s[8:11], s48 offen offset:3072 nt
  s_or_b32 s48, s48, 40960
  s_add_u32 s48, s48, 4096
  s_and_b32 s48, s48, 1003520
  s_mov_b32 s49, 0
  buffer_load_dwordx4 v[204:207], v5, s[24:27], s49 offen offset:3072 nt
  v_dot2_f32_bf16 v20, v133, v17, v20
  v_dot2_f32_bf16 v21, v137, v17, v21
  v_dot2_f32_bf16 v22, v141, v17, v22
  v_dot2_f32_bf16 v23, v145, v17, v23
  s_waitcnt vmcnt(9)
  s_cmp_ge_i32 s101, 8
  s_cbranch_scc1 L_b217
  s_waitcnt vmcnt(8)
  s_cmp_ge_i32 s101, 5
  s_cbranch_scc1 L_b217
  s_waitcnt vmcnt(6)
L_b217:
  buffer_load_dwordx4 v[180:183], v0, s[8:11], s48 offen offset:0 nt
  v_dot2_f32_bf16 v20, v134, v18, v20
  v_dot2_f32_bf16 v21, v138, v18, v21
  v_dot2_f32_bf16 v22, v142, v18, v22
  v_dot2_f32_bf16 v23, v146, v18, v23
  s_waitcnt vmcnt(9)
  s_cmp_ge_i32 s101, 7
  s_cbranch_scc1 L_b218
  s_waitcnt vmcnt(7)
  s_cmp_ge_i32 s101, 4
  s_cbranch_scc1 L_b218
  s_waitcnt vmcnt(6)
L_b218:
  buffer_load_dwordx4 v[184:187], v0, s[8:11], s48 offen offset:1024 nt
  s_mov_b32 s49, 4096
  buffer_load_dwordx4 v[208:211], v5, s[24:27], s49 offen offset:0 nt
  v_dot2_f32_bf16 v20, v135, v19, v20
  v_dot2_f32_bf16 v21, v139, v19, v21
  v_dot2_f32_bf16 v22, v143, v19, v22
  v_dot2_f32_bf16 v23, v147, v19, v23
  s_waitcnt vmcnt(9)
  s_cmp_ge_i32 s101, 8
  s_cbranch_scc1 L_b219
  s_waitcnt vmcnt(8)
  s_cmp_ge_i32 s101, 5
  s_cbranch_scc1 L_b219
  s_waitcnt vmcnt(6)
L_b219:
  buffer_load_dwordx4 v[188:191], v0, s[8:11], s48 offen offset:2048 nt
  v_add_f32_dpp v20, v20, v20 row_ror:8 row_mask:0xf bank_mask:0x3
  v_add_f32_dpp v21, v21, v21 row_ror:8 row_mask:0xf bank_mask:0x3
  v_add_f32_dpp v20, v22, v22 row_ror:8 row_mask:0xf bank_mask:0xc
  v_add_f32_dpp v21, v23, v23 row_ror:8 row_mask:0xf bank_mask:0xc
  s_nop 0
  v_add_f32_dpp v25, v20, v20 row_half_mirror row_mask:0xf bank_mask:0x5
  v_add_f32_dpp v25, v21, v21 row_half_mirror row_mask:0xf bank_mask:0xa
  v_dot2_f32_bf16 v20, v148, v16, 0
  v_dot2_f32_bf16 v21, v152, v16, 0
  v_dot2_f32_bf16 v22, v156, v16, 0
  v_dot2_f32_bf16 v23, v160, v16, 0
  s_waitcnt vmcnt(9)
  s_cmp_ge_i32 s101, 6
  s_cbranch_scc1 L_b220
  s_waitcnt vmcnt(7)
  s_cmp_ge_i32 s101, 3
  s_cbranch_scc1 L_b220
  s_waitcnt vmcnt(6)
L_b220:
  buffer_load_dwordx4 v[96:99], v0, s[8:11], s48 offen offset:3072 nt
  s_or_b32 s48, s48, 40960
  s_add_u32 s48, s48, 4096
  s_and_b32 s48, s48, 1003520
  v_dot2_f32_bf16 v20, v149, v17, v20
  v_dot2_f32_bf16 v21, v153, v17, v21
  v_dot2_f32_bf16 v22, v157, v17, v22
  v_dot2_f32_bf16 v23, v161, v17, v23
  s_waitcnt vmcnt(8)
  s_cmp_ge_i32 s101, 8
  s_cbranch_scc1 L_b221
  s_waitcnt vmcnt(7)
  s_cmp_ge_i32 s101, 5
  s_cbranch_scc1 L_b221
  s_waitcnt vmcnt(6)
L_b221:
  buffer_load_dwordx4 v[100:103], v0, s[8:11], s48 offen offset:0 nt
  s_mov_b32 s49, 4096
  buffer_load_dwordx4 v[212:215], v5, s[24:27], s49 offen offset:1024 nt
  v_dot2_f32_bf16 v20, v150, v18, v20
  v_dot2_f32_bf16 v21, v154, v18, v21
  v_dot2_f32_bf16 v22, v158, v18, v22
  v_dot2_f32_bf16 v23, v162, v18, v23
  s_waitcnt vmcnt(9)
  s_cmp_ge_i32 s101, 7
  s_cbranch_scc1 L_b222
  s_waitcnt vmcnt(8)
  s_cmp_ge_i32 s101, 4
  s_cbranch_scc1 L_b222
  s_waitcnt vmcnt(6)
L_b222:
  buffer_load_dwordx4 v[104:107], v0, s[8:11], s48 offen offset:1024 nt
  v_dot2_f32_bf16 v20, v151, v19, v20
  v_dot2_f32_bf16 v21, v155, v19, v21
  v_dot2_f32_bf16 v22, v159, v19, v22
  v_dot2_f32_bf16 v23, v163, v19, v23
  s_waitcnt vmcnt(9)
  s_cmp_ge_i32 s101, 8
  s_cbranch_scc1 L_b223
  s_waitcnt vmcnt(7)
  s_cmp_ge_i32 s101, 5
  s_cbranch_scc1 L_b223
  s_waitcnt vmcnt(6)
L_b223:
  buffer_load_dwordx4 v[108:111], v0, s[8:11], s48 offen offset:2048 nt
  v_add_f32_dpp v20, v20, v20 row_ror:8 row_mask:0xf bank_mask:0x3
  v_add_f32_dpp v21, v21, v21 row_ror:8 row_mask:0xf bank_mask:0x3
  v_add_f32_dpp v20, v22, v22 row_ror:8 row_mask:0xf bank_mask:0xc
  v_add_f32_dpp v21, v23, v23 row_ror:8 row_mask:0xf bank_mask:0xc
  s_nop 0
  v_add_f32_dpp v26, v20, v20 row_half_mirror row_mask:0xf bank_mask:0x5
  v_add_f32_dpp v26, v21, v21 row_half_mirror row_mask:0xf bank_mask:0xa
  v_dot2_f32_bf16 v20, v164, v16, 0
  v_dot2_f32_bf16 v21, v168, v16, 0
  v_dot2_f32_bf16 v22, v172, v16, 0
  v_dot2_f32_bf16 v23, v176, v16, 0
  s_waitcnt vmcnt(8)
  s_memrealtime s[80:81]
L_blk14:
  s_cmp_ge_i32 s101, 6
  s_cbranch_scc1 L_b224
  s_waitcnt vmcnt(7)
  s_cmp_ge_i32 s101, 1
  s_cbranch_scc1 L_b224
  s_waitcnt vmcnt(5)
L_b224:
  buffer_load_dwordx4 v[112:115], v0, s[8:11], s48 offen offset:3072 nt
  s_or_b32 s48, s48, 40960
  s_add_u32 s48, s48, 4096
  s_and_b32 s48, s48, 1003520
  s_mov_b32 s49, 4096
  buffer_load_dwordx4 v[216:219], v5, s[24:27], s49 offen offset:2048 nt
  v_dot2_f32_bf16 v20, v165, v17, v20
  v_dot2_f32_bf16 v21, v169, v17, v21
  v_dot2_f32_bf16 v22, v173, v17, v22
  v_dot2_f32_bf16 v23, v177, v17, v23
  v_dot2_f32_bf16 v20, v166, v18, v20
  v_dot2_f32_bf16 v21, v170, v18, v21
  v_dot2_f32_bf16 v22, v174, v18, v22
  v_dot2_f32_bf16 v23, v178, v18, v23
  s_waitcnt vmcnt(9)
  s_cmp_ge_i32 s101, 8
  s_cbranch_scc1 L_b225
  s_waitcnt vmcnt(7)
  s_cmp_ge_i32 s101, 5
  s_cbranch_scc1 L_b225
  s_waitcnt vmcnt(6)
L_b225:
  buffer_load_dwordx4 v[116:119], v0, s[8:11], s48 offen offset:0 nt
  v_dot2_f32_bf16 v20, v167, v19, v20
  v_dot2_f32_bf16 v21, v171, v19, v21
  v_dot2_f32_bf16 v22, v175, v19, v22
  v_dot2_f32_bf16 v23, v179, v19, v23
  v_add_f32_dpp v20, v20, v20 row_ror:8 row_mask:0xf bank_mask:0x3
  v_add_f32_dpp v21, v21, v21 row_ror:8 row_mask:0xf bank_mask:0x3
  v_add_f32_dpp v20, v22, v22 row_ror:8 row_mask:0xf bank_mask:0xc
  v_add_f32_dpp v21, v23, v23 row_ror:8 row_mask:0xf bank_mask:0xc
  s_nop 0
  v_add_f32_dpp v27, v20, v20 row_half_mirror row_mask:0xf bank_mask:0x5
  v_add_f32_dpp v27, v21, v21 row_half_mirror row_mask:0xf bank_mask:0xa
  s_waitcnt vmcnt(8)
  s_waitcnt lgkmcnt(0)
  s_sub_u32 s101, s80, s84
  s_sub_i32 s101, s101, 3390
  s_mul_i32 s101, s101, 2184
  s_ashr_i32 s101, s101, 16
  s_cmp_ge_i32 s101, 7
  s_cbranch_scc1 L_b226
  s_waitcnt vmcnt(7)
  s_cmp_ge_i32 s101, 4
  s_cbranch_scc1 L_b226
  s_waitcnt vmcnt(6)
L_b226:
  buffer_load_dwordx4 v[120:123], v0, s[8:11], s48 offen offset:1024 nt
  s_mov_b32 s49, 4096
  buffer_load_dwordx4 v[220:223], v5, s[24:27], s49 offen offset:3072 nt
  v_add_f32_dpp v24, v24, v24 quad_perm:[1,0,3,2] row_mask:0xf bank_mask:0xf
  v_add_f32_dpp v25, v25, v25 quad_perm:[1,0,3,2] row_mask:0xf bank_mask:0xf
  v_add_f32_dpp v26, v26, v26 quad_perm:[1,0,3,2] row_mask:0xf bank_mask:0xf
  v_add_f32_dpp v27, v27, v27 quad_perm:[1,0,3,2] row_mask:0xf bank_mask:0xf
  v_cndmask_b32 v24, v24, v25, s[52:53]
  v_cndmask_b32 v26, v26, v27, s[52:53]
  s_nop 0
  v_add_f32_dpp v24, v24, v24 quad_perm:[2,3,0,1] row_mask:0xf bank_mask:0xf
  v_add_f32_dpp v26, v26, v26 quad_perm:[2,3,0,1] row_mask:0xf bank_mask:0xf
  v_cndmask_b32 v41, v24, v26, s[54:55]
  s_waitcnt vmcnt(9)
  s_mov_b32 s82, L_blk17-L_pc
  s_load_dword s83, s[78:79], s82 offset:0
  s_load_dword s83, s[78:79], s82 offset:512
  s_load_dword s83, s[78:79], s82 offset:1024
  s_cmp_ge_i32 s101, 8
  s_cbranch_scc1 L_b227
  s_waitcnt vmcnt(8)
  s_cmp_ge_i32 s101, 5
  s_cbranch_scc1 L_b227
  s_waitcnt vmcnt(6)
L_b227:
  buffer_load_dwordx4 v[124:127], v0, s[8:11], s48 offen offset:2048 nt
  v_cvt_pk_bf16_f32 v41, v41, v41
  v_and_b32 v41, 0xffff0000, v41
  v_mul_f32 v41, s44, v41
  v_cvt_pk_bf16_f32 v41, v41, v41
  v_and_b32 v41, 0xffff0000, v41
  v_max_f32 v15, v15, v41
  v_dot2_f32_bf16 v20, v180, v16, 0
  v_dot2_f32_bf16 v21, v184, v16, 0
  v_dot2_f32_bf16 v22, v188, v16, 0
  v_dot2_f32_bf16 v23, v96, v16, 0
  s_waitcnt vmcnt(9)
  s_cmp_ge_i32 s101, 6
  s_cbranch_scc1 L_b228
  s_waitcnt vmcnt(7)
  s_cmp_ge_i32 s101, 3
  s_cbranch_scc1 L_b228
  s_waitcnt vmcnt(6)
L_b228:
  buffer_load_dwordx4 v[128:131], v0, s[8:11], s48 offen offset:3072 nt
  s_or_b32 s48, s48, 40960
  s_add_u32 s48, s48, 4096
  s_and_b32 s48, s48, 1003520
  v_dot2_f32_bf16 v20, v181, v17, v20
  v_dot2_f32_bf16 v21, v185, v17, v21
  v_dot2_f32_bf16 v22, v189, v17, v22
  v_dot2_f32_bf16 v23, v97, v17, v23
  s_waitcnt vmcnt(8)
  s_cmp_ge_i32 s101, 8
  s_cbranch_scc1 L_b229
  s_waitcnt vmcnt(7)
  s_cmp_ge_i32 s101, 5
  s_cbranch_scc1 L_b229
  s_waitcnt vmcnt(6)
L_b229:
  buffer_load_dwordx4 v[132:135], v0, s[8:11], s48 offen offset:0 nt
  s_mov_b32 s49, 8192
  buffer_load_dwordx4 v[224:227], v5, s[24:27], s49 offen offset:0 nt
  v_dot2_f32_bf16 v20, v182, v18, v20
  v_dot2_f32_bf16 v21, v186, v18, v21
  v_dot2_f32_bf16 v22, v190, v18, v22
  v_dot2_f32_bf16 v23, v98, v18, v23
  s_waitcnt vmcnt(9)
  s_cmp_ge_i32 s101, 7
  s_cbranch_scc1 L_b230
  s_waitcnt vmcnt(8)
  s_cmp_ge_i32 s101, 4
  s_cbranch_scc1 L_b230
  s_waitcnt vmcnt(6)
L_b230:
  buffer_load_dwordx4 v[136:139], v0, s[8:11], s48 offen offset:1024 nt
  v_dot2_f32_bf16 v20, v183, v19, v20
  v_dot2_f32_bf16 v21, v187, v19, v21
  v_dot2_f32_bf16 v22, v191, v19, v22
  v_dot2_f32_bf16 v23, v99, v19, v23
  s_waitcnt vmcnt(9)
  s_cmp_ge_i32 s101, 8
  s_cbranch_scc1 L_b231
  s_waitcnt vmcnt(7)
  s_cmp_ge_i32 s101, 5
  s_cbranch_scc1 L_b231
  s_waitcnt vmcnt(6)
L_b231:
  buffer_load_dwordx4 v[140:143], v0, s[8:11], s48 offen offset:2048 nt
  s_mov_b32 s49, 8192
  buffer_load_dwordx4 v[228:231], v5, s[24:27], s49 offen offset:1024 nt
  v_add_f32_dpp v20, v20, v20 row_ror:8 row_mask:0xf bank_mask:0x3
  v_add_f32_dpp v21, v21, v21 row_ror:8 row_mask:0xf bank_mask:0x3
  v_add_f32_dpp v20, v22, v22 row_ror:8 row_mask:0xf bank_mask:0xc
  v_add_f32_dpp v21, v23, v23 row_ror:8 row_mask:0xf bank_mask:0xc
  s_nop 0
  v_add_f32_dpp v24, v20, v20 row_half_mirror row_mask:0xf bank_mask:0x5
  v_add_f32_dpp v24, v21, v21 row_half_mirror row_mask:0xf bank_mask:0xa
  v_dot2_f32_bf16 v20, v100, v16, 0
  v_dot2_f32_bf16 v21, v104, v16, 0
  v_dot2_f32_bf16 v22, v108, v16, 0
  v_dot2_f32_bf16 v23, v112, v16, 0
  s_waitcnt vmcnt(9)
  s_cmp_ge_i32 s101, 6
  s_cbranch_scc1 L_b232
  s_waitcnt vmcnt(8)
  s_cmp_ge_i32 s101, 2
  s_cbranch_scc1 L_b232
  s_waitcnt vmcnt(6)
L_b232:
  buffer_load_dwordx4 v[144:147], v0, s[8:11], s48 offen offset:3072 nt
  s_or_b32 s48, s48, 40960
  s_add_u32 s48, s48, 4096
  s_and_b32 s48, s48, 1003520
  v_dot2_f32_bf16 v20, v101, v17, v20
  v_dot2_f32_bf16 v21, v105, v17, v21
  v_dot2_f32_bf16 v22, v109, v17, v22
  v_dot2_f32_bf16 v23, v113, v17, v23
  s_waitcnt vmcnt(9)
  s_cmp_ge_i32 s101, 8
  s_cbranch_scc1 L_b233
  s_waitcnt vmcnt(7)
  s_cmp_ge_i32 s101, 5
  s_cbranch_scc1 L_b233
  s_waitcnt vmcnt(6)
L_b233:
  buffer_load_dwordx4 v[148:151], v0, s[8:11], s48 offen offset:0 nt
  v_dot2_f32_bf16 v20, v102, v18, v20
  v_dot2_f32_bf16 v21, v106, v18, v21
  v_dot2_f32_bf16 v22, v110, v18, v22
  v_dot2_f32_bf16 v23, v114, v18, v23
  s_waitcnt vmcnt(8)
  s_cmp_ge_i32 s101, 7
  s_cbranch_scc1 L_b234
  s_waitcnt vmcnt(7)
  s_cmp_ge_i32 s101, 4
  s_cbranch_scc1 L_b234
  s_waitcnt vmcnt(6)
L_b234:
  buffer_load_dwordx4 v[152:155], v0, s[8:11], s48 offen offset:1024 nt
  s_mov_b32 s49, 8192
  buffer_load_dwordx4 v[232:235], v5, s[24:27], s49 offen offset:2048 nt
  v_dot2_f32_bf16 v20, v103, v19, v20
  v_dot2_f32_bf16 v21, v107, v19, v21
  v_dot2_f32_bf16 v22, v111, v19, v22
  v_dot2_f32_bf16 v23, v115, v19, v23
  s_waitcnt vmcnt(9)
  s_cmp_ge_i32 s101, 8
  s_cbranch_scc1 L_b235
  s_waitcnt vmcnt(8)
  s_cmp_ge_i32 s101, 5
  s_cbranch_scc1 L_b235
  s_waitcnt vmcnt(6)
L_b235:
  buffer_load_dwordx4 v[156:159], v0, s[8:11], s48 offen offset:2048 nt
  v_add_f32_dpp v20, v20, v20 row_ror:8 row_mask:0xf bank_mask:0x3
  v_add_f32_dpp v21, v21, v21 row_ror:8 row_mask:0xf bank_mask:0x3
  v_add_f32_dpp v20, v22, v22 row_ror:8 row_mask:0xf bank_mask:0xc
  v_add_f32_dpp v21, v23, v23 row_ror:8 row_mask:0xf bank_mask:0xc
  s_nop 0
  v_add_f32_dpp v25, v20, v20 row_half_mirror row_mask:0xf bank_mask:0x5
  v_add_f32_dpp v25, v21, v21 row_half_mirror row_mask:0xf bank_mask:0xa
  v_dot2_f32_bf16 v20, v116, v16, 0
  v_dot2_f32_bf16 v21, v120, v16, 0
  v_dot2_f32_bf16 v22, v124, v16, 0
  v_dot2_f32_bf16 v23, v128, v16, 0
  s_waitcnt vmcnt(9)
  s_cmp_ge_i32 s101, 6
  s_cbranch_scc1 L_b236
  s_waitcnt vmcnt(7)
  s_cmp_ge_i32 s101, 3
  s_cbranch_scc1 L_b236
  s_waitcnt vmcnt(6)
L_b236:
  buffer_load_dwordx4 v[160:163], v0, s[8:11], s48 offen offset:3072 nt
  s_or_b32 s48, s48, 40960
  s_add_u32 s48, s48, 4096
  s_and_b32 s48, s48, 1003520
  v_dot2_f32_bf16 v20, v117, v17, v20
  v_dot2_f32_bf16 v21, v121, v17, v21
  v_dot2_f32_bf16 v22, v125, v17, v22
  v_dot2_f32_bf16 v23, v129, v17, v23
  s_waitcnt vmcnt(8)
  s_cmp_ge_i32 s101, 8
  s_cbranch_scc1 L_b237
  s_waitcnt vmcnt(7)
  s_cmp_ge_i32 s101, 5
  s_cbranch_scc1 L_b237
  s_waitcnt vmcnt(5)
L_b237:
  buffer_load_dwordx4 v[164:167], v0, s[8:11], s48 offen offset:0 nt
  s_mov_b32 s49, 8192
  buffer_load_dwordx4 v[236:239], v5, s[24:27], s49 offen offset:3072 nt
  v_dot2_f32_bf16 v20, v118, v18, v20
  v_dot2_f32_bf16 v21, v122, v18, v21
  v_dot2_f32_bf16 v22, v126, v18, v22
  v_dot2_f32_bf16 v23, v130, v18, v23
  s_waitcnt vmcnt(9)
  s_cmp_ge_i32 s101, 7
  s_cbranch_scc1 L_b238
  s_waitcnt vmcnt(7)
  s_cmp_ge_i32 s101, 4
  s_cbranch_scc1 L_b238
  s_waitcnt vmcnt(6)
L_b238:
  buffer_load_dwordx4 v[168:171], v0, s[8:11], s48 offen offset:1024 nt
  v_dot2_f32_bf16 v20, v119, v19, v20
  v_dot2_f32_bf16 v21, v123, v19, v21
  v_dot2_f32_bf16 v22, v127, v19, v22
  v_dot2_f32_bf16 v23, v131, v19, v23
  s_waitcnt vmcnt(8)
  s_cmp_ge_i32 s101, 8
  s_cbranch_scc1 L_b239
  s_waitcnt vmcnt(7)
  s_cmp_ge_i32 s101, 5
  s_cbranch_scc1 L_b239
  s_waitcnt vmcnt(6)
L_b239:
  buffer_load_dwordx4 v[172:175], v0, s[8:11], s48 offen offset:2048 nt
  s_mov_b32 s49, 12288
  buffer_load_dwordx4 v[240:243], v5, s[24:27], s49 offen offset:0 nt
  v_add_f32_dpp v20, v20, v20 row_ror:8 row_mask:0xf bank_mask:0x3
  v_add_f32_dpp v21, v21, v21 row_ror:8 row_mask:0xf bank_mask:0x3
  v_add_f32_dpp v20, v22, v22 row_ror:8 row_mask:0xf bank_mask:0xc
  v_add_f32_dpp v21, v23, v23 row_ror:8 row_mask:0xf bank_mask:0xc
  s_nop 0
  v_add_f32_dpp v26, v20, v20 row_half_mirror row_mask:0xf bank_mask:0x5
  v_add_f32_dpp v26, v21, v21 row_half_mirror row_mask:0xf bank_mask:0xa
  v_dot2_f32_bf16 v20, v132, v16, 0
  v_dot2_f32_bf16 v21, v136, v16, 0
  v_dot2_f32_bf16 v22, v140, v16, 0
  v_dot2_f32_bf16 v23, v144, v16, 0
  s_waitcnt vmcnt(9)
  s_memrealtime s[80:81]
L_blk15:
  s_cmp_ge_i32 s101, 6
  s_cbranch_scc1 L_b240
  s_waitcnt vmcnt(8)
  s_cmp_ge_i32 s101, 1
  s_cbranch_scc1 L_b240
  s_waitcnt vmcnt(6)
L_b240:
  buffer_load_dwordx4 v[176:179], v0, s[8:11], s48 offen offset:3072 nt
  s_or_b32 s48, s48, 40960
  s_add_u32 s48, s48, 4096
  s_and_b32 s48, s48, 1003520
  v_dot2_f32_bf16 v20, v133, v17, v20
  v_dot2_f32_bf16 v21, v137, v17, v21
  v_dot2_f32_bf16 v22, v141, v17, v22
  v_dot2_f32_bf16 v23, v145, v17, v23
  v_dot2_f32_bf16 v20, v134, v18, v20
  v_dot2_f32_bf16 v21, v138, v18, v21
  v_dot2_f32_bf16 v22, v142, v18, v22
  v_dot2_f32_bf16 v23, v146, v18, v23
  s_waitcnt vmcnt(9)
  s_cmp_ge_i32 s101, 8
  s_cbranch_scc1 L_b241
  s_waitcnt vmcnt(7)
  s_cmp_ge_i32 s101, 5
  s_cbranch_scc1 L_b241
  s_waitcnt vmcnt(6)
L_b241:
  buffer_load_dwordx4 v[180:183], v0, s[8:11], s48 offen offset:0 nt
  v_dot2_f32_bf16 v20, v135, v19, v20
  v_dot2_f32_bf16 v21, v139, v19, v21
  v_dot2_f32_bf16 v22, v143, v19, v22
  v_dot2_f32_bf16 v23, v147, v19, v23
  v_add_f32_dpp v20, v20, v20 row_ror:8 row_mask:0xf bank_mask:0x3
  v_add_f32_dpp v21, v21, v21 row_ror:8 row_mask:0xf bank_mask:0x3
  v_add_f32_dpp v20, v22, v22 row_ror:8 row_mask:0xf bank_mask:0xc
  v_add_f32_dpp v21, v23, v23 row_ror:8 row_mask:0xf bank_mask:0xc
  s_nop 0
  v_add_f32_dpp v27, v20, v20 row_half_mirror row_mask:0xf bank_mask:0x5
  v_add_f32_dpp v27, v21, v21 row_half_mirror row_mask:0xf bank_mask:0xa
  s_waitcnt vmcnt(8)
  s_waitcnt lgkmcnt(0)
  s_sub_u32 s101, s80, s84
  s_sub_i32 s101, s101, 3620
  s_mul_i32 s101, s101, 2184
  s_ashr_i32 s101, s101, 16
  s_cmp_ge_i32 s101, 7
  s_cbranch_scc1 L_b242
  s_waitcnt vmcnt(7)
  s_cmp_ge_i32 s101, 4
  s_cbranch_scc1 L_b242
  s_waitcnt vmcnt(6)
L_b242:
  buffer_load_dwordx4 v[184:187], v0, s[8:11], s48 offen offset:1024 nt
  s_mov_b32 s49, 12288
  buffer_load_dwordx4 v[244:247], v5, s[24:27], s49 offen offset:1024 nt
  v_add_f32_dpp v24, v24, v24 quad_perm:[1,0,3,2] row_mask:0xf bank_mask:0xf
  v_add_f32_dpp v25, v25, v25 quad_perm:[1,0,3,2] row_mask:0xf bank_mask:0xf
  v_add_f32_dpp v26, v26, v26 quad_perm:[1,0,3,2] row_mask:0xf bank_mask:0xf
  v_add_f32_dpp v27, v27, v27 quad_perm:[1,0,3,2] row_mask:0xf bank_mask:0xf
  v_cndmask_b32 v24, v24, v25, s[52:53]
  v_cndmask_b32 v26, v26, v27, s[52:53]
  s_nop 0
  v_add_f32_dpp v24, v24, v24 quad_perm:[2,3,0,1] row_mask:0xf bank_mask:0xf
  v_add_f32_dpp v26, v26, v26 quad_perm:[2,3,0,1] row_mask:0xf bank_mask:0xf
  v_cndmask_b32 v42, v24, v26, s[54:55]
  s_waitcnt vmcnt(9)
  s_mov_b32 s82, L_blk18-L_pc
  s_load_dword s83, s[78:79], s82 offset:0
  s_load_dword s83, s[78:79], s82 offset:512
  s_load_dword s83, s[78:79], s82 offset:1024
  s_cmp_ge_i32 s101, 8
  s_cbranch_scc1 L_b243
  s_waitcnt vmcnt(8)
  s_cmp_ge_i32 s101, 5
  s_cbranch_scc1 L_b243
  s_waitcnt vmcnt(6)
L_b243:
  buffer_load_dwordx4 v[188:191], v0, s[8:11], s48 offen offset:2048 nt
  v_cvt_pk_bf16_f32 v42, v42, v42
  v_and_b32 v42, 0xffff0000, v42
  v_mul_f32 v42, s44, v42
  v_cvt_pk_bf16_f32 v42, v42, v42
  v_and_b32 v42, 0xffff0000, v42
  v_max_f32 v15, v15, v42
  v_dot2_f32_bf16 v20, v148, v16, 0
  v_dot2_f32_bf16 v21, v152, v16, 0
  v_dot2_f32_bf16 v22, v156, v16, 0
  v_dot2_f32_bf16 v23, v160, v16, 0
  s_waitcnt vmcnt(9)
  s_cmp_ge_i32 s101, 6
  s_cbranch_scc1 L_b244
  s_waitcnt vmcnt(7)
  s_cmp_ge_i32 s101, 3
  s_cbranch_scc1 L_b244
  s_waitcnt vmcnt(6)
L_b244:
  buffer_load_dwordx4 v[96:99], v0, s[8:11], s48 offen offset:3072 nt
  s_or_b32 s48, s48, 40960
  s_add_u32 s48, s48, 4096
  s_and_b32 s48, s48, 1003520
  s_mov_b32 s49, 12288
  buffer_load_dwordx4 v[248:251], v5, s[24:27], s49 offen offset:2048 nt
  v_dot2_f32_bf16 v20, v149, v17, v20
  v_dot2_f32_bf16 v21, v153, v17, v21
  v_dot2_f32_bf16 v22, v157, v17, v22
  v_dot2_f32_bf16 v23, v161, v17, v23
  s_waitcnt vmcnt(9)
  s_cmp_ge_i32 s101, 8
  s_cbranch_scc1 L_b245
  s_waitcnt vmcnt(8)
  s_cmp_ge_i32 s101, 5
  s_cbranch_scc1 L_b245
  s_waitcnt vmcnt(6)
L_b245:
  buffer_load_dwordx4 v[100:103], v0, s[8:11], s48 offen offset:0 nt
  v_dot2_f32_bf16 v20, v150, v18, v20
  v_dot2_f32_bf16 v21, v154, v18, v21
  v_dot2_f32_bf16 v22, v158, v18, v22
  v_dot2_f32_bf16 v23, v162, v18, v23
  s_waitcnt vmcnt(9)
  s_cmp_ge_i32 s101, 7
  s_cbranch_scc1 L_b246
  s_waitcnt vmcnt(7)
  s_cmp_ge_i32 s101, 4
  s_cbranch_scc1 L_b246
  s_waitcnt vmcnt(6)
L_b246:
  buffer_load_dwordx4 v[104:107], v0, s[8:11], s48 offen offset:1024 nt
  v_dot2_f32_bf16 v20, v151, v19, v20
  v_dot2_f32_bf16 v21, v155, v19, v21
  v_dot2_f32_bf16 v22, v159, v19, v22
  v_dot2_f32_bf16 v23, v163, v19, v23
  s_waitcnt vmcnt(8)
  s_cmp_ge_i32 s101, 8
  s_cbranch_scc1 L_b247
  s_waitcnt vmcnt(7)
  s_cmp_ge_i32 s101, 5
  s_cbranch_scc1 L_b247
  s_waitcnt vmcnt(6)
L_b247:
  buffer_load_dwordx4 v[108:111], v0, s[8:11], s48 offen offset:2048 nt
  s_mov_b32 s49, 12288
  buffer_load_dwordx4 v[252:255], v5, s[24:27], s49 offen offset:3072 nt
  v_add_f32_dpp v20, v20, v20 row_ror:8 row_mask:0xf bank_mask:0x3
  v_add_f32_dpp v21, v21, v21 row_ror:8 row_mask:0xf bank_mask:0x3
  v_add_f32_dpp v20, v22, v22 row_ror:8 row_mask:0xf bank_mask:0xc
  v_add_f32_dpp v21, v23, v23 row_ror:8 row_mask:0xf bank_mask:0xc
  s_nop 0
  v_add_f32_dpp v24, v20, v20 row_half_mirror row_mask:0xf bank_mask:0x5
  v_add_f32_dpp v24, v21, v21 row_half_mirror row_mask:0xf bank_mask:0xa
  v_dot2_f32_bf16 v20, v164, v16, 0
  v_dot2_f32_bf16 v21, v168, v16, 0
  v_dot2_f32_bf16 v22, v172, v16, 0
  v_dot2_f32_bf16 v23, v176, v16, 0
  s_waitcnt vmcnt(9)
  s_cmp_ge_i32 s101, 6
  s_cbranch_scc1 L_b248
  s_waitcnt vmcnt(8)
  s_cmp_ge_i32 s101, 2
  s_cbranch_scc1 L_b248
  s_waitcnt vmcnt(6)
L_b248:
  buffer_load_dwordx4 v[112:115], v0, s[8:11], s48 offen offset:3072 nt
  s_or_b32 s48, s48, 40960
  s_add_u32 s48, s48, 4096
  s_and_b32 s48, s48, 1003520
  v_dot2_f32_bf16 v20, v165, v17, v20
  v_dot2_f32_bf16 v21, v169, v17, v21
  v_dot2_f32_bf16 v22, v173, v17, v22
  v_dot2_f32_bf16 v23, v177, v17, v23
  s_waitcnt vmcnt(9)
  s_cmp_ge_i32 s101, 8
  s_cbranch_scc1 L_b249
  s_waitcnt vmcnt(7)
  s_cmp_ge_i32 s101, 5
  s_cbranch_scc1 L_b249
  s_waitcnt vmcnt(6)
L_b249:
  buffer_load_dwordx4 v[116:119], v2, s[12:15], s48 offen offset:0 nt
  v_dot2_f32_bf16 v20, v166, v18, v20
  v_dot2_f32_bf16 v21, v170, v18, v21
  v_dot2_f32_bf16 v22, v174, v18, v22
  v_dot2_f32_bf16 v23, v178, v18, v23
  s_waitcnt vmcnt(8)
  s_cmp_ge_i32 s101, 7
  s_cbranch_scc1 L_b250
  s_waitcnt vmcnt(7)
  s_cmp_ge_i32 s101, 4
  s_cbranch_scc1 L_b250
  s_waitcnt vmcnt(5)
L_b250:
  buffer_load_dwordx4 v[120:123], v2, s[12:15], s48 offen offset:1024 nt
  v_dot2_f32_bf16 v20, v167, v19, v20
  v_dot2_f32_bf16 v21, v171, v19, v21
  v_dot2_f32_bf16 v22, v175, v19, v22
  v_dot2_f32_bf16 v23, v179, v19, v23
  s_waitcnt vmcnt(8)
  s_cmp_ge_i32 s101, 8
  s_cbranch_scc1 L_b251
  s_waitcnt vmcnt(6)
  s_cmp_ge_i32 s101, 5
  s_cbranch_scc1 L_b251
  s_waitcnt vmcnt(5)
L_b251:
  buffer_load_dwordx4 v[124:127], v2, s[12:15], s48 offen offset:2048 nt
  v_add_f32_dpp v20, v20, v20 row_ror:8 row_mask:0xf bank_mask:0x3
  v_add_f32_dpp v21, v21, v21 row_ror:8 row_mask:0xf bank_mask:0x3
  v_add_f32_dpp v20, v22, v22 row_ror:8 row_mask:0xf bank_mask:0xc
  v_add_f32_dpp v21, v23, v23 row_ror:8 row_mask:0xf bank_mask:0xc
  s_nop 0
  v_add_f32_dpp v25, v20, v20 row_half_mirror row_mask:0xf bank_mask:0x5
  v_add_f32_dpp v25, v21, v21 row_half_mirror row_mask:0xf bank_mask:0xa
  v_dot2_f32_bf16 v20, v180, v16, 0
  v_dot2_f32_bf16 v21, v184, v16, 0
  v_dot2_f32_bf16 v22, v188, v16, 0
  v_dot2_f32_bf16 v23, v96, v16, 0
  s_waitcnt vmcnt(7)
  s_cmp_ge_i32 s101, 6
  s_cbranch_scc1 L_b252
  s_waitcnt vmcnt(6)
  s_cmp_ge_i32 s101, 3
  s_cbranch_scc1 L_b252
  s_waitcnt vmcnt(5)
L_b252:
  buffer_load_dwordx4 v[128:131], v2, s[12:15], s48 offen offset:3072 nt
  s_or_b32 s48, s48, 40960
  s_add_u32 s48, s48, 4096
  s_and_b32 s48, s48, 1003520
  v_dot2_f32_bf16 v20, v181, v17, v20
  v_dot2_f32_bf16 v21, v185, v17, v21
  v_dot2_f32_bf16 v22, v189, v17, v22
  v_dot2_f32_bf16 v23, v97, v17, v23
  s_waitcnt vmcnt(7)
  s_cmp_ge_i32 s101, 8
  s_cbranch_scc1 L_b253
  s_waitcnt vmcnt(6)
  s_cmp_ge_i32 s101, 5
  s_cbranch_scc1 L_b253
  s_waitcnt vmcnt(4)
L_b253:
  buffer_load_dwordx4 v[132:135], v2, s[12:15], s48 offen offset:0 nt
  v_dot2_f32_bf16 v20, v182, v18, v20
  v_dot2_f32_bf16 v21, v186, v18, v21
  v_dot2_f32_bf16 v22, v190, v18, v22
  v_dot2_f32_bf16 v23, v98, v18, v23
  s_waitcnt vmcnt(7)
  s_cmp_ge_i32 s101, 7
  s_cbranch_scc1 L_b254
  s_waitcnt vmcnt(5)
  s_cmp_ge_i32 s101, 4
  s_cbranch_scc1 L_b254
  s_waitcnt vmcnt(4)
L_b254:
  buffer_load_dwordx4 v[136:139], v2, s[12:15], s48 offen offset:1024 nt
  v_dot2_f32_bf16 v20, v183, v19, v20
  v_dot2_f32_bf16 v21, v187, v19, v21
  v_dot2_f32_bf16 v22, v191, v19, v22
  v_dot2_f32_bf16 v23, v99, v19, v23
  s_waitcnt vmcnt(6)
  s_cmp_ge_i32 s101, 8
  s_cbranch_scc1 L_b255
  s_waitcnt vmcnt(5)
  s_cmp_ge_i32 s101, 5
  s_cbranch_scc1 L_b255
  s_waitcnt vmcnt(4)
L_b255:
  buffer_load_dwordx4 v[140:143], v2, s[12:15], s48 offen offset:2048 nt
  v_add_f32_dpp v20, v20, v20 row_ror:8 row_mask:0xf bank_mask:0x3
  v_add_f32_dpp v21, v21, v21 row_ror:8 row_mask:0xf bank_mask:0x3
  v_add_f32_dpp v20, v22, v22 row_ror:8 row_mask:0xf bank_mask:0xc
  v_add_f32_dpp v21, v23, v23 row_ror:8 row_mask:0xf bank_mask:0xc
  s_nop 0
  v_add_f32_dpp v26, v20, v20 row_half_mirror row_mask:0xf bank_mask:0x5
  v_add_f32_dpp v26, v21, v21 row_half_mirror row_mask:0xf bank_mask:0xa
  v_dot2_f32_bf16 v20, v100, v16, 0
  v_dot2_f32_bf16 v21, v104, v16, 0
  v_dot2_f32_bf16 v22, v108, v16, 0
  v_dot2_f32_bf16 v23, v112, v16, 0
  v_dot2_f32_bf16 v20, v101, v17, v20
  v_dot2_f32_bf16 v21, v105, v17, v21
  v_dot2_f32_bf16 v22, v109, v17, v22
  v_dot2_f32_bf16 v23, v113, v17, v23
  v_dot2_f32_bf16 v20, v102, v18, v20
  v_dot2_f32_bf16 v21, v106, v18, v21
  v_dot2_f32_bf16 v22, v110, v18, v22
  v_dot2_f32_bf16 v23, v114, v18, v23
  v_dot2_f32_bf16 v20, v103, v19, v20
  v_dot2_f32_bf16 v21, v107, v19, v21
  v_dot2_f32_bf16 v22, v111, v19, v22
  v_dot2_f32_bf16 v23, v115, v19, v23
  v_add_f32_dpp v20, v20, v20 row_ror:8 row_mask:0xf bank_mask:0x3
  v_add_f32_dpp v21, v21, v21 row_ror:8 row_mask:0xf bank_mask:0x3
  v_add_f32_dpp v20, v22, v22 row_ror:8 row_mask:0xf bank_mask:0xc
  v_add_f32_dpp v21, v23, v23 row_ror:8 row_mask:0xf bank_mask:0xc
  s_nop 0
  v_add_f32_dpp v27, v20, v20 row_half_mirror row_mask:0xf bank_mask:0x5
  v_add_f32_dpp v27, v21, v21 row_half_mirror row_mask:0xf bank_mask:0xa
  v_add_f32_dpp v24, v24, v24 quad_perm:[1,0,3,2] row_mask:0xf bank_mask:0xf
  v_add_f32_dpp v25, v25, v25 quad_perm:[1,0,3,2] row_mask:0xf bank_mask:0xf
  v_add_f32_dpp v26, v26, v26 quad_perm:[1,0,3,2] row_mask:0xf bank_mask:0xf
  v_add_f32_dpp v27, v27, v27 quad_perm:[1,0,3,2] row_mask:0xf bank_mask:0xf
  v_cndmask_b32 v24, v24, v25, s[52:53]
  v_cndmask_b32 v26, v26, v27, s[52:53]
  s_nop 0
  v_add_f32_dpp v24, v24, v24 quad_perm:[2,3,0,1] row_mask:0xf bank_mask:0xf
  v_add_f32_dpp v26, v26, v26 quad_perm:[2,3,0,1] row_mask:0xf bank_mask:0xf
  v_cndmask_b32 v43, v24, v26, s[54:55]
  v_cvt_pk_bf16_f32 v43, v43, v43
  v_and_b32 v43, 0xffff0000, v43
  v_mul_f32 v43, s44, v43
  v_cvt_pk_bf16_f32 v43, v43, v43
  v_and_b32 v43, 0xffff0000, v43
  v_max_f32 v15, v15, v43
  buffer_load_dwordx4 v[144:147], v2, s[12:15], s48 offen offset:3072 nt
  s_or_b32 s48, s48, 40960
  s_add_u32 s48, s48, 4096
  s_and_b32 s48, s48, 1003520
  v_max_f32_dpp v15, v15, v15 row_ror:8 row_mask:0xf bank_mask:0xf
  s_nop 1
  v_max_f32_dpp v15, v15, v15 row_ror:4 row_mask:0xf bank_mask:0xf
  s_nop 1
  v_max_f32_dpp v15, v15, v15 row_ror:2 row_mask:0xf bank_mask:0xf
  s_nop 1
  v_max_f32_dpp v15, v15, v15 row_ror:1 row_mask:0xf bank_mask:0xf
  v_mov_b32 v68, v15
  s_nop 1
  v_permlane16_swap_b32 v15, v68
  v_max_f32 v15, v15, v68
  v_mov_b32 v68, v15
  s_nop 1
  v_permlane32_swap_b32 v15, v68
  v_max_f32 v15, v15, v68
  v_mul_f32 v68, s59, v15
  v_fma_f32 v28, v28, s59, -v68
  v_fma_f32 v29, v29, s59, -v68
  v_fma_f32 v30, v30, s59, -v68
  v_fma_f32 v31, v31, s59, -v68
  v_fma_f32 v32, v32, s59, -v68
  v_fma_f32 v33, v33, s59, -v68
  v_fma_f32 v34, v34, s59, -v68
  v_fma_f32 v35, v35, s59, -v68
  v_fma_f32 v36, v36, s59, -v68
  v_fma_f32 v37, v37, s59, -v68
  v_fma_f32 v38, v38, s59, -v68
  v_fma_f32 v39, v39, s59, -v68
  v_fma_f32 v40, v40, s59, -v68
  v_fma_f32 v41, v41, s59, -v68
  v_fma_f32 v42, v42, s59, -v68
  v_fma_f32 v43, v43, s59, -v68
  v_exp_f32 v28, v28
  v_exp_f32 v29, v29
  v_exp_f32 v30, v30
  v_exp_f32 v31, v31
  v_exp_f32 v32, v32
  v_exp_f32 v33, v33
  v_exp_f32 v34, v34
  v_exp_f32 v35, v35
  v_exp_f32 v36, v36
  v_exp_f32 v37, v37
  v_exp_f32 v38, v38
  v_exp_f32 v39, v39
  v_exp_f32 v40, v40
  v_exp_f32 v41, v41
  v_exp_f32 v42, v42
  v_exp_f32 v43, v43
  buffer_load_dwordx4 v[148:151], v2, s[12:15], s48 offen offset:0 nt
  v_add_f32 v44, v28, v29
  v_add_f32 v45, v30, v31
  v_add_f32 v46, v32, v33
  v_add_f32 v47, v34, v35
  v_add_f32 v48, v36, v37
  v_add_f32 v49, v38, v39
  v_add_f32 v50, v40, v41
  v_add_f32 v51, v42, v43
  v_add_f32 v44, v44, v48
  v_add_f32 v45, v45, v49
  v_add_f32 v46, v46, v50
  v_add_f32 v47, v47, v51
  v_add_f32 v44, v44, v46
  v_add_f32 v45, v45, v47
  v_add_f32 v71, v44, v45
  s_nop 1
  v_add_f32_dpp v71, v71, v71 row_ror:8 row_mask:0xf bank_mask:0xf
  s_nop 1
  v_add_f32_dpp v71, v71, v71 row_ror:4 row_mask:0xf bank_mask:0xf
  s_nop 1
  v_add_f32_dpp v71, v71, v71 row_ror:2 row_mask:0xf bank_mask:0xf
  s_nop 1
  v_add_f32_dpp v71, v71, v71 row_ror:1 row_mask:0xf bank_mask:0xf
  v_mov_b32 v69, v71
  s_nop 1
  v_permlane16_swap_b32 v71, v69
  v_add_f32 v71, v71, v69
  v_mov_b32 v69, v71
  s_nop 1
  v_permlane32_swap_b32 v71, v69
  v_add_f32 v71, v71, v69
  v_mov_b32 v70, v68
  s_lshl_b32 s50, s3, 3
  v_mov_b32 v69, s50
  s_mov_b64 exec, 1
  ds_write_b64 v69, v[70:71] offset:2048
  s_mov_b64 exec, -1
  v_mov_b32 v69, 0
  buffer_load_dwordx4 v[152:155], v2, s[12:15], s48 offen offset:1024 nt
  s_waitcnt lgkmcnt(0)
  s_barrier
  buffer_load_dwordx4 v[156:159], v2, s[12:15], s48 offen offset:2048 nt
  ds_read_b128 v[44:47], v69 offset:2048
  ds_read_b128 v[48:51], v69 offset:2064
  s_waitcnt lgkmcnt(0)
  v_max3_f32 v73, v44, v46, v48
  v_max_f32 v73, v73, v50
  v_sub_f32 v44, v44, v73
  v_sub_f32 v46, v46, v73
  v_sub_f32 v48, v48, v73
  v_sub_f32 v50, v50, v73
  v_sub_f32 v68, v68, v73
  v_exp_f32 v44, v44
  v_exp_f32 v46, v46
  v_exp_f32 v48, v48
  v_exp_f32 v50, v50
  v_exp_f32 v68, v68
  v_mul_f32 v44, v44, v45
  v_mul_f32 v48, v48, v49
  v_fmac_f32 v44, v46, v47
  v_fmac_f32 v48, v50, v51
  v_add_f32 v44, v44, v48
  v_rcp_f32 v44, v44
  s_nop 0
  v_mul_f32 v68, v68, v44
  buffer_load_dwordx4 v[160:163], v2, s[12:15], s48 offen offset:3072 nt
  s_or_b32 s48, s48, 40960
  s_add_u32 s48, s48, 4096
  s_and_b32 s48, s48, 1003520
  v_mul_f32 v28, v28, v68
  v_mul_f32 v29, v29, v68
  v_mul_f32 v30, v30, v68
  v_mul_f32 v31, v31, v68
  v_mul_f32 v32, v32, v68
  v_mul_f32 v33, v33, v68
  v_mul_f32 v34, v34, v68
  v_mul_f32 v35, v35, v68
  v_mul_f32 v36, v36, v68
  v_mul_f32 v37, v37, v68
  v_mul_f32 v38, v38, v68
  v_mul_f32 v39, v39, v68
  v_mul_f32 v40, v40, v68
  v_mul_f32 v41, v41, v68
  v_mul_f32 v42, v42, v68
  v_mul_f32 v43, v43, v68
  v_cvt_pk_bf16_f32 v28, v28, v28
  v_cvt_pk_bf16_f32 v29, v29, v29
  v_cvt_pk_bf16_f32 v30, v30, v30
  v_cvt_pk_bf16_f32 v31, v31, v31
  v_cvt_pk_bf16_f32 v32, v32, v32
  v_cvt_pk_bf16_f32 v33, v33, v33
  v_cvt_pk_bf16_f32 v34, v34, v34
  v_cvt_pk_bf16_f32 v35, v35, v35
  v_cvt_pk_bf16_f32 v36, v36, v36
  v_cvt_pk_bf16_f32 v37, v37, v37
  v_cvt_pk_bf16_f32 v38, v38, v38
  v_cvt_pk_bf16_f32 v39, v39, v39
  v_cvt_pk_bf16_f32 v40, v40, v40
  v_cvt_pk_bf16_f32 v41, v41, v41
  v_cvt_pk_bf16_f32 v42, v42, v42
  v_cvt_pk_bf16_f32 v43, v43, v43
  v_and_b32_dpp v44, v28, v12 quad_perm:[0,0,0,0] row_mask:0xf bank_mask:0xf
  v_and_b32_dpp v45, v28, v13 quad_perm:[0,0,0,0] row_mask:0xf bank_mask:0xf
  s_waitcnt vmcnt(11)
  s_memrealtime s[80:81]
L_blk16:
  v_mfma_f32_4x4x4_16b_bf16 v[60:63], v[44:45], v[116:117], 0 cbsz:2 abid:0
  v_mfma_f32_4x4x4_16b_bf16 v[64:67], v[44:45], v[118:119], 0 cbsz:2 abid:0
  v_and_b32_dpp v46, v28, v12 quad_perm:[1,1,1,1] row_mask:0xf bank_mask:0xf
  v_and_b32_dpp v47, v28, v13 quad_perm:[1,1,1,1] row_mask:0xf bank_mask:0xf
  s_waitcnt vmcnt(10)
  v_mfma_f32_4x4x4_16b_bf16 v[60:63], v[44:45], v[120:121], v[60:63] cbsz:2 abid:1
  v_mfma_f32_4x4x4_16b_bf16 v[64:67], v[44:45], v[122:123], v[64:67] cbsz:2 abid:1
  s_waitcnt vmcnt(9)
  s_waitcnt lgkmcnt(0)
  s_sub_u32 s101, s80, s84
  s_sub_i32 s101, s101, 3843
  s_mul_i32 s101, s101, 2184
  s_ashr_i32 s101, s101, 16
  v_mfma_f32_4x4x4_16b_bf16 v[60:63], v[44:45], v[124:125], v[60:63] cbsz:2 abid:2
  v_mfma_f32_4x4x4_16b_bf16 v[64:67], v[44:45], v[126:127], v[64:67] cbsz:2 abid:2
  s_waitcnt vmcnt(8)
  s_mov_b32 s82, L_blk19-L_pc
  s_load_dword s83, s[78:79], s82 offset:0
  s_load_dword s83, s[78:79], s82 offset:512
  s_load_dword s83, s[78:79], s82 offset:1024
  v_mfma_f32_4x4x4_16b_bf16 v[60:63], v[44:45], v[128:129], v[60:63] cbsz:2 abid:3
  v_mfma_f32_4x4x4_16b_bf16 v[64:67], v[44:45], v[130:131], v[64:67] cbsz:2 abid:3
  s_waitcnt vmcnt(7)
  v_mfma_f32_4x4x4_16b_bf16 v[60:63], v[46:47], v[132:133], v[60:63] cbsz:2 abid:0
  v_mfma_f32_4x4x4_16b_bf16 v[64:67], v[46:47], v[134:135], v[64:67] cbsz:2 abid:0
  v_and_b32_dpp v44, v28, v12 quad_perm:[2,2,2,2] row_mask:0xf bank_mask:0xf
  v_and_b32_dpp v45, v28, v13 quad_perm:[2,2,2,2] row_mask:0xf bank_mask:0xf
  s_waitcnt vmcnt(6)
  s_cmp_ge_i32 s101, 8
  s_cbranch_scc1 L_b261
  s_waitcnt vmcnt(5)
  s_cmp_ge_i32 s101, 5
  s_cbranch_scc1 L_b261
  s_waitcnt vmcnt(4)
L_b261:
  buffer_load_dwordx4 v[164:167], v2, s[12:15], s48 offen offset:0 nt
  v_mfma_f32_4x4x4_16b_bf16 v[60:63], v[46:47], v[136:137], v[60:63] cbsz:2 abid:1
  v_mfma_f32_4x4x4_16b_bf16 v[64:67], v[46:47], v[138:139], v[64:67] cbsz:2 abid:1
  s_waitcnt vmcnt(6)
  s_cmp_ge_i32 s101, 7
  s_cbranch_scc1 L_b262
  s_waitcnt vmcnt(5)
  s_cmp_ge_i32 s101, 4
  s_cbranch_scc1 L_b262
  s_waitcnt vmcnt(4)
L_b262:
  buffer_load_dwordx4 v[168:171], v2, s[12:15], s48 offen offset:1024 nt
  v_mfma_f32_4x4x4_16b_bf16 v[60:63], v[46:47], v[140:141], v[60:63] cbsz:2 abid:2
  v_mfma_f32_4x4x4_16b_bf16 v[64:67], v[46:47], v[142:143], v[64:67] cbsz:2 abid:2
  s_waitcnt vmcnt(6)
  s_cmp_ge_i32 s101, 8
  s_cbranch_scc1 L_b263
  s_waitcnt vmcnt(5)
  s_cmp_ge_i32 s101, 5
  s_cbranch_scc1 L_b263
  s_waitcnt vmcnt(4)
L_b263:
  buffer_load_dwordx4 v[172:175], v2, s[12:15], s48 offen offset:2048 nt
  v_mfma_f32_4x4x4_16b_bf16 v[60:63], v[46:47], v[144:145], v[60:63] cbsz:2 abid:3
  v_mfma_f32_4x4x4_16b_bf16 v[64:67], v[46:47], v[146:147], v[64:67] cbsz:2 abid:3
  s_waitcnt vmcnt(6)
  s_cmp_ge_i32 s101, 6
  s_cbranch_scc1 L_b264
  s_waitcnt vmcnt(5)
  s_cmp_ge_i32 s101, 2
  s_cbranch_scc1 L_b264
  s_waitcnt vmcnt(4)
L_b264:
  buffer_load_dwordx4 v[176:179], v2, s[12:15], s48 offen offset:3072 nt
  s_or_b32 s48, s48, 40960
  s_add_u32 s48, s48, 4096
  s_and_b32 s48, s48, 1003520
  v_mfma_f32_4x4x4_16b_bf16 v[60:63], v[44:45], v[148:149], v[60:63] cbsz:2 abid:0
  v_mfma_f32_4x4x4_16b_bf16 v[64:67], v[44:45], v[150:151], v[64:67] cbsz:2 abid:0
  v_and_b32_dpp v46, v28, v12 quad_perm:[3,3,3,3] row_mask:0xf bank_mask:0xf
  v_and_b32_dpp v47, v28, v13 quad_perm:[3,3,3,3] row_mask:0xf bank_mask:0xf
  s_waitcnt vmcnt(6)
  s_cmp_ge_i32 s101, 8
  s_cbranch_scc1 L_b265
  s_waitcnt vmcnt(5)
  s_cmp_ge_i32 s101, 5
  s_cbranch_scc1 L_b265
  s_waitcnt vmcnt(4)
L_b265:
  buffer_load_dwordx4 v[180:183], v2, s[12:15], s48 offen offset:0 nt
  v_mfma_f32_4x4x4_16b_bf16 v[60:63], v[44:45], v[152:153], v[60:63] cbsz:2 abid:1
  v_mfma_f32_4x4x4_16b_bf16 v[64:67], v[44:45], v[154:155], v[64:67] cbsz:2 abid:1
  s_waitcnt vmcnt(6)
  s_cmp_ge_i32 s101, 7
  s_cbranch_scc1 L_b266
  s_waitcnt vmcnt(5)
  s_cmp_ge_i32 s101, 4
  s_cbranch_scc1 L_b266
  s_waitcnt vmcnt(4)
L_b266:
  buffer_load_dwordx4 v[184:187], v2, s[12:15], s48 offen offset:1024 nt
  v_mfma_f32_4x4x4_16b_bf16 v[60:63], v[44:45], v[156:157], v[60:63] cbsz:2 abid:2
  v_mfma_f32_4x4x4_16b_bf16 v[64:67], v[44:45], v[158:159], v[64:67] cbsz:2 abid:2
  s_waitcnt vmcnt(6)
  s_cmp_ge_i32 s101, 8
  s_cbranch_scc1 L_b267
  s_waitcnt vmcnt(5)
  s_cmp_ge_i32 s101, 5
  s_cbranch_scc1 L_b267
  s_waitcnt vmcnt(4)
L_b267:
  buffer_load_dwordx4 v[188:191], v2, s[12:15], s48 offen offset:2048 nt
  v_mfma_f32_4x4x4_16b_bf16 v[60:63], v[44:45], v[160:161], v[60:63] cbsz:2 abid:3
  v_mfma_f32_4x4x4_16b_bf16 v[64:67], v[44:45], v[162:163], v[64:67] cbsz:2 abid:3
  s_waitcnt vmcnt(6)
  s_cmp_ge_i32 s101, 6
  s_cbranch_scc1 L_b268
  s_waitcnt vmcnt(5)
  s_cmp_ge_i32 s101, 3
  s_cbranch_scc1 L_b268
  s_waitcnt vmcnt(4)
L_b268:
  buffer_load_dwordx4 v[96:99], v2, s[12:15], s48 offen offset:3072 nt
  s_or_b32 s48, s48, 40960
  s_add_u32 s48, s48, 4096
  s_and_b32 s48, s48, 1003520
  v_mfma_f32_4x4x4_16b_bf16 v[60:63], v[46:47], v[164:165], v[60:63] cbsz:2 abid:0
  v_mfma_f32_4x4x4_16b_bf16 v[64:67], v[46:47], v[166:167], v[64:67] cbsz:2 abid:0
  v_and_b32_dpp v44, v29, v12 quad_perm:[0,0,0,0] row_mask:0xf bank_mask:0xf
  v_and_b32_dpp v45, v29, v13 quad_perm:[0,0,0,0] row_mask:0xf bank_mask:0xf
  s_waitcnt vmcnt(6)
  s_cmp_ge_i32 s101, 8
  s_cbranch_scc1 L_b269
  s_waitcnt vmcnt(5)
  s_cmp_ge_i32 s101, 5
  s_cbranch_scc1 L_b269
  s_waitcnt vmcnt(4)
L_b269:
  buffer_load_dwordx4 v[100:103], v2, s[12:15], s48 offen offset:0 nt
  v_mfma_f32_4x4x4_16b_bf16 v[60:63], v[46:47], v[168:169], v[60:63] cbsz:2 abid:1
  v_mfma_f32_4x4x4_16b_bf16 v[64:67], v[46:47], v[170:171], v[64:67] cbsz:2 abid:1
  s_waitcnt vmcnt(6)
  s_cmp_ge_i32 s101, 7
  s_cbranch_scc1 L_b270
  s_waitcnt vmcnt(5)
  s_cmp_ge_i32 s101, 4
  s_cbranch_scc1 L_b270
  s_waitcnt vmcnt(4)
L_b270:
  buffer_load_dwordx4 v[104:107], v2, s[12:15], s48 offen offset:1024 nt
  v_mfma_f32_4x4x4_16b_bf16 v[60:63], v[46:47], v[172:173], v[60:63] cbsz:2 abid:2
  v_mfma_f32_4x4x4_16b_bf16 v[64:67], v[46:47], v[174:175], v[64:67] cbsz:2 abid:2
  s_waitcnt vmcnt(6)
  s_cmp_ge_i32 s101, 8
  s_cbranch_scc1 L_b271
  s_waitcnt vmcnt(5)
  s_cmp_ge_i32 s101, 5
  s_cbranch_scc1 L_b271
  s_waitcnt vmcnt(4)
L_b271:
  buffer_load_dwordx4 v[108:111], v2, s[12:15], s48 offen offset:2048 nt
  v_mfma_f32_4x4x4_16b_bf16 v[60:63], v[46:47], v[176:177], v[60:63] cbsz:2 abid:3
  v_mfma_f32_4x4x4_16b_bf16 v[64:67], v[46:47], v[178:179], v[64:67] cbsz:2 abid:3
  s_waitcnt vmcnt(6)
  s_memrealtime s[80:81]
L_blk17:
  s_cmp_ge_i32 s101, 6
  s_cbranch_scc1 L_b272
  s_waitcnt vmcnt(5)
  s_cmp_ge_i32 s101, 1
  s_cbranch_scc1 L_b272
  s_waitcnt vmcnt(4)
L_b272:
  buffer_load_dwordx4 v[112:115], v2, s[12:15], s48 offen offset:3072 nt
  s_or_b32 s48, s48, 40960
  s_add_u32 s48, s48, 4096
  s_and_b32 s48, s48, 1003520
  v_mfma_f32_4x4x4_16b_bf16 v[60:63], v[44:45], v[180:181], v[60:63] cbsz:2 abid:0
  v_mfma_f32_4x4x4_16b_bf16 v[64:67], v[44:45], v[182:183], v[64:67] cbsz:2 abid:0
  v_and_b32_dpp v46, v29, v12 quad_perm:[1,1,1,1] row_mask:0xf bank_mask:0xf
  v_and_b32_dpp v47, v29, v13 quad_perm:[1,1,1,1] row_mask:0xf bank_mask:0xf
  s_waitcnt vmcnt(6)
  s_cmp_ge_i32 s101, 8
  s_cbranch_scc1 L_b273
  s_waitcnt vmcnt(5)
  s_cmp_ge_i32 s101, 5
  s_cbranch_scc1 L_b273
  s_waitcnt vmcnt(4)
L_b273:
  buffer_load_dwordx4 v[116:119], v2, s[12:15], s48 offen offset:0 nt
  v_mfma_f32_4x4x4_16b_bf16 v[60:63], v[44:45], v[184:185], v[60:63] cbsz:2 abid:1
  v_mfma_f32_4x4x4_16b_bf16 v[64:67], v[44:45], v[186:187], v[64:67] cbsz:2 abid:1
  s_waitcnt vmcnt(6)
  s_waitcnt lgkmcnt(0)
  s_sub_u32 s101, s80, s84
  s_sub_i32 s101, s101, 4060
  s_mul_i32 s101, s101, 2184
  s_ashr_i32 s101, s101, 16
  s_cmp_ge_i32 s101, 7
  s_cbranch_scc1 L_b274
  s_waitcnt vmcnt(5)
  s_cmp_ge_i32 s101, 4
  s_cbranch_scc1 L_b274
  s_waitcnt vmcnt(4)
L_b274:
  buffer_load_dwordx4 v[120:123], v2, s[12:15], s48 offen offset:1024 nt
  v_mfma_f32_4x4x4_16b_bf16 v[60:63], v[44:45], v[188:189], v[60:63] cbsz:2 abid:2
  v_mfma_f32_4x4x4_16b_bf16 v[64:67], v[44:45], v[190:191], v[64:67] cbsz:2 abid:2
  s_waitcnt vmcnt(6)
  s_mov_b32 s82, L_blk20-L_pc
  s_load_dword s83, s[78:79], s82 offset:0
  s_load_dword s83, s[78:79], s82 offset:512
  s_load_dword s83, s[78:79], s82 offset:1024
  s_cmp_ge_i32 s101, 8
  s_cbranch_scc1 L_b275
  s_waitcnt vmcnt(5)
  s_cmp_ge_i32 s101, 5
  s_cbranch_scc1 L_b275
  s_waitcnt vmcnt(4)
L_b275:
  buffer_load_dwordx4 v[124:127], v2, s[12:15], s48 offen offset:2048 nt
  v_mfma_f32_4x4x4_16b_bf16 v[60:63], v[44:45], v[96:97], v[60:63] cbsz:2 abid:3
  v_mfma_f32_4x4x4_16b_bf16 v[64:67], v[44:45], v[98:99], v[64:67] cbsz:2 abid:3
  s_waitcnt vmcnt(6)
  s_cmp_ge_i32 s101, 6
  s_cbranch_scc1 L_b276
  s_waitcnt vmcnt(5)
  s_cmp_ge_i32 s101, 3
  s_cbranch_scc1 L_b276
  s_waitcnt vmcnt(4)
L_b276:
  buffer_load_dwordx4 v[128:131], v2, s[12:15], s48 offen offset:3072 nt
  s_or_b32 s48, s48, 40960
  s_add_u32 s48, s48, 4096
  s_and_b32 s48, s48, 1003520
  v_mfma_f32_4x4x4_16b_bf16 v[60:63], v[46:47], v[100:101], v[60:63] cbsz:2 abid:0
  v_mfma_f32_4x4x4_16b_bf16 v[64:67], v[46:47], v[102:103], v[64:67] cbsz:2 abid:0
  v_and_b32_dpp v44, v29, v12 quad_perm:[2,2,2,2] row_mask:0xf bank_mask:0xf
  v_and_b32_dpp v45, v29, v13 quad_perm:[2,2,2,2] row_mask:0xf bank_mask:0xf
  s_waitcnt vmcnt(6)
  s_cmp_ge_i32 s101, 8
  s_cbranch_scc1 L_b277
  s_waitcnt vmcnt(5)
  s_cmp_ge_i32 s101, 5
  s_cbranch_scc1 L_b277
  s_waitcnt vmcnt(4)
L_b277:
  buffer_load_dwordx4 v[132:135], v2, s[12:15], s48 offen offset:0 nt
  v_mfma_f32_4x4x4_16b_bf16 v[60:63], v[46:47], v[104:105], v[60:63] cbsz:2 abid:1
  v_mfma_f32_4x4x4_16b_bf16 v[64:67], v[46:47], v[106:107], v[64:67] cbsz:2 abid:1
  s_waitcnt vmcnt(6)
  s_cmp_ge_i32 s101, 7
  s_cbranch_scc1 L_b278
  s_waitcnt vmcnt(5)
  s_cmp_ge_i32 s101, 4
  s_cbranch_scc1 L_b278
  s_waitcnt vmcnt(4)
L_b278:
  buffer_load_dwordx4 v[136:139], v2, s[12:15], s48 offen offset:1024 nt
  v_mfma_f32_4x4x4_16b_bf16 v[60:63], v[46:47], v[108:109], v[60:63] cbsz:2 abid:2
  v_mfma_f32_4x4x4_16b_bf16 v[64:67], v[46:47], v[110:111], v[64:67] cbsz:2 abid:2
  s_waitcnt vmcnt(6)
  s_cmp_ge_i32 s101, 8
  s_cbranch_scc1 L_b279
  s_waitcnt vmcnt(5)
  s_cmp_ge_i32 s101, 5
  s_cbranch_scc1 L_b279
  s_waitcnt vmcnt(4)
L_b279:
  buffer_load_dwordx4 v[140:143], v2, s[12:15], s48 offen offset:2048 nt
  v_mfma_f32_4x4x4_16b_bf16 v[60:63], v[46:47], v[112:113], v[60:63] cbsz:2 abid:3
  v_mfma_f32_4x4x4_16b_bf16 v[64:67], v[46:47], v[114:115], v[64:67] cbsz:2 abid:3
  s_waitcnt vmcnt(6)
  s_cmp_ge_i32 s101, 6
  s_cbranch_scc1 L_b280
  s_waitcnt vmcnt(5)
  s_cmp_ge_i32 s101, 2
  s_cbranch_scc1 L_b280
  s_waitcnt vmcnt(4)
L_b280:
  buffer_load_dwordx4 v[144:147], v2, s[12:15], s48 offen offset:3072 nt
  s_or_b32 s48, s48, 40960
  s_add_u32 s48, s48, 4096
  s_and_b32 s48, s48, 1003520
  v_mfma_f32_4x4x4_16b_bf16 v[60:63], v[44:45], v[116:117], v[60:63] cbsz:2 abid:0
  v_mfma_f32_4x4x4_16b_bf16 v[64:67], v[44:45], v[118:119], v[64:67] cbsz:2 abid:0
  v_and_b32_dpp v46, v29, v12 quad_perm:[3,3,3,3] row_mask:0xf bank_mask:0xf
  v_and_b32_dpp v47, v29, v13 quad_perm:[3,3,3,3] row_mask:0xf bank_mask:0xf
  s_waitcnt vmcnt(6)
  s_cmp_ge_i32 s101, 8
  s_cbranch_scc1 L_b281
  s_waitcnt vmcnt(5)
  s_cmp_ge_i32 s101, 5
  s_cbranch_scc1 L_b281
  s_waitcnt vmcnt(4)
L_b281:
  buffer_load_dwordx4 v[148:151], v0, s[12:15], s48 offen offset:0 nt
  v_mfma_f32_4x4x4_16b_bf16 v[60:63], v[44:45], v[120:121], v[60:63] cbsz:2 abid:1
  v_mfma_f32_4x4x4_16b_bf16 v[64:67], v[44:45], v[122:123], v[64:67] cbsz:2 abid:1
  s_waitcnt vmcnt(6)
  s_cmp_ge_i32 s101, 7
  s_cbranch_scc1 L_b282
  s_waitcnt vmcnt(5)
  s_cmp_ge_i32 s101, 4
  s_cbranch_scc1 L_b282
  s_waitcnt vmcnt(4)
L_b282:
  buffer_load_dwordx4 v[152:155], v0, s[12:15], s48 offen offset:1024 nt
  v_mfma_f32_4x4x4_16b_bf16 v[60:63], v[44:45], v[124:125], v[60:63] cbsz:2 abid:2
  v_mfma_f32_4x4x4_16b_bf16 v[64:67], v[44:45], v[126:127], v[64:67] cbsz:2 abid:2
  s_waitcnt vmcnt(6)
  s_cmp_ge_i32 s101, 8
  s_cbranch_scc1 L_b283
  s_waitcnt vmcnt(5)
  s_cmp_ge_i32 s101, 5
  s_cbranch_scc1 L_b283
  s_waitcnt vmcnt(4)
L_b283:
  buffer_load_dwordx4 v[156:159], v0, s[12:15], s48 offen offset:2048 nt
  v_mfma_f32_4x4x4_16b_bf16 v[60:63], v[44:45], v[128:129], v[60:63] cbsz:2 abid:3
  v_mfma_f32_4x4x4_16b_bf16 v[64:67], v[44:45], v[130:131], v[64:67] cbsz:2 abid:3
  s_waitcnt vmcnt(6)
  s_cmp_ge_i32 s101, 6
  s_cbranch_scc1 L_b284
  s_waitcnt vmcnt(5)
  s_cmp_ge_i32 s101, 3
  s_cbranch_scc1 L_b284
  s_waitcnt vmcnt(4)
L_b284:
  buffer_load_dwordx4 v[160:163], v0, s[12:15], s48 offen offset:3072 nt
  s_or_b32 s48, s48, 40960
  s_add_u32 s48, s48, 4096
  s_and_b32 s48, s48, 1003520
  v_mfma_f32_4x4x4_16b_bf16 v[60:63], v[46:47], v[132:133], v[60:63] cbsz:2 abid:0
  v_mfma_f32_4x4x4_16b_bf16 v[64:67], v[46:47], v[134:135], v[64:67] cbsz:2 abid:0
  v_and_b32_dpp v44, v30, v12 quad_perm:[0,0,0,0] row_mask:0xf bank_mask:0xf
  v_and_b32_dpp v45, v30, v13 quad_perm:[0,0,0,0] row_mask:0xf bank_mask:0xf
  s_waitcnt vmcnt(6)
  s_cmp_ge_i32 s101, 8
  s_cbranch_scc1 L_b285
  s_waitcnt vmcnt(5)
  s_cmp_ge_i32 s101, 5
  s_cbranch_scc1 L_b285
  s_waitcnt vmcnt(4)
L_b285:
  buffer_load_dwordx4 v[164:167], v0, s[12:15], s48 offen offset:0 nt
  v_mfma_f32_4x4x4_16b_bf16 v[60:63], v[46:47], v[136:137], v[60:63] cbsz:2 abid:1
  v_mfma_f32_4x4x4_16b_bf16 v[64:67], v[46:47], v[138:139], v[64:67] cbsz:2 abid:1
  s_waitcnt vmcnt(6)
  s_cmp_ge_i32 s101, 7
  s_cbranch_scc1 L_b286
  s_waitcnt vmcnt(5)
  s_cmp_ge_i32 s101, 4
  s_cbranch_scc1 L_b286
  s_waitcnt vmcnt(4)
L_b286:
  buffer_load_dwordx4 v[168:171], v0, s[12:15], s48 offen offset:1024 nt
  v_mfma_f32_4x4x4_16b_bf16 v[60:63], v[46:47], v[140:141], v[60:63] cbsz:2 abid:2
  v_mfma_f32_4x4x4_16b_bf16 v[64:67], v[46:47], v[142:143], v[64:67] cbsz:2 abid:2
  s_waitcnt vmcnt(6)
  s_cmp_ge_i32 s101, 8
  s_cbranch_scc1 L_b287
  s_waitcnt vmcnt(5)
  s_cmp_ge_i32 s101, 5
  s_cbranch_scc1 L_b287
  s_waitcnt vmcnt(4)
L_b287:
  buffer_load_dwordx4 v[172:175], v0, s[12:15], s48 offen offset:2048 nt
  v_mfma_f32_4x4x4_16b_bf16 v[60:63], v[46:47], v[144:145], v[60:63] cbsz:2 abid:3
  v_mfma_f32_4x4x4_16b_bf16 v[64:67], v[46:47], v[146:147], v[64:67] cbsz:2 abid:3
  s_waitcnt vmcnt(6)
  s_memrealtime s[80:81]
L_blk18:
  s_cmp_ge_i32 s101, 6
  s_cbranch_scc1 L_b288
  s_waitcnt vmcnt(5)
  s_cmp_ge_i32 s101, 1
  s_cbranch_scc1 L_b288
  s_waitcnt vmcnt(4)
L_b288:
  buffer_load_dwordx4 v[176:179], v0, s[12:15], s48 offen offset:3072 nt
  s_or_b32 s48, s48, 40960
  s_add_u32 s48, s48, 4096
  s_and_b32 s48, s48, 1003520
  v_mfma_f32_4x4x4_16b_bf16 v[60:63], v[44:45], v[148:149], v[60:63] cbsz:2 abid:0
  v_mfma_f32_4x4x4_16b_bf16 v[64:67], v[44:45], v[150:151], v[64:67] cbsz:2 abid:0
  v_and_b32_dpp v46, v30, v12 quad_perm:[1,1,1,1] row_mask:0xf bank_mask:0xf
  v_and_b32_dpp v47, v30, v13 quad_perm:[1,1,1,1] row_mask:0xf bank_mask:0xf
  s_waitcnt vmcnt(6)
  s_cmp_ge_i32 s101, 8
  s_cbranch_scc1 L_b289
  s_waitcnt vmcnt(5)
  s_cmp_ge_i32 s101, 5
  s_cbranch_scc1 L_b289
  s_waitcnt vmcnt(4)
L_b289:
  buffer_load_dwordx4 v[180:183], v0, s[12:15], s48 offen offset:0 nt
  v_mfma_f32_4x4x4_16b_bf16 v[60:63], v[44:45], v[152:153], v[60:63] cbsz:2 abid:1
  v_mfma_f32_4x4x4_16b_bf16 v[64:67], v[44:45], v[154:155], v[64:67] cbsz:2 abid:1
  s_waitcnt vmcnt(6)
  s_waitcnt lgkmcnt(0)
  s_sub_u32 s101, s80, s84
  s_sub_i32 s101, s101, 4278
  s_mul_i32 s101, s101, 2184
  s_ashr_i32 s101, s101, 16
  s_cmp_ge_i32 s101, 7
  s_cbranch_scc1 L_b290
  s_waitcnt vmcnt(5)
  s_cmp_ge_i32 s101, 4
  s_cbranch_scc1 L_b290
  s_waitcnt vmcnt(4)
L_b290:
  buffer_load_dwordx4 v[184:187], v0, s[12:15], s48 offen offset:1024 nt
  v_mfma_f32_4x4x4_16b_bf16 v[60:63], v[44:45], v[156:157], v[60:63] cbsz:2 abid:2
  v_mfma_f32_4x4x4_16b_bf16 v[64:67], v[44:45], v[158:159], v[64:67] cbsz:2 abid:2
  s_waitcnt vmcnt(6)
  s_mov_b32 s82, L_blk21-L_pc
  s_load_dword s83, s[78:79], s82 offset:0
  s_load_dword s83, s[78:79], s82 offset:512
  s_load_dword s83, s[78:79], s82 offset:1024
  s_cmp_ge_i32 s101, 8
  s_cbranch_scc1 L_b291
  s_waitcnt vmcnt(5)
  s_cmp_ge_i32 s101, 5
  s_cbranch_scc1 L_b291
  s_waitcnt vmcnt(4)
L_b291:
  buffer_load_dwordx4 v[188:191], v0, s[12:15], s48 offen offset:2048 nt
  v_mfma_f32_4x4x4_16b_bf16 v[60:63], v[44:45], v[160:161], v[60:63] cbsz:2 abid:3
  v_mfma_f32_4x4x4_16b_bf16 v[64:67], v[44:45], v[162:163], v[64:67] cbsz:2 abid:3
  s_waitcnt vmcnt(6)
  s_cmp_ge_i32 s101, 6
  s_cbranch_scc1 L_b292
  s_waitcnt vmcnt(5)
  s_cmp_ge_i32 s101, 3
  s_cbranch_scc1 L_b292
  s_waitcnt vmcnt(4)
L_b292:
  buffer_load_dwordx4 v[96:99], v0, s[12:15], s48 offen offset:3072 nt
  s_or_b32 s48, s48, 40960
  s_add_u32 s48, s48, 4096
  s_and_b32 s48, s48, 1003520
  v_mfma_f32_4x4x4_16b_bf16 v[60:63], v[46:47], v[164:165], v[60:63] cbsz:2 abid:0
  v_mfma_f32_4x4x4_16b_bf16 v[64:67], v[46:47], v[166:167], v[64:67] cbsz:2 abid:0
  v_and_b32_dpp v44, v30, v12 quad_perm:[2,2,2,2] row_mask:0xf bank_mask:0xf
  v_and_b32_dpp v45, v30, v13 quad_perm:[2,2,2,2] row_mask:0xf bank_mask:0xf
  s_waitcnt vmcnt(6)
  s_cmp_ge_i32 s101, 8
  s_cbranch_scc1 L_b293
  s_waitcnt vmcnt(5)
  s_cmp_ge_i32 s101, 5
  s_cbranch_scc1 L_b293
  s_waitcnt vmcnt(4)
L_b293:
  buffer_load_dwordx4 v[100:103], v0, s[12:15], s48 offen offset:0 nt
  v_mfma_f32_4x4x4_16b_bf16 v[60:63], v[46:47], v[168:169], v[60:63] cbsz:2 abid:1
  v_mfma_f32_4x4x4_16b_bf16 v[64:67], v[46:47], v[170:171], v[64:67] cbsz:2 abid:1
  s_waitcnt vmcnt(6)
  s_cmp_ge_i32 s101, 7
  s_cbranch_scc1 L_b294
  s_waitcnt vmcnt(5)
  s_cmp_ge_i32 s101, 4
  s_cbranch_scc1 L_b294
  s_waitcnt vmcnt(4)
L_b294:
  buffer_load_dwordx4 v[104:107], v0, s[12:15], s48 offen offset:1024 nt
  v_mfma_f32_4x4x4_16b_bf16 v[60:63], v[46:47], v[172:173], v[60:63] cbsz:2 abid:2
  v_mfma_f32_4x4x4_16b_bf16 v[64:67], v[46:47], v[174:175], v[64:67] cbsz:2 abid:2
  s_waitcnt vmcnt(6)
  s_cmp_ge_i32 s101, 8
  s_cbranch_scc1 L_b295
  s_waitcnt vmcnt(5)
  s_cmp_ge_i32 s101, 5
  s_cbranch_scc1 L_b295
  s_waitcnt vmcnt(4)
L_b295:
  buffer_load_dwordx4 v[108:111], v0, s[12:15], s48 offen offset:2048 nt
  v_mfma_f32_4x4x4_16b_bf16 v[60:63], v[46:47], v[176:177], v[60:63] cbsz:2 abid:3
  v_mfma_f32_4x4x4_16b_bf16 v[64:67], v[46:47], v[178:179], v[64:67] cbsz:2 abid:3
  s_waitcnt vmcnt(6)
  s_cmp_ge_i32 s101, 6
  s_cbranch_scc1 L_b296
  s_waitcnt vmcnt(5)
  s_cmp_ge_i32 s101, 2
  s_cbranch_scc1 L_b296
  s_waitcnt vmcnt(4)
L_b296:
  buffer_load_dwordx4 v[112:115], v0, s[12:15], s48 offen offset:3072 nt
  s_or_b32 s48, s48, 40960
  s_add_u32 s48, s48, 4096
  s_and_b32 s48, s48, 1003520
  v_mfma_f32_4x4x4_16b_bf16 v[60:63], v[44:45], v[180:181], v[60:63] cbsz:2 abid:0
  v_mfma_f32_4x4x4_16b_bf16 v[64:67], v[44:45], v[182:183], v[64:67] cbsz:2 abid:0
  v_and_b32_dpp v46, v30, v12 quad_perm:[3,3,3,3] row_mask:0xf bank_mask:0xf
  v_and_b32_dpp v47, v30, v13 quad_perm:[3,3,3,3] row_mask:0xf bank_mask:0xf
  s_waitcnt vmcnt(6)
  s_cmp_ge_i32 s101, 8
  s_cbranch_scc1 L_b297
  s_waitcnt vmcnt(5)
  s_cmp_ge_i32 s101, 5
  s_cbranch_scc1 L_b297
  s_waitcnt vmcnt(4)
L_b297:
  buffer_load_dwordx4 v[116:119], v0, s[12:15], s48 offen offset:0 nt
  v_mfma_f32_4x4x4_16b_bf16 v[60:63], v[44:45], v[184:185], v[60:63] cbsz:2 abid:1
  v_mfma_f32_4x4x4_16b_bf16 v[64:67], v[44:45], v[186:187], v[64:67] cbsz:2 abid:1
  s_waitcnt vmcnt(6)
  s_cmp_ge_i32 s101, 7
  s_cbranch_scc1 L_b298
  s_waitcnt vmcnt(5)
  s_cmp_ge_i32 s101, 4
  s_cbranch_scc1 L_b298
  s_waitcnt vmcnt(4)
L_b298:
  buffer_load_dwordx4 v[120:123], v0, s[12:15], s48 offen offset:1024 nt
  v_mfma_f32_4x4x4_16b_bf16 v[60:63], v[44:45], v[188:189], v[60:63] cbsz:2 abid:2
  v_mfma_f32_4x4x4_16b_bf16 v[64:67], v[44:45], v[190:191], v[64:67] cbsz:2 abid:2
  s_waitcnt vmcnt(6)
  s_cmp_ge_i32 s101, 8
  s_cbranch_scc1 L_b299
  s_waitcnt vmcnt(5)
  s_cmp_ge_i32 s101, 5
  s_cbranch_scc1 L_b299
  s_waitcnt vmcnt(4)
L_b299:
  buffer_load_dwordx4 v[124:127], v0, s[12:15], s48 offen offset:2048 nt
  v_mfma_f32_4x4x4_16b_bf16 v[60:63], v[44:45], v[96:97], v[60:63] cbsz:2 abid:3
  v_mfma_f32_4x4x4_16b_bf16 v[64:67], v[44:45], v[98:99], v[64:67] cbsz:2 abid:3
  v_and_b32 v48, 0x3f803f80, v12
  v_and_b32 v49, 0x3f803f80, v13
  s_waitcnt vmcnt(6)
  s_cmp_ge_i32 s101, 6
  s_cbranch_scc1 L_b300
  s_waitcnt vmcnt(5)
  s_cmp_ge_i32 s101, 3
  s_cbranch_scc1 L_b300
  s_waitcnt vmcnt(4)
L_b300:
  buffer_load_dwordx4 v[128:131], v0, s[12:15], s48 offen offset:3072 nt
  s_or_b32 s48, s48, 40960
  s_add_u32 s48, s48, 4096
  s_and_b32 s48, s48, 1003520
  v_mfma_f32_4x4x4_16b_bf16 v[60:63], v[46:47], v[100:101], v[60:63] cbsz:2 abid:0
  v_mfma_f32_4x4x4_16b_bf16 v[64:67], v[46:47], v[102:103], v[64:67] cbsz:2 abid:0
  v_mfma_f32_4x4x4_16b_bf16 v[76:79], v[48:49], a[0:1], 0 cbsz:2 abid:0
  v_mfma_f32_4x4x4_16b_bf16 v[80:83], v[48:49], a[2:3], 0 cbsz:2 abid:0
  v_and_b32_dpp v44, v31, v12 quad_perm:[0,0,0,0] row_mask:0xf bank_mask:0xf
  v_and_b32_dpp v45, v31, v13 quad_perm:[0,0,0,0] row_mask:0xf bank_mask:0xf
  s_waitcnt vmcnt(6)
  s_cmp_ge_i32 s101, 8
  s_cbranch_scc1 L_b301
  s_waitcnt vmcnt(5)
  s_cmp_ge_i32 s101, 5
  s_cbranch_scc1 L_b301
  s_waitcnt vmcnt(4)
L_b301:
  buffer_load_dwordx4 v[132:135], v0, s[12:15], s48 offen offset:0 nt
  v_mfma_f32_4x4x4_16b_bf16 v[60:63], v[46:47], v[104:105], v[60:63] cbsz:2 abid:1
  v_mfma_f32_4x4x4_16b_bf16 v[64:67], v[46:47], v[106:107], v[64:67] cbsz:2 abid:1
  v_mfma_f32_4x4x4_16b_bf16 v[76:79], v[48:49], a[4:5], v[76:79] cbsz:2 abid:0
  v_mfma_f32_4x4x4_16b_bf16 v[80:83], v[48:49], a[6:7], v[80:83] cbsz:2 abid:0
  s_waitcnt vmcnt(6)
  s_cmp_ge_i32 s101, 7
  s_cbranch_scc1 L_b302
  s_waitcnt vmcnt(5)
  s_cmp_ge_i32 s101, 4
  s_cbranch_scc1 L_b302
  s_waitcnt vmcnt(4)
L_b302:
  buffer_load_dwordx4 v[136:139], v0, s[12:15], s48 offen offset:1024 nt
  v_mfma_f32_4x4x4_16b_bf16 v[60:63], v[46:47], v[108:109], v[60:63] cbsz:2 abid:2
  v_mfma_f32_4x4x4_16b_bf16 v[64:67], v[46:47], v[110:111], v[64:67] cbsz:2 abid:2
  v_mfma_f32_4x4x4_16b_bf16 v[76:79], v[48:49], a[8:9], v[76:79] cbsz:2 abid:0
  v_mfma_f32_4x4x4_16b_bf16 v[80:83], v[48:49], a[10:11], v[80:83] cbsz:2 abid:0
  s_waitcnt vmcnt(6)
  s_cmp_ge_i32 s101, 8
  s_cbranch_scc1 L_b303
  s_waitcnt vmcnt(5)
  s_cmp_ge_i32 s101, 5
  s_cbranch_scc1 L_b303
  s_waitcnt vmcnt(4)
L_b303:
  buffer_load_dwordx4 v[140:143], v0, s[12:15], s48 offen offset:2048 nt
  v_mfma_f32_4x4x4_16b_bf16 v[60:63], v[46:47], v[112:113], v[60:63] cbsz:2 abid:3
  v_mfma_f32_4x4x4_16b_bf16 v[64:67], v[46:47], v[114:115], v[64:67] cbsz:2 abid:3
  v_mfma_f32_4x4x4_16b_bf16 v[76:79], v[48:49], a[12:13], v[76:79] cbsz:2 abid:0
  v_mfma_f32_4x4x4_16b_bf16 v[80:83], v[48:49], a[14:15], v[80:83] cbsz:2 abid:0
  s_waitcnt vmcnt(6)
  s_memrealtime s[80:81]
L_blk19:
  s_cmp_ge_i32 s101, 6
  s_cbranch_scc1 L_b304
  s_waitcnt vmcnt(5)
  s_cmp_ge_i32 s101, 1
  s_cbranch_scc1 L_b304
  s_waitcnt vmcnt(4)
L_b304:
  buffer_load_dwordx4 v[144:147], v0, s[12:15], s48 offen offset:3072 nt
  s_or_b32 s48, s48, 40960
  s_add_u32 s48, s48, 4096
  s_and_b32 s48, s48, 1003520
  v_mfma_f32_4x4x4_16b_bf16 v[60:63], v[44:45], v[116:117], v[60:63] cbsz:2 abid:0
  v_mfma_f32_4x4x4_16b_bf16 v[64:67], v[44:45], v[118:119], v[64:67] cbsz:2 abid:0
  v_mfma_f32_4x4x4_16b_bf16 v[76:79], v[48:49], a[16:17], v[76:79] cbsz:2 abid:0
  v_mfma_f32_4x4x4_16b_bf16 v[80:83], v[48:49], a[18:19], v[80:83] cbsz:2 abid:0
  v_and_b32_dpp v46, v31, v12 quad_perm:[1,1,1,1] row_mask:0xf bank_mask:0xf
  v_and_b32_dpp v47, v31, v13 quad_perm:[1,1,1,1] row_mask:0xf bank_mask:0xf
  s_waitcnt vmcnt(6)
  s_cmp_ge_i32 s101, 8
  s_cbranch_scc1 L_b305
  s_waitcnt vmcnt(5)
  s_cmp_ge_i32 s101, 5
  s_cbranch_scc1 L_b305
  s_waitcnt vmcnt(4)
L_b305:
  buffer_load_dwordx4 v[148:151], v0, s[12:15], s48 offen offset:0 nt
  v_mfma_f32_4x4x4_16b_bf16 v[60:63], v[44:45], v[120:121], v[60:63] cbsz:2 abid:1
  v_mfma_f32_4x4x4_16b_bf16 v[64:67], v[44:45], v[122:123], v[64:67] cbsz:2 abid:1
  v_mfma_f32_4x4x4_16b_bf16 v[76:79], v[48:49], a[20:21], v[76:79] cbsz:2 abid:0
  v_mfma_f32_4x4x4_16b_bf16 v[80:83], v[48:49], a[22:23], v[80:83] cbsz:2 abid:0
  s_waitcnt vmcnt(6)
  s_waitcnt lgkmcnt(0)
  s_sub_u32 s101, s80, s84
  s_sub_i32 s101, s101, 4496
  s_mul_i32 s101, s101, 2184
  s_ashr_i32 s101, s101, 16
  s_cmp_ge_i32 s101, 7
  s_cbranch_scc1 L_b306
  s_waitcnt vmcnt(5)
  s_cmp_ge_i32 s101, 4
  s_cbranch_scc1 L_b306
  s_waitcnt vmcnt(4)
L_b306:
  buffer_load_dwordx4 v[152:155], v0, s[12:15], s48 offen offset:1024 nt
  v_mfma_f32_4x4x4_16b_bf16 v[60:63], v[44:45], v[124:125], v[60:63] cbsz:2 abid:2
  v_mfma_f32_4x4x4_16b_bf16 v[64:67], v[44:45], v[126:127], v[64:67] cbsz:2 abid:2
  v_mfma_f32_4x4x4_16b_bf16 v[76:79], v[48:49], a[24:25], v[76:79] cbsz:2 abid:0
  v_mfma_f32_4x4x4_16b_bf16 v[80:83], v[48:49], a[26:27], v[80:83] cbsz:2 abid:0
  s_waitcnt vmcnt(6)
  s_mov_b32 s82, L_blk22-L_pc
  s_load_dword s83, s[78:79], s82 offset:0
  s_load_dword s83, s[78:79], s82 offset:512
  s_load_dword s83, s[78:79], s82 offset:1024
  s_cmp_ge_i32 s101, 8
  s_cbranch_scc1 L_b307
  s_waitcnt vmcnt(5)
  s_cmp_ge_i32 s101, 5
  s_cbranch_scc1 L_b307
  s_waitcnt vmcnt(4)
L_b307:
  buffer_load_dwordx4 v[156:159], v0, s[12:15], s48 offen offset:2048 nt
  v_mfma_f32_4x4x4_16b_bf16 v[60:63], v[44:45], v[128:129], v[60:63] cbsz:2 abid:3
  v_mfma_f32_4x4x4_16b_bf16 v[64:67], v[44:45], v[130:131], v[64:67] cbsz:2 abid:3
  v_mfma_f32_4x4x4_16b_bf16 v[76:79], v[48:49], a[28:29], v[76:79] cbsz:2 abid:0
  v_mfma_f32_4x4x4_16b_bf16 v[80:83], v[48:49], a[30:31], v[80:83] cbsz:2 abid:0
  s_waitcnt vmcnt(6)
  s_cmp_ge_i32 s101, 6
  s_cbranch_scc1 L_b308
  s_waitcnt vmcnt(5)
  s_cmp_ge_i32 s101, 3
  s_cbranch_scc1 L_b308
  s_waitcnt vmcnt(4)
L_b308:
  buffer_load_dwordx4 v[160:163], v0, s[12:15], s48 offen offset:3072 nt
  s_or_b32 s48, s48, 40960
  s_add_u32 s48, s48, 4096
  s_and_b32 s48, s48, 1003520
  v_mfma_f32_4x4x4_16b_bf16 v[60:63], v[46:47], v[132:133], v[60:63] cbsz:2 abid:0
  v_mfma_f32_4x4x4_16b_bf16 v[64:67], v[46:47], v[134:135], v[64:67] cbsz:2 abid:0
  v_mfma_f32_4x4x4_16b_bf16 v[76:79], v[48:49], a[32:33], v[76:79] cbsz:2 abid:0
  v_mfma_f32_4x4x4_16b_bf16 v[80:83], v[48:49], a[34:35], v[80:83] cbsz:2 abid:0
  v_and_b32_dpp v44, v31, v12 quad_perm:[2,2,2,2] row_mask:0xf bank_mask:0xf
  v_and_b32_dpp v45, v31, v13 quad_perm:[2,2,2,2] row_mask:0xf bank_mask:0xf
  s_waitcnt vmcnt(6)
  s_cmp_ge_i32 s101, 8
  s_cbranch_scc1 L_b309
  s_waitcnt vmcnt(5)
  s_cmp_ge_i32 s101, 5
  s_cbranch_scc1 L_b309
  s_waitcnt vmcnt(4)
L_b309:
  buffer_load_dwordx4 v[164:167], v0, s[12:15], s48 offen offset:0 nt
  v_mfma_f32_4x4x4_16b_bf16 v[60:63], v[46:47], v[136:137], v[60:63] cbsz:2 abid:1
  v_mfma_f32_4x4x4_16b_bf16 v[64:67], v[46:47], v[138:139], v[64:67] cbsz:2 abid:1
  v_mfma_f32_4x4x4_16b_bf16 v[76:79], v[48:49], a[36:37], v[76:79] cbsz:2 abid:0
  v_mfma_f32_4x4x4_16b_bf16 v[80:83], v[48:49], a[38:39], v[80:83] cbsz:2 abid:0
  s_waitcnt vmcnt(6)
  s_cmp_ge_i32 s101, 7
  s_cbranch_scc1 L_b310
  s_waitcnt vmcnt(5)
  s_cmp_ge_i32 s101, 4
  s_cbranch_scc1 L_b310
  s_waitcnt vmcnt(4)
L_b310:
  buffer_load_dwordx4 v[168:171], v0, s[12:15], s48 offen offset:1024 nt
  v_mfma_f32_4x4x4_16b_bf16 v[60:63], v[46:47], v[140:141], v[60:63] cbsz:2 abid:2
  v_mfma_f32_4x4x4_16b_bf16 v[64:67], v[46:47], v[142:143], v[64:67] cbsz:2 abid:2
  v_mfma_f32_4x4x4_16b_bf16 v[76:79], v[48:49], a[40:41], v[76:79] cbsz:2 abid:0
  v_mfma_f32_4x4x4_16b_bf16 v[80:83], v[48:49], a[42:43], v[80:83] cbsz:2 abid:0
  s_waitcnt vmcnt(6)
  s_cmp_ge_i32 s101, 8
  s_cbranch_scc1 L_b311
  s_waitcnt vmcnt(5)
  s_cmp_ge_i32 s101, 5
  s_cbranch_scc1 L_b311
  s_waitcnt vmcnt(4)
L_b311:
  buffer_load_dwordx4 v[172:175], v0, s[12:15], s48 offen offset:2048 nt
  v_mfma_f32_4x4x4_16b_bf16 v[60:63], v[46:47], v[144:145], v[60:63] cbsz:2 abid:3
  v_mfma_f32_4x4x4_16b_bf16 v[64:67], v[46:47], v[146:147], v[64:67] cbsz:2 abid:3
  v_mfma_f32_4x4x4_16b_bf16 v[76:79], v[48:49], a[44:45], v[76:79] cbsz:2 abid:0
  v_mfma_f32_4x4x4_16b_bf16 v[80:83], v[48:49], a[46:47], v[80:83] cbsz:2 abid:0
  s_waitcnt vmcnt(6)
  s_cmp_ge_i32 s101, 6
  s_cbranch_scc1 L_b312
  s_waitcnt vmcnt(5)
  s_cmp_ge_i32 s101, 2
  s_cbranch_scc1 L_b312
  s_waitcnt vmcnt(4)
L_b312:
  buffer_load_dwordx4 v[176:179], v0, s[12:15], s48 offen offset:3072 nt
  s_or_b32 s48, s48, 40960
  s_add_u32 s48, s48, 4096
  s_and_b32 s48, s48, 1003520
  v_mfma_f32_4x4x4_16b_bf16 v[60:63], v[44:45], v[148:149], v[60:63] cbsz:2 abid:0
  v_mfma_f32_4x4x4_16b_bf16 v[64:67], v[44:45], v[150:151], v[64:67] cbsz:2 abid:0
  v_mfma_f32_4x4x4_16b_bf16 v[76:79], v[48:49], a[48:49], v[76:79] cbsz:2 abid:0
  v_mfma_f32_4x4x4_16b_bf16 v[80:83], v[48:49], a[50:51], v[80:83] cbsz:2 abid:0
  v_and_b32_dpp v46, v31, v12 quad_perm:[3,3,3,3] row_mask:0xf bank_mask:0xf
  v_and_b32_dpp v47, v31, v13 quad_perm:[3,3,3,3] row_mask:0xf bank_mask:0xf
  s_waitcnt vmcnt(6)
  s_cmp_ge_i32 s101, 8
  s_cbranch_scc1 L_b313
  s_waitcnt vmcnt(5)
  s_cmp_ge_i32 s101, 5
  s_cbranch_scc1 L_b313
  s_waitcnt vmcnt(4)
L_b313:
  buffer_load_dwordx4 v[180:183], v2, s[12:15], s48 offen offset:0 nt
  v_mfma_f32_4x4x4_16b_bf16 v[60:63], v[44:45], v[152:153], v[60:63] cbsz:2 abid:1
  v_mfma_f32_4x4x4_16b_bf16 v[64:67], v[44:45], v[154:155], v[64:67] cbsz:2 abid:1
  v_mfma_f32_4x4x4_16b_bf16 v[76:79], v[48:49], a[52:53], v[76:79] cbsz:2 abid:0
  v_mfma_f32_4x4x4_16b_bf16 v[80:83], v[48:49], a[54:55], v[80:83] cbsz:2 abid:0
  s_waitcnt vmcnt(6)
  s_cmp_ge_i32 s101, 7
  s_cbranch_scc1 L_b314
  s_waitcnt vmcnt(5)
  s_cmp_ge_i32 s101, 4
  s_cbranch_scc1 L_b314
  s_waitcnt vmcnt(4)
L_b314:
  buffer_load_dwordx4 v[184:187], v2, s[12:15], s48 offen offset:1024 nt
  v_mfma_f32_4x4x4_16b_bf16 v[60:63], v[44:45], v[156:157], v[60:63] cbsz:2 abid:2
  v_mfma_f32_4x4x4_16b_bf16 v[64:67], v[44:45], v[158:159], v[64:67] cbsz:2 abid:2
  v_mfma_f32_4x4x4_16b_bf16 v[76:79], v[48:49], a[56:57], v[76:79] cbsz:2 abid:0
  v_mfma_f32_4x4x4_16b_bf16 v[80:83], v[48:49], a[58:59], v[80:83] cbsz:2 abid:0
  s_waitcnt vmcnt(6)
  s_cmp_ge_i32 s101, 8
  s_cbranch_scc1 L_b315
  s_waitcnt vmcnt(5)
  s_cmp_ge_i32 s101, 5
  s_cbranch_scc1 L_b315
  s_waitcnt vmcnt(4)
L_b315:
  buffer_load_dwordx4 v[188:191], v2, s[12:15], s48 offen offset:2048 nt
  v_mfma_f32_4x4x4_16b_bf16 v[60:63], v[44:45], v[160:161], v[60:63] cbsz:2 abid:3
  v_mfma_f32_4x4x4_16b_bf16 v[64:67], v[44:45], v[162:163], v[64:67] cbsz:2 abid:3
  v_mfma_f32_4x4x4_16b_bf16 v[76:79], v[48:49], a[60:61], v[76:79] cbsz:2 abid:0
  v_mfma_f32_4x4x4_16b_bf16 v[80:83], v[48:49], a[62:63], v[80:83] cbsz:2 abid:0
  s_waitcnt vmcnt(6)
  s_cmp_ge_i32 s101, 6
  s_cbranch_scc1 L_b316
  s_waitcnt vmcnt(5)
  s_cmp_ge_i32 s101, 3
  s_cbranch_scc1 L_b316
  s_waitcnt vmcnt(4)
L_b316:
  buffer_load_dwordx4 v[96:99], v2, s[12:15], s48 offen offset:3072 nt
  s_or_b32 s48, s48, 40960
  s_add_u32 s48, s48, 4096
  s_and_b32 s48, s48, 1003520
  v_mfma_f32_4x4x4_16b_bf16 v[60:63], v[46:47], v[164:165], v[60:63] cbsz:2 abid:0
  v_mfma_f32_4x4x4_16b_bf16 v[64:67], v[46:47], v[166:167], v[64:67] cbsz:2 abid:0
  v_mfma_f32_4x4x4_16b_bf16 v[76:79], v[48:49], a[64:65], v[76:79] cbsz:2 abid:0
  v_mfma_f32_4x4x4_16b_bf16 v[80:83], v[48:49], a[66:67], v[80:83] cbsz:2 abid:0
  v_and_b32_dpp v44, v32, v12 quad_perm:[0,0,0,0] row_mask:0xf bank_mask:0xf
  v_and_b32_dpp v45, v32, v13 quad_perm:[0,0,0,0] row_mask:0xf bank_mask:0xf
  s_waitcnt vmcnt(6)
  s_cmp_ge_i32 s101, 8
  s_cbranch_scc1 L_b317
  s_waitcnt vmcnt(5)
  s_cmp_ge_i32 s101, 5
  s_cbranch_scc1 L_b317
  s_waitcnt vmcnt(4)
L_b317:
  buffer_load_dwordx4 v[100:103], v2, s[12:15], s48 offen offset:0 nt
  v_mfma_f32_4x4x4_16b_bf16 v[60:63], v[46:47], v[168:169], v[60:63] cbsz:2 abid:1
  v_mfma_f32_4x4x4_16b_bf16 v[64:67], v[46:47], v[170:171], v[64:67] cbsz:2 abid:1
  v_mfma_f32_4x4x4_16b_bf16 v[76:79], v[48:49], a[68:69], v[76:79] cbsz:2 abid:0
  v_mfma_f32_4x4x4_16b_bf16 v[80:83], v[48:49], a[70:71], v[80:83] cbsz:2 abid:0
  s_waitcnt vmcnt(6)
  s_cmp_ge_i32 s101, 7
  s_cbranch_scc1 L_b318
  s_waitcnt vmcnt(5)
  s_cmp_ge_i32 s101, 4
  s_cbranch_scc1 L_b318
  s_waitcnt vmcnt(4)
L_b318:
  buffer_load_dwordx4 v[104:107], v2, s[12:15], s48 offen offset:1024 nt
  v_mfma_f32_4x4x4_16b_bf16 v[60:63], v[46:47], v[172:173], v[60:63] cbsz:2 abid:2
  v_mfma_f32_4x4x4_16b_bf16 v[64:67], v[46:47], v[174:175], v[64:67] cbsz:2 abid:2
  v_mfma_f32_4x4x4_16b_bf16 v[76:79], v[48:49], a[72:73], v[76:79] cbsz:2 abid:0
  v_mfma_f32_4x4x4_16b_bf16 v[80:83], v[48:49], a[74:75], v[80:83] cbsz:2 abid:0
  s_waitcnt vmcnt(6)
  s_cmp_ge_i32 s101, 8
  s_cbranch_scc1 L_b319
  s_waitcnt vmcnt(5)
  s_cmp_ge_i32 s101, 5
  s_cbranch_scc1 L_b319
  s_waitcnt vmcnt(4)
L_b319:
  buffer_load_dwordx4 v[108:111], v2, s[12:15], s48 offen offset:2048 nt
  v_mfma_f32_4x4x4_16b_bf16 v[60:63], v[46:47], v[176:177], v[60:63] cbsz:2 abid:3
  v_mfma_f32_4x4x4_16b_bf16 v[64:67], v[46:47], v[178:179], v[64:67] cbsz:2 abid:3
  v_mfma_f32_4x4x4_16b_bf16 v[76:79], v[48:49], a[76:77], v[76:79] cbsz:2 abid:0
  v_mfma_f32_4x4x4_16b_bf16 v[80:83], v[48:49], a[78:79], v[80:83] cbsz:2 abid:0
  s_waitcnt vmcnt(6)
  s_memrealtime s[80:81]
L_blk20:
  s_cmp_ge_i32 s101, 6
  s_cbranch_scc1 L_b320
  s_waitcnt vmcnt(5)
  s_cmp_ge_i32 s101, 1
  s_cbranch_scc1 L_b320
  s_waitcnt vmcnt(4)
L_b320:
  buffer_load_dwordx4 v[112:115], v2, s[12:15], s48 offen offset:3072 nt
  s_or_b32 s48, s48, 40960
  s_add_u32 s48, s48, 4096
  s_and_b32 s48, s48, 1003520
  v_mfma_f32_4x4x4_16b_bf16 v[60:63], v[44:45], v[180:181], v[60:63] cbsz:2 abid:0
  v_mfma_f32_4x4x4_16b_bf16 v[64:67], v[44:45], v[182:183], v[64:67] cbsz:2 abid:0
  v_mfma_f32_4x4x4_16b_bf16 v[76:79], v[48:49], a[80:81], v[76:79] cbsz:2 abid:0
  v_mfma_f32_4x4x4_16b_bf16 v[80:83], v[48:49], a[82:83], v[80:83] cbsz:2 abid:0
  v_and_b32_dpp v46, v32, v12 quad_perm:[1,1,1,1] row_mask:0xf bank_mask:0xf
  v_and_b32_dpp v47, v32, v13 quad_perm:[1,1,1,1] row_mask:0xf bank_mask:0xf
  s_waitcnt vmcnt(6)
  s_cmp_ge_i32 s101, 8
  s_cbranch_scc1 L_b321
  s_waitcnt vmcnt(5)
  s_cmp_ge_i32 s101, 5
  s_cbranch_scc1 L_b321
  s_waitcnt vmcnt(4)
L_b321:
  buffer_load_dwordx4 v[116:119], v2, s[12:15], s48 offen offset:0 nt
  v_mfma_f32_4x4x4_16b_bf16 v[60:63], v[44:45], v[184:185], v[60:63] cbsz:2 abid:1
  v_mfma_f32_4x4x4_16b_bf16 v[64:67], v[44:45], v[186:187], v[64:67] cbsz:2 abid:1
  v_mfma_f32_4x4x4_16b_bf16 v[76:79], v[48:49], a[84:85], v[76:79] cbsz:2 abid:0
  v_mfma_f32_4x4x4_16b_bf16 v[80:83], v[48:49], a[86:87], v[80:83] cbsz:2 abid:0
  s_waitcnt vmcnt(6)
  s_waitcnt lgkmcnt(0)
  s_sub_u32 s101, s80, s84
  s_sub_i32 s101, s101, 4713
  s_mul_i32 s101, s101, 2184
  s_ashr_i32 s101, s101, 16
  s_cmp_ge_i32 s101, 7
  s_cbranch_scc1 L_b322
  s_waitcnt vmcnt(5)
  s_cmp_ge_i32 s101, 4
  s_cbranch_scc1 L_b322
  s_waitcnt vmcnt(4)
L_b322:
  buffer_load_dwordx4 v[120:123], v2, s[12:15], s48 offen offset:1024 nt
  v_mfma_f32_4x4x4_16b_bf16 v[60:63], v[44:45], v[188:189], v[60:63] cbsz:2 abid:2
  v_mfma_f32_4x4x4_16b_bf16 v[64:67], v[44:45], v[190:191], v[64:67] cbsz:2 abid:2
  v_mfma_f32_4x4x4_16b_bf16 v[76:79], v[48:49], a[88:89], v[76:79] cbsz:2 abid:0
  v_mfma_f32_4x4x4_16b_bf16 v[80:83], v[48:49], a[90:91], v[80:83] cbsz:2 abid:0
  s_waitcnt vmcnt(6)
  s_mov_b32 s82, L_blk23-L_pc
  s_load_dword s83, s[78:79], s82 offset:0
  s_load_dword s83, s[78:79], s82 offset:512
  s_load_dword s83, s[78:79], s82 offset:1024
  s_cmp_ge_i32 s101, 8
  s_cbranch_scc1 L_b323
  s_waitcnt vmcnt(5)
  s_cmp_ge_i32 s101, 5
  s_cbranch_scc1 L_b323
  s_waitcnt vmcnt(4)
L_b323:
  buffer_load_dwordx4 v[124:127], v2, s[12:15], s48 offen offset:2048 nt
  v_mfma_f32_4x4x4_16b_bf16 v[60:63], v[44:45], v[96:97], v[60:63] cbsz:2 abid:3
  v_mfma_f32_4x4x4_16b_bf16 v[64:67], v[44:45], v[98:99], v[64:67] cbsz:2 abid:3
  v_mfma_f32_4x4x4_16b_bf16 v[76:79], v[48:49], a[92:93], v[76:79] cbsz:2 abid:0
  v_mfma_f32_4x4x4_16b_bf16 v[80:83], v[48:49], a[94:95], v[80:83] cbsz:2 abid:0
  s_waitcnt vmcnt(6)
  s_cmp_ge_i32 s101, 6
  s_cbranch_scc1 L_b324
  s_waitcnt vmcnt(5)
  s_cmp_ge_i32 s101, 3
  s_cbranch_scc1 L_b324
  s_waitcnt vmcnt(4)
L_b324:
  buffer_load_dwordx4 v[128:131], v2, s[12:15], s48 offen offset:3072 nt
  s_or_b32 s48, s48, 40960
  s_add_u32 s48, s48, 4096
  s_and_b32 s48, s48, 1003520
  v_mfma_f32_4x4x4_16b_bf16 v[60:63], v[46:47], v[100:101], v[60:63] cbsz:2 abid:0
  v_mfma_f32_4x4x4_16b_bf16 v[64:67], v[46:47], v[102:103], v[64:67] cbsz:2 abid:0
  v_mfma_f32_4x4x4_16b_bf16 v[76:79], v[48:49], a[96:97], v[76:79] cbsz:2 abid:0
  v_mfma_f32_4x4x4_16b_bf16 v[80:83], v[48:49], a[98:99], v[80:83] cbsz:2 abid:0
  v_and_b32_dpp v44, v32, v12 quad_perm:[2,2,2,2] row_mask:0xf bank_mask:0xf
  v_and_b32_dpp v45, v32, v13 quad_perm:[2,2,2,2] row_mask:0xf bank_mask:0xf
  s_waitcnt vmcnt(6)
  s_cmp_ge_i32 s101, 8
  s_cbranch_scc1 L_b325
  s_waitcnt vmcnt(5)
  s_cmp_ge_i32 s101, 5
  s_cbranch_scc1 L_b325
  s_waitcnt vmcnt(4)
L_b325:
  buffer_load_dwordx4 v[132:135], v2, s[12:15], s48 offen offset:0 nt
  v_mfma_f32_4x4x4_16b_bf16 v[60:63], v[46:47], v[104:105], v[60:63] cbsz:2 abid:1
  v_mfma_f32_4x4x4_16b_bf16 v[64:67], v[46:47], v[106:107], v[64:67] cbsz:2 abid:1
  v_mfma_f32_4x4x4_16b_bf16 v[76:79], v[48:49], a[100:101], v[76:79] cbsz:2 abid:0
  v_mfma_f32_4x4x4_16b_bf16 v[80:83], v[48:49], a[102:103], v[80:83] cbsz:2 abid:0
  s_waitcnt vmcnt(6)
  s_cmp_ge_i32 s101, 7
  s_cbranch_scc1 L_b326
  s_waitcnt vmcnt(5)
  s_cmp_ge_i32 s101, 4
  s_cbranch_scc1 L_b326
  s_waitcnt vmcnt(4)
L_b326:
  buffer_load_dwordx4 v[136:139], v2, s[12:15], s48 offen offset:1024 nt
  v_mfma_f32_4x4x4_16b_bf16 v[60:63], v[46:47], v[108:109], v[60:63] cbsz:2 abid:2
  v_mfma_f32_4x4x4_16b_bf16 v[64:67], v[46:47], v[110:111], v[64:67] cbsz:2 abid:2
  v_mfma_f32_4x4x4_16b_bf16 v[76:79], v[48:49], a[104:105], v[76:79] cbsz:2 abid:0
  v_mfma_f32_4x4x4_16b_bf16 v[80:83], v[48:49], a[106:107], v[80:83] cbsz:2 abid:0
  s_waitcnt vmcnt(6)
  s_cmp_ge_i32 s101, 8
  s_cbranch_scc1 L_b327
  s_waitcnt vmcnt(5)
  s_cmp_ge_i32 s101, 5
  s_cbranch_scc1 L_b327
  s_waitcnt vmcnt(4)
L_b327:
  buffer_load_dwordx4 v[140:143], v2, s[12:15], s48 offen offset:2048 nt
  v_mfma_f32_4x4x4_16b_bf16 v[60:63], v[46:47], v[112:113], v[60:63] cbsz:2 abid:3
  v_mfma_f32_4x4x4_16b_bf16 v[64:67], v[46:47], v[114:115], v[64:67] cbsz:2 abid:3
  v_mfma_f32_4x4x4_16b_bf16 v[76:79], v[48:49], a[108:109], v[76:79] cbsz:2 abid:0
  v_mfma_f32_4x4x4_16b_bf16 v[80:83], v[48:49], a[110:111], v[80:83] cbsz:2 abid:0
  s_waitcnt vmcnt(6)
  s_cmp_ge_i32 s101, 6
  s_cbranch_scc1 L_b328
  s_waitcnt vmcnt(5)
  s_cmp_ge_i32 s101, 2
  s_cbranch_scc1 L_b328
  s_waitcnt vmcnt(4)
L_b328:
  buffer_load_dwordx4 v[144:147], v2, s[12:15], s48 offen offset:3072 nt
  s_or_b32 s48, s48, 40960
  s_add_u32 s48, s48, 4096
  s_and_b32 s48, s48, 1003520
  v_mfma_f32_4x4x4_16b_bf16 v[60:63], v[44:45], v[116:117], v[60:63] cbsz:2 abid:0
  v_mfma_f32_4x4x4_16b_bf16 v[64:67], v[44:45], v[118:119], v[64:67] cbsz:2 abid:0
  v_mfma_f32_4x4x4_16b_bf16 v[76:79], v[48:49], a[112:113], v[76:79] cbsz:2 abid:0
  v_mfma_f32_4x4x4_16b_bf16 v[80:83], v[48:49], a[114:115], v[80:83] cbsz:2 abid:0
  v_and_b32_dpp v46, v32, v12 quad_perm:[3,3,3,3] row_mask:0xf bank_mask:0xf
  v_and_b32_dpp v47, v32, v13 quad_perm:[3,3,3,3] row_mask:0xf bank_mask:0xf
  s_waitcnt vmcnt(6)
  s_cmp_ge_i32 s101, 8
  s_cbranch_scc1 L_b329
  s_waitcnt vmcnt(5)
  s_cmp_ge_i32 s101, 5
  s_cbranch_scc1 L_b329
  s_waitcnt vmcnt(4)
L_b329:
  buffer_load_dwordx4 v[148:151], v2, s[12:15], s48 offen offset:0 nt
  v_mfma_f32_4x4x4_16b_bf16 v[60:63], v[44:45], v[120:121], v[60:63] cbsz:2 abid:1
  v_mfma_f32_4x4x4_16b_bf16 v[64:67], v[44:45], v[122:123], v[64:67] cbsz:2 abid:1
  v_mfma_f32_4x4x4_16b_bf16 v[76:79], v[48:49], a[116:117], v[76:79] cbsz:2 abid:0
  v_mfma_f32_4x4x4_16b_bf16 v[80:83], v[48:49], a[118:119], v[80:83] cbsz:2 abid:0
  s_waitcnt vmcnt(6)
  s_cmp_ge_i32 s101, 7
  s_cbranch_scc1 L_b330
  s_waitcnt vmcnt(5)
  s_cmp_ge_i32 s101, 4
  s_cbranch_scc1 L_b330
  s_waitcnt vmcnt(4)
L_b330:
  buffer_load_dwordx4 v[152:155], v2, s[12:15], s48 offen offset:1024 nt
  v_mfma_f32_4x4x4_16b_bf16 v[60:63], v[44:45], v[124:125], v[60:63] cbsz:2 abid:2
  v_mfma_f32_4x4x4_16b_bf16 v[64:67], v[44:45], v[126:127], v[64:67] cbsz:2 abid:2
  v_mfma_f32_4x4x4_16b_bf16 v[76:79], v[48:49], a[120:121], v[76:79] cbsz:2 abid:0
  v_mfma_f32_4x4x4_16b_bf16 v[80:83], v[48:49], a[122:123], v[80:83] cbsz:2 abid:0
  s_waitcnt vmcnt(6)
  s_cmp_ge_i32 s101, 8
  s_cbranch_scc1 L_b331
  s_waitcnt vmcnt(5)
  s_cmp_ge_i32 s101, 5
  s_cbranch_scc1 L_b331
  s_waitcnt vmcnt(4)
L_b331:
  buffer_load_dwordx4 v[156:159], v2, s[12:15], s48 offen offset:2048 nt
  v_mfma_f32_4x4x4_16b_bf16 v[60:63], v[44:45], v[128:129], v[60:63] cbsz:2 abid:3
  v_mfma_f32_4x4x4_16b_bf16 v[64:67], v[44:45], v[130:131], v[64:67] cbsz:2 abid:3
  v_mfma_f32_4x4x4_16b_bf16 v[76:79], v[48:49], a[124:125], v[76:79] cbsz:2 abid:0
  v_mfma_f32_4x4x4_16b_bf16 v[80:83], v[48:49], a[126:127], v[80:83] cbsz:2 abid:0
  s_waitcnt vmcnt(6)
  s_cmp_ge_i32 s101, 6
  s_cbranch_scc1 L_b332
  s_waitcnt vmcnt(5)
  s_cmp_ge_i32 s101, 3
  s_cbranch_scc1 L_b332
  s_waitcnt vmcnt(4)
L_b332:
  buffer_load_dwordx4 v[160:163], v2, s[12:15], s48 offen offset:3072 nt
  s_or_b32 s48, s48, 40960
  s_add_u32 s48, s48, 4096
  s_and_b32 s48, s48, 1003520
  v_mfma_f32_4x4x4_16b_bf16 v[60:63], v[46:47], v[132:133], v[60:63] cbsz:2 abid:0
  v_mfma_f32_4x4x4_16b_bf16 v[64:67], v[46:47], v[134:135], v[64:67] cbsz:2 abid:0
  v_and_b32_dpp v44, v33, v12 quad_perm:[0,0,0,0] row_mask:0xf bank_mask:0xf
  v_and_b32_dpp v45, v33, v13 quad_perm:[0,0,0,0] row_mask:0xf bank_mask:0xf
  s_waitcnt vmcnt(6)
  s_cmp_ge_i32 s101, 8
  s_cbranch_scc1 L_b333
  s_waitcnt vmcnt(5)
  s_cmp_ge_i32 s101, 5
  s_cbranch_scc1 L_b333
  s_waitcnt vmcnt(4)
L_b333:
  buffer_load_dwordx4 v[164:167], v2, s[12:15], s48 offen offset:0 nt
  v_mfma_f32_4x4x4_16b_bf16 v[60:63], v[46:47], v[136:137], v[60:63] cbsz:2 abid:1
  v_mfma_f32_4x4x4_16b_bf16 v[64:67], v[46:47], v[138:139], v[64:67] cbsz:2 abid:1
  v_permlane32_swap_b32 v76, v80
  v_permlane32_swap_b32 v77, v81
  v_permlane32_swap_b32 v78, v82
  v_permlane32_swap_b32 v79, v83
  v_add_f32 v76, v76, v80
  v_add_f32 v77, v77, v81
  v_add_f32 v78, v78, v82
  v_add_f32 v79, v79, v83
  s_nop 0
  v_permlane16_swap_b32 v76, v78
  v_permlane16_swap_b32 v77, v79
  v_add_f32 v68, v76, v78
  v_add_f32 v69, v77, v79
  ds_write_b64 v11, v[68:69] offset:8192
  s_waitcnt vmcnt(6)
  s_cmp_ge_i32 s101, 7
  s_cbranch_scc1 L_b334
  s_waitcnt vmcnt(5)
  s_cmp_ge_i32 s101, 4
  s_cbranch_scc1 L_b334
  s_waitcnt vmcnt(4)
L_b334:
  buffer_load_dwordx4 v[168:171], v2, s[12:15], s48 offen offset:1024 nt
  v_mfma_f32_4x4x4_16b_bf16 v[60:63], v[46:47], v[140:141], v[60:63] cbsz:2 abid:2
  v_mfma_f32_4x4x4_16b_bf16 v[64:67], v[46:47], v[142:143], v[64:67] cbsz:2 abid:2
  s_waitcnt vmcnt(6)
  s_cmp_ge_i32 s101, 8
  s_cbranch_scc1 L_b335
  s_waitcnt vmcnt(5)
  s_cmp_ge_i32 s101, 5
  s_cbranch_scc1 L_b335
  s_waitcnt vmcnt(4)
L_b335:
  buffer_load_dwordx4 v[172:175], v2, s[12:15], s48 offen offset:2048 nt
  v_mfma_f32_4x4x4_16b_bf16 v[60:63], v[46:47], v[144:145], v[60:63] cbsz:2 abid:3
  v_mfma_f32_4x4x4_16b_bf16 v[64:67], v[46:47], v[146:147], v[64:67] cbsz:2 abid:3
  s_waitcnt vmcnt(6)
  s_memrealtime s[80:81]
L_blk21:
  s_cmp_ge_i32 s101, 6
  s_cbranch_scc1 L_b336
  s_waitcnt vmcnt(5)
  s_cmp_ge_i32 s101, 1
  s_cbranch_scc1 L_b336
  s_waitcnt vmcnt(4)
L_b336:
  buffer_load_dwordx4 v[176:179], v2, s[12:15], s48 offen offset:3072 nt
  s_or_b32 s48, s48, 40960
  s_add_u32 s48, s48, 4096
  s_and_b32 s48, s48, 1003520
  v_mfma_f32_4x4x4_16b_bf16 v[60:63], v[44:45], v[148:149], v[60:63] cbsz:2 abid:0
  v_mfma_f32_4x4x4_16b_bf16 v[64:67], v[44:45], v[150:151], v[64:67] cbsz:2 abid:0
  v_and_b32_dpp v46, v33, v12 quad_perm:[1,1,1,1] row_mask:0xf bank_mask:0xf
  v_and_b32_dpp v47, v33, v13 quad_perm:[1,1,1,1] row_mask:0xf bank_mask:0xf
  s_waitcnt vmcnt(6)
  s_cmp_ge_i32 s101, 8
  s_cbranch_scc1 L_b337
  s_waitcnt vmcnt(5)
  s_cmp_ge_i32 s101, 5
  s_cbranch_scc1 L_b337
  s_waitcnt vmcnt(4)
L_b337:
  buffer_load_dwordx4 v[180:183], v2, s[12:15], s48 offen offset:0 nt
  v_mfma_f32_4x4x4_16b_bf16 v[60:63], v[44:45], v[152:153], v[60:63] cbsz:2 abid:1
  v_mfma_f32_4x4x4_16b_bf16 v[64:67], v[44:45], v[154:155], v[64:67] cbsz:2 abid:1
  s_waitcnt vmcnt(6)
  s_waitcnt lgkmcnt(0)
  s_sub_u32 s101, s80, s84
  s_sub_i32 s101, s101, 4931
  s_mul_i32 s101, s101, 2184
  s_ashr_i32 s101, s101, 16
  s_cmp_ge_i32 s101, 7
  s_cbranch_scc1 L_b338
  s_waitcnt vmcnt(5)
  s_cmp_ge_i32 s101, 4
  s_cbranch_scc1 L_b338
  s_waitcnt vmcnt(4)
L_b338:
  buffer_load_dwordx4 v[184:187], v2, s[12:15], s48 offen offset:1024 nt
  v_mfma_f32_4x4x4_16b_bf16 v[60:63], v[44:45], v[156:157], v[60:63] cbsz:2 abid:2
  v_mfma_f32_4x4x4_16b_bf16 v[64:67], v[44:45], v[158:159], v[64:67] cbsz:2 abid:2
  s_waitcnt vmcnt(6)
  s_mov_b32 s82, L_blk24-L_pc
  s_load_dword s83, s[78:79], s82 offset:0
  s_load_dword s83, s[78:79], s82 offset:512
  s_load_dword s83, s[78:79], s82 offset:1024
  s_cmp_ge_i32 s101, 8
  s_cbranch_scc1 L_b339
  s_waitcnt vmcnt(5)
  s_cmp_ge_i32 s101, 5
  s_cbranch_scc1 L_b339
  s_waitcnt vmcnt(4)
L_b339:
  buffer_load_dwordx4 v[188:191], v2, s[12:15], s48 offen offset:2048 nt
  v_mfma_f32_4x4x4_16b_bf16 v[60:63], v[44:45], v[160:161], v[60:63] cbsz:2 abid:3
  v_mfma_f32_4x4x4_16b_bf16 v[64:67], v[44:45], v[162:163], v[64:67] cbsz:2 abid:3
  s_waitcnt vmcnt(6)
  s_cmp_ge_i32 s101, 6
  s_cbranch_scc1 L_b340
  s_waitcnt vmcnt(5)
  s_cmp_ge_i32 s101, 3
  s_cbranch_scc1 L_b340
  s_waitcnt vmcnt(4)
L_b340:
  buffer_load_dwordx4 v[96:99], v2, s[12:15], s48 offen offset:3072 nt
  s_or_b32 s48, s48, 40960
  s_add_u32 s48, s48, 4096
  s_and_b32 s48, s48, 1003520
  v_mfma_f32_4x4x4_16b_bf16 v[60:63], v[46:47], v[164:165], v[60:63] cbsz:2 abid:0
  v_mfma_f32_4x4x4_16b_bf16 v[64:67], v[46:47], v[166:167], v[64:67] cbsz:2 abid:0
  v_and_b32_dpp v44, v33, v12 quad_perm:[2,2,2,2] row_mask:0xf bank_mask:0xf
  v_and_b32_dpp v45, v33, v13 quad_perm:[2,2,2,2] row_mask:0xf bank_mask:0xf
  s_waitcnt vmcnt(6)
  s_cmp_ge_i32 s101, 8
  s_cbranch_scc1 L_b341
  s_waitcnt vmcnt(5)
  s_cmp_ge_i32 s101, 5
  s_cbranch_scc1 L_b341
  s_waitcnt vmcnt(4)
L_b341:
  buffer_load_dwordx4 v[100:103], v2, s[12:15], s48 offen offset:0 nt
  v_mfma_f32_4x4x4_16b_bf16 v[60:63], v[46:47], v[168:169], v[60:63] cbsz:2 abid:1
  v_mfma_f32_4x4x4_16b_bf16 v[64:67], v[46:47], v[170:171], v[64:67] cbsz:2 abid:1
  s_waitcnt vmcnt(6)
  s_cmp_ge_i32 s101, 7
  s_cbranch_scc1 L_b342
  s_waitcnt vmcnt(5)
  s_cmp_ge_i32 s101, 4
  s_cbranch_scc1 L_b342
  s_waitcnt vmcnt(4)
L_b342:
  buffer_load_dwordx4 v[104:107], v2, s[12:15], s48 offen offset:1024 nt
  v_mfma_f32_4x4x4_16b_bf16 v[60:63], v[46:47], v[172:173], v[60:63] cbsz:2 abid:2
  v_mfma_f32_4x4x4_16b_bf16 v[64:67], v[46:47], v[174:175], v[64:67] cbsz:2 abid:2
  s_waitcnt vmcnt(6)
  s_cmp_ge_i32 s101, 8
  s_cbranch_scc1 L_b343
  s_waitcnt vmcnt(5)
  s_cmp_ge_i32 s101, 5
  s_cbranch_scc1 L_b343
  s_waitcnt vmcnt(4)
L_b343:
  buffer_load_dwordx4 v[108:111], v2, s[12:15], s48 offen offset:2048 nt
  v_mfma_f32_4x4x4_16b_bf16 v[60:63], v[46:47], v[176:177], v[60:63] cbsz:2 abid:3
  v_mfma_f32_4x4x4_16b_bf16 v[64:67], v[46:47], v[178:179], v[64:67] cbsz:2 abid:3
  s_waitcnt vmcnt(6)
  s_cmp_ge_i32 s101, 6
  s_cbranch_scc1 L_b344
  s_waitcnt vmcnt(5)
  s_cmp_ge_i32 s101, 2
  s_cbranch_scc1 L_b344
  s_waitcnt vmcnt(4)
L_b344:
  buffer_load_dwordx4 v[112:115], v2, s[12:15], s48 offen offset:3072 nt
  s_or_b32 s48, s48, 40960
  s_add_u32 s48, s48, 4096
  s_and_b32 s48, s48, 1003520
  v_mfma_f32_4x4x4_16b_bf16 v[60:63], v[44:45], v[180:181], v[60:63] cbsz:2 abid:0
  v_mfma_f32_4x4x4_16b_bf16 v[64:67], v[44:45], v[182:183], v[64:67] cbsz:2 abid:0
  v_and_b32_dpp v46, v33, v12 quad_perm:[3,3,3,3] row_mask:0xf bank_mask:0xf
  v_and_b32_dpp v47, v33, v13 quad_perm:[3,3,3,3] row_mask:0xf bank_mask:0xf
  s_waitcnt vmcnt(6)
  s_cmp_ge_i32 s101, 8
  s_cbranch_scc1 L_b345
  s_waitcnt vmcnt(5)
  s_cmp_ge_i32 s101, 5
  s_cbranch_scc1 L_b345
  s_waitcnt vmcnt(4)
L_b345:
  buffer_load_dwordx4 v[116:119], v0, s[12:15], s48 offen offset:0 nt
  v_mfma_f32_4x4x4_16b_bf16 v[60:63], v[44:45], v[184:185], v[60:63] cbsz:2 abid:1
  v_mfma_f32_4x4x4_16b_bf16 v[64:67], v[44:45], v[186:187], v[64:67] cbsz:2 abid:1
  s_waitcnt vmcnt(6)
  s_cmp_ge_i32 s101, 7
  s_cbranch_scc1 L_b346
  s_waitcnt vmcnt(5)
  s_cmp_ge_i32 s101, 4
  s_cbranch_scc1 L_b346
  s_waitcnt vmcnt(4)
L_b346:
  buffer_load_dwordx4 v[120:123], v0, s[12:15], s48 offen offset:1024 nt
  v_mfma_f32_4x4x4_16b_bf16 v[60:63], v[44:45], v[188:189], v[60:63] cbsz:2 abid:2
  v_mfma_f32_4x4x4_16b_bf16 v[64:67], v[44:45], v[190:191], v[64:67] cbsz:2 abid:2
  s_waitcnt vmcnt(6)
  s_cmp_ge_i32 s101, 8
  s_cbranch_scc1 L_b347
  s_waitcnt vmcnt(5)
  s_cmp_ge_i32 s101, 5
  s_cbranch_scc1 L_b347
  s_waitcnt vmcnt(4)
L_b347:
  buffer_load_dwordx4 v[124:127], v0, s[12:15], s48 offen offset:2048 nt
  v_mfma_f32_4x4x4_16b_bf16 v[60:63], v[44:45], v[96:97], v[60:63] cbsz:2 abid:3
  v_mfma_f32_4x4x4_16b_bf16 v[64:67], v[44:45], v[98:99], v[64:67] cbsz:2 abid:3
  s_waitcnt vmcnt(6)
  s_cmp_ge_i32 s101, 6
  s_cbranch_scc1 L_b348
  s_waitcnt vmcnt(5)
  s_cmp_ge_i32 s101, 3
  s_cbranch_scc1 L_b348
  s_waitcnt vmcnt(4)
L_b348:
  buffer_load_dwordx4 v[128:131], v0, s[12:15], s48 offen offset:3072 nt
  s_or_b32 s48, s48, 40960
  s_add_u32 s48, s48, 4096
  s_and_b32 s48, s48, 1003520
  v_mfma_f32_4x4x4_16b_bf16 v[60:63], v[46:47], v[100:101], v[60:63] cbsz:2 abid:0
  v_mfma_f32_4x4x4_16b_bf16 v[64:67], v[46:47], v[102:103], v[64:67] cbsz:2 abid:0
  v_and_b32_dpp v44, v34, v12 quad_perm:[0,0,0,0] row_mask:0xf bank_mask:0xf
  v_and_b32_dpp v45, v34, v13 quad_perm:[0,0,0,0] row_mask:0xf bank_mask:0xf
  s_waitcnt vmcnt(6)
  s_cmp_ge_i32 s101, 8
  s_cbranch_scc1 L_b349
  s_waitcnt vmcnt(5)
  s_cmp_ge_i32 s101, 5
  s_cbranch_scc1 L_b349
  s_waitcnt vmcnt(4)
L_b349:
  buffer_load_dwordx4 v[132:135], v0, s[12:15], s48 offen offset:0 nt
  v_mfma_f32_4x4x4_16b_bf16 v[60:63], v[46:47], v[104:105], v[60:63] cbsz:2 abid:1
  v_mfma_f32_4x4x4_16b_bf16 v[64:67], v[46:47], v[106:107], v[64:67] cbsz:2 abid:1
  s_waitcnt vmcnt(6)
  s_cmp_ge_i32 s101, 7
  s_cbranch_scc1 L_b350
  s_waitcnt vmcnt(5)
  s_cmp_ge_i32 s101, 4
  s_cbranch_scc1 L_b350
  s_waitcnt vmcnt(4)
L_b350:
  buffer_load_dwordx4 v[136:139], v0, s[12:15], s48 offen offset:1024 nt
  v_mfma_f32_4x4x4_16b_bf16 v[60:63], v[46:47], v[108:109], v[60:63] cbsz:2 abid:2
  v_mfma_f32_4x4x4_16b_bf16 v[64:67], v[46:47], v[110:111], v[64:67] cbsz:2 abid:2
  s_waitcnt vmcnt(6)
  s_cmp_ge_i32 s101, 8
  s_cbranch_scc1 L_b351
  s_waitcnt vmcnt(5)
  s_cmp_ge_i32 s101, 5
  s_cbranch_scc1 L_b351
  s_waitcnt vmcnt(4)
L_b351:
  buffer_load_dwordx4 v[140:143], v0, s[12:15], s48 offen offset:2048 nt
  v_mfma_f32_4x4x4_16b_bf16 v[60:63], v[46:47], v[112:113], v[60:63] cbsz:2 abid:3
  v_mfma_f32_4x4x4_16b_bf16 v[64:67], v[46:47], v[114:115], v[64:67] cbsz:2 abid:3
  s_waitcnt vmcnt(6)
  s_memrealtime s[80:81]
L_blk22:
  s_cmp_ge_i32 s101, 6
  s_cbranch_scc1 L_b352
  s_waitcnt vmcnt(5)
  s_cmp_ge_i32 s101, 1
  s_cbranch_scc1 L_b352
  s_waitcnt vmcnt(4)
L_b352:
  buffer_load_dwordx4 v[144:147], v0, s[12:15], s48 offen offset:3072 nt
  s_or_b32 s48, s48, 40960
  s_add_u32 s48, s48, 4096
  s_and_b32 s48, s48, 1003520
  v_mfma_f32_4x4x4_16b_bf16 v[60:63], v[44:45], v[116:117], v[60:63] cbsz:2 abid:0
  v_mfma_f32_4x4x4_16b_bf16 v[64:67], v[44:45], v[118:119], v[64:67] cbsz:2 abid:0
  v_and_b32_dpp v46, v34, v12 quad_perm:[1,1,1,1] row_mask:0xf bank_mask:0xf
  v_and_b32_dpp v47, v34, v13 quad_perm:[1,1,1,1] row_mask:0xf bank_mask:0xf
  s_waitcnt vmcnt(6)
  s_cmp_ge_i32 s101, 8
  s_cbranch_scc1 L_b353
  s_waitcnt vmcnt(5)
  s_cmp_ge_i32 s101, 5
  s_cbranch_scc1 L_b353
  s_waitcnt vmcnt(4)
L_b353:
  buffer_load_dwordx4 v[148:151], v0, s[12:15], s48 offen offset:0 nt
  v_mfma_f32_4x4x4_16b_bf16 v[60:63], v[44:45], v[120:121], v[60:63] cbsz:2 abid:1
  v_mfma_f32_4x4x4_16b_bf16 v[64:67], v[44:45], v[122:123], v[64:67] cbsz:2 abid:1
  s_waitcnt vmcnt(6)
  s_waitcnt lgkmcnt(0)
  s_sub_u32 s101, s80, s84
  s_sub_i32 s101, s101, 5148
  s_mul_i32 s101, s101, 2184
  s_ashr_i32 s101, s101, 16
  s_cmp_ge_i32 s101, 7
  s_cbranch_scc1 L_b354
  s_waitcnt vmcnt(5)
  s_cmp_ge_i32 s101, 4
  s_cbranch_scc1 L_b354
  s_waitcnt vmcnt(4)
L_b354:
  buffer_load_dwordx4 v[152:155], v0, s[12:15], s48 offen offset:1024 nt
  v_mfma_f32_4x4x4_16b_bf16 v[60:63], v[44:45], v[124:125], v[60:63] cbsz:2 abid:2
  v_mfma_f32_4x4x4_16b_bf16 v[64:67], v[44:45], v[126:127], v[64:67] cbsz:2 abid:2
  s_waitcnt vmcnt(6)
  s_mov_b32 s82, L_blk25-L_pc
  s_load_dword s83, s[78:79], s82 offset:0
  s_load_dword s83, s[78:79], s82 offset:512
  s_load_dword s83, s[78:79], s82 offset:1024
  s_cmp_ge_i32 s101, 8
  s_cbranch_scc1 L_b355
  s_waitcnt vmcnt(5)
  s_cmp_ge_i32 s101, 5
  s_cbranch_scc1 L_b355
  s_waitcnt vmcnt(4)
L_b355:
  buffer_load_dwordx4 v[156:159], v0, s[12:15], s48 offen offset:2048 nt
  v_mfma_f32_4x4x4_16b_bf16 v[60:63], v[44:45], v[128:129], v[60:63] cbsz:2 abid:3
  v_mfma_f32_4x4x4_16b_bf16 v[64:67], v[44:45], v[130:131], v[64:67] cbsz:2 abid:3
  s_waitcnt vmcnt(6)
  s_cmp_ge_i32 s101, 6
  s_cbranch_scc1 L_b356
  s_waitcnt vmcnt(5)
  s_cmp_ge_i32 s101, 3
  s_cbranch_scc1 L_b356
  s_waitcnt vmcnt(4)
L_b356:
  buffer_load_dwordx4 v[160:163], v0, s[12:15], s48 offen offset:3072 nt
  s_or_b32 s48, s48, 40960
  s_add_u32 s48, s48, 4096
  s_and_b32 s48, s48, 1003520
  v_mfma_f32_4x4x4_16b_bf16 v[60:63], v[46:47], v[132:133], v[60:63] cbsz:2 abid:0
  v_mfma_f32_4x4x4_16b_bf16 v[64:67], v[46:47], v[134:135], v[64:67] cbsz:2 abid:0
  v_and_b32_dpp v44, v34, v12 quad_perm:[2,2,2,2] row_mask:0xf bank_mask:0xf
  v_and_b32_dpp v45, v34, v13 quad_perm:[2,2,2,2] row_mask:0xf bank_mask:0xf
  s_waitcnt vmcnt(6)
  s_cmp_ge_i32 s101, 8
  s_cbranch_scc1 L_b357
  s_waitcnt vmcnt(5)
  s_cmp_ge_i32 s101, 5
  s_cbranch_scc1 L_b357
  s_waitcnt vmcnt(4)
L_b357:
  buffer_load_dwordx4 v[164:167], v0, s[12:15], s48 offen offset:0 nt
  v_mfma_f32_4x4x4_16b_bf16 v[60:63], v[46:47], v[136:137], v[60:63] cbsz:2 abid:1
  v_mfma_f32_4x4x4_16b_bf16 v[64:67], v[46:47], v[138:139], v[64:67] cbsz:2 abid:1
  s_waitcnt vmcnt(6)
  s_cmp_ge_i32 s101, 7
  s_cbranch_scc1 L_b358
  s_waitcnt vmcnt(5)
  s_cmp_ge_i32 s101, 4
  s_cbranch_scc1 L_b358
  s_waitcnt vmcnt(4)
L_b358:
  buffer_load_dwordx4 v[168:171], v0, s[12:15], s48 offen offset:1024 nt
  v_mfma_f32_4x4x4_16b_bf16 v[60:63], v[46:47], v[140:141], v[60:63] cbsz:2 abid:2
  v_mfma_f32_4x4x4_16b_bf16 v[64:67], v[46:47], v[142:143], v[64:67] cbsz:2 abid:2
  s_waitcnt vmcnt(6)
  s_cmp_ge_i32 s101, 8
  s_cbranch_scc1 L_b359
  s_waitcnt vmcnt(5)
  s_cmp_ge_i32 s101, 5
  s_cbranch_scc1 L_b359
  s_waitcnt vmcnt(4)
L_b359:
  buffer_load_dwordx4 v[172:175], v0, s[12:15], s48 offen offset:2048 nt
  v_mfma_f32_4x4x4_16b_bf16 v[60:63], v[46:47], v[144:145], v[60:63] cbsz:2 abid:3
  v_mfma_f32_4x4x4_16b_bf16 v[64:67], v[46:47], v[146:147], v[64:67] cbsz:2 abid:3
  s_waitcnt vmcnt(6)
  s_cmp_ge_i32 s101, 6
  s_cbranch_scc1 L_b360
  s_waitcnt vmcnt(5)
  s_cmp_ge_i32 s101, 2
  s_cbranch_scc1 L_b360
  s_waitcnt vmcnt(4)
L_b360:
  buffer_load_dwordx4 v[176:179], v0, s[12:15], s48 offen offset:3072 nt
  s_or_b32 s48, s48, 40960
  s_add_u32 s48, s48, 4096
  s_and_b32 s48, s48, 1003520
  v_mfma_f32_4x4x4_16b_bf16 v[60:63], v[44:45], v[148:149], v[60:63] cbsz:2 abid:0
  v_mfma_f32_4x4x4_16b_bf16 v[64:67], v[44:45], v[150:151], v[64:67] cbsz:2 abid:0
  v_and_b32_dpp v46, v34, v12 quad_perm:[3,3,3,3] row_mask:0xf bank_mask:0xf
  v_and_b32_dpp v47, v34, v13 quad_perm:[3,3,3,3] row_mask:0xf bank_mask:0xf
  s_waitcnt vmcnt(6)
  s_cmp_ge_i32 s101, 8
  s_cbranch_scc1 L_b361
  s_waitcnt vmcnt(5)
  s_cmp_ge_i32 s101, 5
  s_cbranch_scc1 L_b361
  s_waitcnt vmcnt(4)
L_b361:
  buffer_load_dwordx4 v[180:183], v0, s[12:15], s48 offen offset:0 nt
  v_mfma_f32_4x4x4_16b_bf16 v[60:63], v[44:45], v[152:153], v[60:63] cbsz:2 abid:1
  v_mfma_f32_4x4x4_16b_bf16 v[64:67], v[44:45], v[154:155], v[64:67] cbsz:2 abid:1
  s_waitcnt vmcnt(6)
  s_cmp_ge_i32 s101, 7
  s_cbranch_scc1 L_b362
  s_waitcnt vmcnt(5)
  s_cmp_ge_i32 s101, 4
  s_cbranch_scc1 L_b362
  s_waitcnt vmcnt(4)
L_b362:
  buffer_load_dwordx4 v[184:187], v0, s[12:15], s48 offen offset:1024 nt
  v_mfma_f32_4x4x4_16b_bf16 v[60:63], v[44:45], v[156:157], v[60:63] cbsz:2 abid:2
  v_mfma_f32_4x4x4_16b_bf16 v[64:67], v[44:45], v[158:159], v[64:67] cbsz:2 abid:2
  s_waitcnt vmcnt(6)
  s_cmp_ge_i32 s101, 8
  s_cbranch_scc1 L_b363
  s_waitcnt vmcnt(5)
  s_cmp_ge_i32 s101, 5
  s_cbranch_scc1 L_b363
  s_waitcnt vmcnt(4)
L_b363:
  buffer_load_dwordx4 v[188:191], v0, s[12:15], s48 offen offset:2048 nt
  v_mfma_f32_4x4x4_16b_bf16 v[60:63], v[44:45], v[160:161], v[60:63] cbsz:2 abid:3
  v_mfma_f32_4x4x4_16b_bf16 v[64:67], v[44:45], v[162:163], v[64:67] cbsz:2 abid:3
  s_waitcnt vmcnt(6)
  s_cmp_ge_i32 s101, 6
  s_cbranch_scc1 L_b364
  s_waitcnt vmcnt(5)
  s_cmp_ge_i32 s101, 3
  s_cbranch_scc1 L_b364
  s_waitcnt vmcnt(4)
L_b364:
  buffer_load_dwordx4 v[96:99], v0, s[12:15], s48 offen offset:3072 nt
  s_or_b32 s48, s48, 40960
  s_add_u32 s48, s48, 4096
  s_and_b32 s48, s48, 1003520
  v_mfma_f32_4x4x4_16b_bf16 v[60:63], v[46:47], v[164:165], v[60:63] cbsz:2 abid:0
  v_mfma_f32_4x4x4_16b_bf16 v[64:67], v[46:47], v[166:167], v[64:67] cbsz:2 abid:0
  v_and_b32_dpp v44, v35, v12 quad_perm:[0,0,0,0] row_mask:0xf bank_mask:0xf
  v_and_b32_dpp v45, v35, v13 quad_perm:[0,0,0,0] row_mask:0xf bank_mask:0xf
  s_waitcnt vmcnt(6)
  s_cmp_ge_i32 s101, 8
  s_cbranch_scc1 L_b365
  s_waitcnt vmcnt(5)
  s_cmp_ge_i32 s101, 5
  s_cbranch_scc1 L_b365
  s_waitcnt vmcnt(4)
L_b365:
  buffer_load_dwordx4 v[100:103], v0, s[12:15], s48 offen offset:0 nt
  v_mfma_f32_4x4x4_16b_bf16 v[60:63], v[46:47], v[168:169], v[60:63] cbsz:2 abid:1
  v_mfma_f32_4x4x4_16b_bf16 v[64:67], v[46:47], v[170:171], v[64:67] cbsz:2 abid:1
  s_waitcnt vmcnt(6)
  s_cmp_ge_i32 s101, 7
  s_cbranch_scc1 L_b366
  s_waitcnt vmcnt(5)
  s_cmp_ge_i32 s101, 4
  s_cbranch_scc1 L_b366
  s_waitcnt vmcnt(4)
L_b366:
  buffer_load_dwordx4 v[104:107], v0, s[12:15], s48 offen offset:1024 nt
  v_mfma_f32_4x4x4_16b_bf16 v[60:63], v[46:47], v[172:173], v[60:63] cbsz:2 abid:2
  v_mfma_f32_4x4x4_16b_bf16 v[64:67], v[46:47], v[174:175], v[64:67] cbsz:2 abid:2
  s_waitcnt vmcnt(6)
  s_cmp_ge_i32 s101, 8
  s_cbranch_scc1 L_b367
  s_waitcnt vmcnt(5)
  s_cmp_ge_i32 s101, 5
  s_cbranch_scc1 L_b367
  s_waitcnt vmcnt(4)
L_b367:
  buffer_load_dwordx4 v[108:111], v0, s[12:15], s48 offen offset:2048 nt
  v_mfma_f32_4x4x4_16b_bf16 v[60:63], v[46:47], v[176:177], v[60:63] cbsz:2 abid:3
  v_mfma_f32_4x4x4_16b_bf16 v[64:67], v[46:47], v[178:179], v[64:67] cbsz:2 abid:3
  s_waitcnt vmcnt(6)
  s_memrealtime s[80:81]
L_blk23:
  s_cmp_ge_i32 s101, 6
  s_cbranch_scc1 L_b368
  s_waitcnt vmcnt(5)
  s_cmp_ge_i32 s101, 1
  s_cbranch_scc1 L_b368
  s_waitcnt vmcnt(4)
L_b368:
  buffer_load_dwordx4 v[112:115], v0, s[12:15], s48 offen offset:3072 nt
  s_or_b32 s48, s48, 40960
  s_add_u32 s48, s48, 4096
  s_and_b32 s48, s48, 1003520
  v_mfma_f32_4x4x4_16b_bf16 v[60:63], v[44:45], v[180:181], v[60:63] cbsz:2 abid:0
  v_mfma_f32_4x4x4_16b_bf16 v[64:67], v[44:45], v[182:183], v[64:67] cbsz:2 abid:0
  v_and_b32_dpp v46, v35, v12 quad_perm:[1,1,1,1] row_mask:0xf bank_mask:0xf
  v_and_b32_dpp v47, v35, v13 quad_perm:[1,1,1,1] row_mask:0xf bank_mask:0xf
  s_waitcnt vmcnt(6)
  s_cmp_ge_i32 s101, 8
  s_cbranch_scc1 L_b369
  s_waitcnt vmcnt(5)
  s_cmp_ge_i32 s101, 5
  s_cbranch_scc1 L_b369
  s_waitcnt vmcnt(4)
L_b369:
  buffer_load_dwordx4 v[116:119], v0, s[12:15], s48 offen offset:0 nt
  v_mfma_f32_4x4x4_16b_bf16 v[60:63], v[44:45], v[184:185], v[60:63] cbsz:2 abid:1
  v_mfma_f32_4x4x4_16b_bf16 v[64:67], v[44:45], v[186:187], v[64:67] cbsz:2 abid:1
  s_waitcnt vmcnt(6)
  s_waitcnt lgkmcnt(0)
  s_sub_u32 s101, s80, s84
  s_sub_i32 s101, s101, 5366
  s_mul_i32 s101, s101, 2184
  s_ashr_i32 s101, s101, 16
  s_cmp_ge_i32 s101, 7
  s_cbranch_scc1 L_b370
  s_waitcnt vmcnt(5)
  s_cmp_ge_i32 s101, 4
  s_cbranch_scc1 L_b370
  s_waitcnt vmcnt(4)
L_b370:
  buffer_load_dwordx4 v[120:123], v0, s[12:15], s48 offen offset:1024 nt
  v_mfma_f32_4x4x4_16b_bf16 v[60:63], v[44:45], v[188:189], v[60:63] cbsz:2 abid:2
  v_mfma_f32_4x4x4_16b_bf16 v[64:67], v[44:45], v[190:191], v[64:67] cbsz:2 abid:2
  s_waitcnt vmcnt(6)
  s_mov_b32 s82, L_blk26-L_pc
  s_load_dword s83, s[78:79], s82 offset:0
  s_load_dword s83, s[78:79], s82 offset:512
  s_load_dword s83, s[78:79], s82 offset:1024
  s_cmp_ge_i32 s101, 8
  s_cbranch_scc1 L_b371
  s_waitcnt vmcnt(5)
  s_cmp_ge_i32 s101, 5
  s_cbranch_scc1 L_b371
  s_waitcnt vmcnt(4)
L_b371:
  buffer_load_dwordx4 v[124:127], v0, s[12:15], s48 offen offset:2048 nt
  v_mfma_f32_4x4x4_16b_bf16 v[60:63], v[44:45], v[96:97], v[60:63] cbsz:2 abid:3
  v_mfma_f32_4x4x4_16b_bf16 v[64:67], v[44:45], v[98:99], v[64:67] cbsz:2 abid:3
  s_waitcnt vmcnt(6)
  s_cmp_ge_i32 s101, 6
  s_cbranch_scc1 L_b372
  s_waitcnt vmcnt(5)
  s_cmp_ge_i32 s101, 3
  s_cbranch_scc1 L_b372
  s_waitcnt vmcnt(4)
L_b372:
  buffer_load_dwordx4 v[128:131], v0, s[12:15], s48 offen offset:3072 nt
  s_or_b32 s48, s48, 40960
  s_add_u32 s48, s48, 4096
  s_and_b32 s48, s48, 1003520
  v_mfma_f32_4x4x4_16b_bf16 v[60:63], v[46:47], v[100:101], v[60:63] cbsz:2 abid:0
  v_mfma_f32_4x4x4_16b_bf16 v[64:67], v[46:47], v[102:103], v[64:67] cbsz:2 abid:0
  v_and_b32_dpp v44, v35, v12 quad_perm:[2,2,2,2] row_mask:0xf bank_mask:0xf
  v_and_b32_dpp v45, v35, v13 quad_perm:[2,2,2,2] row_mask:0xf bank_mask:0xf
  s_waitcnt vmcnt(6)
  s_cmp_ge_i32 s101, 8
  s_cbranch_scc1 L_b373
  s_waitcnt vmcnt(5)
  s_cmp_ge_i32 s101, 5
  s_cbranch_scc1 L_b373
  s_waitcnt vmcnt(4)
L_b373:
  buffer_load_dwordx4 v[132:135], v0, s[12:15], s48 offen offset:0 nt
  v_mfma_f32_4x4x4_16b_bf16 v[60:63], v[46:47], v[104:105], v[60:63] cbsz:2 abid:1
  v_mfma_f32_4x4x4_16b_bf16 v[64:67], v[46:47], v[106:107], v[64:67] cbsz:2 abid:1
  s_waitcnt vmcnt(6)
  s_cmp_ge_i32 s101, 7
  s_cbranch_scc1 L_b374
  s_waitcnt vmcnt(5)
  s_cmp_ge_i32 s101, 4
  s_cbranch_scc1 L_b374
  s_waitcnt vmcnt(4)
L_b374:
  buffer_load_dwordx4 v[136:139], v0, s[12:15], s48 offen offset:1024 nt
  v_mfma_f32_4x4x4_16b_bf16 v[60:63], v[46:47], v[108:109], v[60:63] cbsz:2 abid:2
  v_mfma_f32_4x4x4_16b_bf16 v[64:67], v[46:47], v[110:111], v[64:67] cbsz:2 abid:2
  s_waitcnt vmcnt(6)
  s_cmp_ge_i32 s101, 8
  s_cbranch_scc1 L_b375
  s_waitcnt vmcnt(5)
  s_cmp_ge_i32 s101, 5
  s_cbranch_scc1 L_b375
  s_waitcnt vmcnt(4)
L_b375:
  buffer_load_dwordx4 v[140:143], v0, s[12:15], s48 offen offset:2048 nt
  v_mfma_f32_4x4x4_16b_bf16 v[60:63], v[46:47], v[112:113], v[60:63] cbsz:2 abid:3
  v_mfma_f32_4x4x4_16b_bf16 v[64:67], v[46:47], v[114:115], v[64:67] cbsz:2 abid:3
  s_waitcnt vmcnt(6)
  s_cmp_ge_i32 s101, 6
  s_cbranch_scc1 L_b376
  s_waitcnt vmcnt(5)
  s_cmp_ge_i32 s101, 2
  s_cbranch_scc1 L_b376
  s_waitcnt vmcnt(4)
L_b376:
  buffer_load_dwordx4 v[144:147], v0, s[12:15], s48 offen offset:3072 nt
  s_or_b32 s48, s48, 40960
  s_add_u32 s48, s48, 4096
  s_and_b32 s48, s48, 1003520
  v_mfma_f32_4x4x4_16b_bf16 v[60:63], v[44:45], v[116:117], v[60:63] cbsz:2 abid:0
  v_mfma_f32_4x4x4_16b_bf16 v[64:67], v[44:45], v[118:119], v[64:67] cbsz:2 abid:0
  v_and_b32_dpp v46, v35, v12 quad_perm:[3,3,3,3] row_mask:0xf bank_mask:0xf
  v_and_b32_dpp v47, v35, v13 quad_perm:[3,3,3,3] row_mask:0xf bank_mask:0xf
  s_waitcnt vmcnt(6)
  s_cmp_ge_i32 s101, 8
  s_cbranch_scc1 L_b377
  s_waitcnt vmcnt(5)
  s_cmp_ge_i32 s101, 5
  s_cbranch_scc1 L_b377
  s_waitcnt vmcnt(4)
L_b377:
  buffer_load_dwordx4 v[148:151], v2, s[12:15], s48 offen offset:0 nt
  v_mfma_f32_4x4x4_16b_bf16 v[60:63], v[44:45], v[120:121], v[60:63] cbsz:2 abid:1
  v_mfma_f32_4x4x4_16b_bf16 v[64:67], v[44:45], v[122:123], v[64:67] cbsz:2 abid:1
  s_waitcnt vmcnt(6)
  s_cmp_ge_i32 s101, 7
  s_cbranch_scc1 L_b378
  s_waitcnt vmcnt(5)
  s_cmp_ge_i32 s101, 4
  s_cbranch_scc1 L_b378
  s_waitcnt vmcnt(4)
L_b378:
  buffer_load_dwordx4 v[152:155], v2, s[12:15], s48 offen offset:1024 nt
  v_mfma_f32_4x4x4_16b_bf16 v[60:63], v[44:45], v[124:125], v[60:63] cbsz:2 abid:2
  v_mfma_f32_4x4x4_16b_bf16 v[64:67], v[44:45], v[126:127], v[64:67] cbsz:2 abid:2
  s_waitcnt vmcnt(6)
  s_cmp_ge_i32 s101, 8
  s_cbranch_scc1 L_b379
  s_waitcnt vmcnt(5)
  s_cmp_ge_i32 s101, 5
  s_cbranch_scc1 L_b379
  s_waitcnt vmcnt(4)
L_b379:
  buffer_load_dwordx4 v[156:159], v2, s[12:15], s48 offen offset:2048 nt
  v_mfma_f32_4x4x4_16b_bf16 v[60:63], v[44:45], v[128:129], v[60:63] cbsz:2 abid:3
  v_mfma_f32_4x4x4_16b_bf16 v[64:67], v[44:45], v[130:131], v[64:67] cbsz:2 abid:3
  s_waitcnt vmcnt(6)
  s_cmp_ge_i32 s101, 6
  s_cbranch_scc1 L_b380
  s_waitcnt vmcnt(5)
  s_cmp_ge_i32 s101, 3
  s_cbranch_scc1 L_b380
  s_waitcnt vmcnt(4)
L_b380:
  buffer_load_dwordx4 v[160:163], v2, s[12:15], s48 offen offset:3072 nt
  s_or_b32 s48, s48, 40960
  s_add_u32 s48, s48, 4096
  s_and_b32 s48, s48, 1003520
  v_mfma_f32_4x4x4_16b_bf16 v[60:63], v[46:47], v[132:133], v[60:63] cbsz:2 abid:0
  v_mfma_f32_4x4x4_16b_bf16 v[64:67], v[46:47], v[134:135], v[64:67] cbsz:2 abid:0
  v_and_b32_dpp v44, v36, v12 quad_perm:[0,0,0,0] row_mask:0xf bank_mask:0xf
  v_and_b32_dpp v45, v36, v13 quad_perm:[0,0,0,0] row_mask:0xf bank_mask:0xf
  s_waitcnt vmcnt(6)
  s_cmp_ge_i32 s101, 8
  s_cbranch_scc1 L_b381
  s_waitcnt vmcnt(5)
  s_cmp_ge_i32 s101, 5
  s_cbranch_scc1 L_b381
  s_waitcnt vmcnt(4)
L_b381:
  buffer_load_dwordx4 v[164:167], v2, s[12:15], s48 offen offset:0 nt
  v_mfma_f32_4x4x4_16b_bf16 v[60:63], v[46:47], v[136:137], v[60:63] cbsz:2 abid:1
  v_mfma_f32_4x4x4_16b_bf16 v[64:67], v[46:47], v[138:139], v[64:67] cbsz:2 abid:1
  s_waitcnt vmcnt(6)
  s_cmp_ge_i32 s101, 7
  s_cbranch_scc1 L_b382
  s_waitcnt vmcnt(5)
  s_cmp_ge_i32 s101, 4
  s_cbranch_scc1 L_b382
  s_waitcnt vmcnt(4)
L_b382:
  buffer_load_dwordx4 v[168:171], v2, s[12:15], s48 offen offset:1024 nt
  v_mfma_f32_4x4x4_16b_bf16 v[60:63], v[46:47], v[140:141], v[60:63] cbsz:2 abid:2
  v_mfma_f32_4x4x4_16b_bf16 v[64:67], v[46:47], v[142:143], v[64:67] cbsz:2 abid:2
  s_waitcnt vmcnt(6)
  s_cmp_ge_i32 s101, 8
  s_cbranch_scc1 L_b383
  s_waitcnt vmcnt(5)
  s_cmp_ge_i32 s101, 5
  s_cbranch_scc1 L_b383
  s_waitcnt vmcnt(4)
L_b383:
  buffer_load_dwordx4 v[172:175], v2, s[12:15], s48 offen offset:2048 nt
  v_mfma_f32_4x4x4_16b_bf16 v[60:63], v[46:47], v[144:145], v[60:63] cbsz:2 abid:3
  v_mfma_f32_4x4x4_16b_bf16 v[64:67], v[46:47], v[146:147], v[64:67] cbsz:2 abid:3
  s_waitcnt vmcnt(6)
  s_memrealtime s[80:81]
L_blk24:
  s_cmp_ge_i32 s101, 6
  s_cbranch_scc1 L_b384
  s_waitcnt vmcnt(5)
  s_cmp_ge_i32 s101, 1
  s_cbranch_scc1 L_b384
  s_waitcnt vmcnt(4)
L_b384:
  buffer_load_dwordx4 v[176:179], v2, s[12:15], s48 offen offset:3072 nt
  s_or_b32 s48, s48, 40960
  s_add_u32 s48, s48, 4096
  s_and_b32 s48, s48, 1003520
  v_mfma_f32_4x4x4_16b_bf16 v[60:63], v[44:45], v[148:149], v[60:63] cbsz:2 abid:0
  v_mfma_f32_4x4x4_16b_bf16 v[64:67], v[44:45], v[150:151], v[64:67] cbsz:2 abid:0
  v_and_b32_dpp v46, v36, v12 quad_perm:[1,1,1,1] row_mask:0xf bank_mask:0xf
  v_and_b32_dpp v47, v36, v13 quad_perm:[1,1,1,1] row_mask:0xf bank_mask:0xf
  s_waitcnt vmcnt(6)
  s_cmp_ge_i32 s101, 8
  s_cbranch_scc1 L_b385
  s_waitcnt vmcnt(5)
  s_cmp_ge_i32 s101, 5
  s_cbranch_scc1 L_b385
  s_waitcnt vmcnt(4)
L_b385:
  buffer_load_dwordx4 v[180:183], v2, s[12:15], s48 offen offset:0 nt
  v_mfma_f32_4x4x4_16b_bf16 v[60:63], v[44:45], v[152:153], v[60:63] cbsz:2 abid:1
  v_mfma_f32_4x4x4_16b_bf16 v[64:67], v[44:45], v[154:155], v[64:67] cbsz:2 abid:1
  s_waitcnt vmcnt(6)
  s_waitcnt lgkmcnt(0)
  s_sub_u32 s101, s80, s84
  s_sub_i32 s101, s101, 5584
  s_mul_i32 s101, s101, 2184
  s_ashr_i32 s101, s101, 16
  s_cmp_ge_i32 s101, 7
  s_cbranch_scc1 L_b386
  s_waitcnt vmcnt(5)
  s_cmp_ge_i32 s101, 4
  s_cbranch_scc1 L_b386
  s_waitcnt vmcnt(4)
L_b386:
  buffer_load_dwordx4 v[184:187], v2, s[12:15], s48 offen offset:1024 nt
  v_mfma_f32_4x4x4_16b_bf16 v[60:63], v[44:45], v[156:157], v[60:63] cbsz:2 abid:2
  v_mfma_f32_4x4x4_16b_bf16 v[64:67], v[44:45], v[158:159], v[64:67] cbsz:2 abid:2
  s_waitcnt vmcnt(6)
  s_mov_b32 s82, L_blk27-L_pc
  s_load_dword s83, s[78:79], s82 offset:0
  s_load_dword s83, s[78:79], s82 offset:512
  s_load_dword s83, s[78:79], s82 offset:1024
  s_cmp_ge_i32 s101, 8
  s_cbranch_scc1 L_b387
  s_waitcnt vmcnt(5)
  s_cmp_ge_i32 s101, 5
  s_cbranch_scc1 L_b387
  s_waitcnt vmcnt(4)
L_b387:
  buffer_load_dwordx4 v[188:191], v2, s[12:15], s48 offen offset:2048 nt
  v_mfma_f32_4x4x4_16b_bf16 v[60:63], v[44:45], v[160:161], v[60:63] cbsz:2 abid:3
  v_mfma_f32_4x4x4_16b_bf16 v[64:67], v[44:45], v[162:163], v[64:67] cbsz:2 abid:3
  s_waitcnt vmcnt(6)
  s_cmp_ge_i32 s101, 6
  s_cbranch_scc1 L_b388
  s_waitcnt vmcnt(5)
  s_cmp_ge_i32 s101, 3
  s_cbranch_scc1 L_b388
  s_waitcnt vmcnt(4)
L_b388:
  buffer_load_dwordx4 v[96:99], v2, s[12:15], s48 offen offset:3072 nt
  s_or_b32 s48, s48, 40960
  s_add_u32 s48, s48, 4096
  s_and_b32 s48, s48, 1003520
  v_mfma_f32_4x4x4_16b_bf16 v[60:63], v[46:47], v[164:165], v[60:63] cbsz:2 abid:0
  v_mfma_f32_4x4x4_16b_bf16 v[64:67], v[46:47], v[166:167], v[64:67] cbsz:2 abid:0
  v_and_b32_dpp v44, v36, v12 quad_perm:[2,2,2,2] row_mask:0xf bank_mask:0xf
  v_and_b32_dpp v45, v36, v13 quad_perm:[2,2,2,2] row_mask:0xf bank_mask:0xf
  s_waitcnt vmcnt(6)
  s_cmp_ge_i32 s101, 8
  s_cbranch_scc1 L_b389
  s_waitcnt vmcnt(5)
  s_cmp_ge_i32 s101, 5
  s_cbranch_scc1 L_b389
  s_waitcnt vmcnt(4)
L_b389:
  buffer_load_dwordx4 v[100:103], v2, s[12:15], s48 offen offset:0 nt
  v_mfma_f32_4x4x4_16b_bf16 v[60:63], v[46:47], v[168:169], v[60:63] cbsz:2 abid:1
  v_mfma_f32_4x4x4_16b_bf16 v[64:67], v[46:47], v[170:171], v[64:67] cbsz:2 abid:1
  s_waitcnt vmcnt(6)
  s_cmp_ge_i32 s101, 7
  s_cbranch_scc1 L_b390
  s_waitcnt vmcnt(5)
  s_cmp_ge_i32 s101, 4
  s_cbranch_scc1 L_b390
  s_waitcnt vmcnt(4)
L_b390:
  buffer_load_dwordx4 v[104:107], v2, s[12:15], s48 offen offset:1024 nt
  v_mfma_f32_4x4x4_16b_bf16 v[60:63], v[46:47], v[172:173], v[60:63] cbsz:2 abid:2
  v_mfma_f32_4x4x4_16b_bf16 v[64:67], v[46:47], v[174:175], v[64:67] cbsz:2 abid:2
  s_waitcnt vmcnt(6)
  s_cmp_ge_i32 s101, 8
  s_cbranch_scc1 L_b391
  s_waitcnt vmcnt(5)
  s_cmp_ge_i32 s101, 5
  s_cbranch_scc1 L_b391
  s_waitcnt vmcnt(4)
L_b391:
  buffer_load_dwordx4 v[108:111], v2, s[12:15], s48 offen offset:2048 nt
  v_mfma_f32_4x4x4_16b_bf16 v[60:63], v[46:47], v[176:177], v[60:63] cbsz:2 abid:3
  v_mfma_f32_4x4x4_16b_bf16 v[64:67], v[46:47], v[178:179], v[64:67] cbsz:2 abid:3
  s_waitcnt vmcnt(6)
  s_cmp_ge_i32 s101, 6
  s_cbranch_scc1 L_b392
  s_waitcnt vmcnt(5)
  s_cmp_ge_i32 s101, 2
  s_cbranch_scc1 L_b392
  s_waitcnt vmcnt(4)
L_b392:
  buffer_load_dwordx4 v[112:115], v2, s[12:15], s48 offen offset:3072 nt
  s_or_b32 s48, s48, 40960
  s_add_u32 s48, s48, 4096
  s_and_b32 s48, s48, 1003520
  v_mfma_f32_4x4x4_16b_bf16 v[60:63], v[44:45], v[180:181], v[60:63] cbsz:2 abid:0
  v_mfma_f32_4x4x4_16b_bf16 v[64:67], v[44:45], v[182:183], v[64:67] cbsz:2 abid:0
  v_and_b32_dpp v46, v36, v12 quad_perm:[3,3,3,3] row_mask:0xf bank_mask:0xf
  v_and_b32_dpp v47, v36, v13 quad_perm:[3,3,3,3] row_mask:0xf bank_mask:0xf
  s_waitcnt vmcnt(6)
  s_cmp_ge_i32 s101, 8
  s_cbranch_scc1 L_b393
  s_waitcnt vmcnt(5)
  s_cmp_ge_i32 s101, 5
  s_cbranch_scc1 L_b393
  s_waitcnt vmcnt(4)
L_b393:
  buffer_load_dwordx4 v[116:119], v2, s[12:15], s48 offen offset:0 nt
  v_mfma_f32_4x4x4_16b_bf16 v[60:63], v[44:45], v[184:185], v[60:63] cbsz:2 abid:1
  v_mfma_f32_4x4x4_16b_bf16 v[64:67], v[44:45], v[186:187], v[64:67] cbsz:2 abid:1
  s_waitcnt vmcnt(6)
  s_cmp_ge_i32 s101, 7
  s_cbranch_scc1 L_b394
  s_waitcnt vmcnt(5)
  s_cmp_ge_i32 s101, 4
  s_cbranch_scc1 L_b394
  s_waitcnt vmcnt(4)
L_b394:
  buffer_load_dwordx4 v[120:123], v2, s[12:15], s48 offen offset:1024 nt
  v_mfma_f32_4x4x4_16b_bf16 v[60:63], v[44:45], v[188:189], v[60:63] cbsz:2 abid:2
  v_mfma_f32_4x4x4_16b_bf16 v[64:67], v[44:45], v[190:191], v[64:67] cbsz:2 abid:2
  s_waitcnt vmcnt(6)
  s_cmp_ge_i32 s101, 8
  s_cbranch_scc1 L_b395
  s_waitcnt vmcnt(5)
  s_cmp_ge_i32 s101, 5
  s_cbranch_scc1 L_b395
  s_waitcnt vmcnt(4)
L_b395:
  buffer_load_dwordx4 v[124:127], v2, s[12:15], s48 offen offset:2048 nt
  v_mfma_f32_4x4x4_16b_bf16 v[60:63], v[44:45], v[96:97], v[60:63] cbsz:2 abid:3
  v_mfma_f32_4x4x4_16b_bf16 v[64:67], v[44:45], v[98:99], v[64:67] cbsz:2 abid:3
  s_waitcnt vmcnt(6)
  s_cmp_ge_i32 s101, 6
  s_cbranch_scc1 L_b396
  s_waitcnt vmcnt(5)
  s_cmp_ge_i32 s101, 3
  s_cbranch_scc1 L_b396
  s_waitcnt vmcnt(4)
L_b396:
  buffer_load_dwordx4 v[128:131], v2, s[12:15], s48 offen offset:3072 nt
  s_or_b32 s48, s48, 40960
  s_add_u32 s48, s48, 4096
  s_and_b32 s48, s48, 1003520
  v_mfma_f32_4x4x4_16b_bf16 v[60:63], v[46:47], v[100:101], v[60:63] cbsz:2 abid:0
  v_mfma_f32_4x4x4_16b_bf16 v[64:67], v[46:47], v[102:103], v[64:67] cbsz:2 abid:0
  v_and_b32_dpp v44, v37, v12 quad_perm:[0,0,0,0] row_mask:0xf bank_mask:0xf
  v_and_b32_dpp v45, v37, v13 quad_perm:[0,0,0,0] row_mask:0xf bank_mask:0xf
  s_waitcnt vmcnt(6)
  s_cmp_ge_i32 s101, 8
  s_cbranch_scc1 L_b397
  s_waitcnt vmcnt(5)
  s_cmp_ge_i32 s101, 5
  s_cbranch_scc1 L_b397
  s_waitcnt vmcnt(4)
L_b397:
  buffer_load_dwordx4 v[132:135], v2, s[12:15], s48 offen offset:0 nt
  v_mfma_f32_4x4x4_16b_bf16 v[60:63], v[46:47], v[104:105], v[60:63] cbsz:2 abid:1
  v_mfma_f32_4x4x4_16b_bf16 v[64:67], v[46:47], v[106:107], v[64:67] cbsz:2 abid:1
  s_waitcnt vmcnt(6)
  s_cmp_ge_i32 s101, 7
  s_cbranch_scc1 L_b398
  s_waitcnt vmcnt(5)
  s_cmp_ge_i32 s101, 4
  s_cbranch_scc1 L_b398
  s_waitcnt vmcnt(4)
L_b398:
  buffer_load_dwordx4 v[136:139], v2, s[12:15], s48 offen offset:1024 nt
  v_mfma_f32_4x4x4_16b_bf16 v[60:63], v[46:47], v[108:109], v[60:63] cbsz:2 abid:2
  v_mfma_f32_4x4x4_16b_bf16 v[64:67], v[46:47], v[110:111], v[64:67] cbsz:2 abid:2
  s_waitcnt vmcnt(6)
  s_cmp_ge_i32 s101, 8
  s_cbranch_scc1 L_b399
  s_waitcnt vmcnt(5)
  s_cmp_ge_i32 s101, 5
  s_cbranch_scc1 L_b399
  s_waitcnt vmcnt(4)
L_b399:
  buffer_load_dwordx4 v[140:143], v2, s[12:15], s48 offen offset:2048 nt
  v_mfma_f32_4x4x4_16b_bf16 v[60:63], v[46:47], v[112:113], v[60:63] cbsz:2 abid:3
  v_mfma_f32_4x4x4_16b_bf16 v[64:67], v[46:47], v[114:115], v[64:67] cbsz:2 abid:3
  s_waitcnt vmcnt(6)
  s_memrealtime s[80:81]
L_blk25:
  s_cmp_ge_i32 s101, 6
  s_cbranch_scc1 L_b400
  s_waitcnt vmcnt(5)
  s_cmp_ge_i32 s101, 1
  s_cbranch_scc1 L_b400
  s_waitcnt vmcnt(4)
L_b400:
  buffer_load_dwordx4 v[144:147], v2, s[12:15], s48 offen offset:3072 nt
  s_or_b32 s48, s48, 40960
  s_add_u32 s48, s48, 4096
  s_and_b32 s48, s48, 1003520
  v_mfma_f32_4x4x4_16b_bf16 v[60:63], v[44:45], v[116:117], v[60:63] cbsz:2 abid:0
  v_mfma_f32_4x4x4_16b_bf16 v[64:67], v[44:45], v[118:119], v[64:67] cbsz:2 abid:0
  v_and_b32_dpp v46, v37, v12 quad_perm:[1,1,1,1] row_mask:0xf bank_mask:0xf
  v_and_b32_dpp v47, v37, v13 quad_perm:[1,1,1,1] row_mask:0xf bank_mask:0xf
  s_waitcnt vmcnt(6)
  s_cmp_ge_i32 s101, 8
  s_cbranch_scc1 L_b401
  s_waitcnt vmcnt(5)
  s_cmp_ge_i32 s101, 5
  s_cbranch_scc1 L_b401
  s_waitcnt vmcnt(4)
L_b401:
  buffer_load_dwordx4 v[148:151], v2, s[12:15], s48 offen offset:0 nt
  v_mfma_f32_4x4x4_16b_bf16 v[60:63], v[44:45], v[120:121], v[60:63] cbsz:2 abid:1
  v_mfma_f32_4x4x4_16b_bf16 v[64:67], v[44:45], v[122:123], v[64:67] cbsz:2 abid:1
  s_waitcnt vmcnt(6)
  s_waitcnt lgkmcnt(0)
  s_sub_u32 s101, s80, s84
  s_sub_i32 s101, s101, 5801
  s_mul_i32 s101, s101, 2184
  s_ashr_i32 s101, s101, 16
  s_cmp_ge_i32 s101, 7
  s_cbranch_scc1 L_b402
  s_waitcnt vmcnt(5)
  s_cmp_ge_i32 s101, 4
  s_cbranch_scc1 L_b402
  s_waitcnt vmcnt(4)
L_b402:
  buffer_load_dwordx4 v[152:155], v2, s[12:15], s48 offen offset:1024 nt
  v_mfma_f32_4x4x4_16b_bf16 v[60:63], v[44:45], v[124:125], v[60:63] cbsz:2 abid:2
  v_mfma_f32_4x4x4_16b_bf16 v[64:67], v[44:45], v[126:127], v[64:67] cbsz:2 abid:2
  s_waitcnt vmcnt(6)
  s_mov_b32 s82, L_blk28-L_pc
  s_load_dword s83, s[78:79], s82 offset:0
  s_load_dword s83, s[78:79], s82 offset:512
  s_load_dword s83, s[78:79], s82 offset:1024
  s_cmp_ge_i32 s101, 8
  s_cbranch_scc1 L_b403
  s_waitcnt vmcnt(5)
  s_cmp_ge_i32 s101, 5
  s_cbranch_scc1 L_b403
  s_waitcnt vmcnt(4)
L_b403:
  buffer_load_dwordx4 v[156:159], v2, s[12:15], s48 offen offset:2048 nt
  v_mfma_f32_4x4x4_16b_bf16 v[60:63], v[44:45], v[128:129], v[60:63] cbsz:2 abid:3
  v_mfma_f32_4x4x4_16b_bf16 v[64:67], v[44:45], v[130:131], v[64:67] cbsz:2 abid:3
  s_waitcnt vmcnt(6)
  s_cmp_ge_i32 s101, 6
  s_cbranch_scc1 L_b404
  s_waitcnt vmcnt(5)
  s_cmp_ge_i32 s101, 3
  s_cbranch_scc1 L_b404
  s_waitcnt vmcnt(4)
L_b404:
  buffer_load_dwordx4 v[160:163], v2, s[12:15], s48 offen offset:3072 nt
  s_or_b32 s48, s48, 40960
  s_add_u32 s48, s48, 4096
  s_and_b32 s48, s48, 1003520
  v_mfma_f32_4x4x4_16b_bf16 v[60:63], v[46:47], v[132:133], v[60:63] cbsz:2 abid:0
  v_mfma_f32_4x4x4_16b_bf16 v[64:67], v[46:47], v[134:135], v[64:67] cbsz:2 abid:0
  v_and_b32_dpp v44, v37, v12 quad_perm:[2,2,2,2] row_mask:0xf bank_mask:0xf
  v_and_b32_dpp v45, v37, v13 quad_perm:[2,2,2,2] row_mask:0xf bank_mask:0xf
  s_waitcnt vmcnt(6)
  s_cmp_ge_i32 s101, 8
  s_cbranch_scc1 L_b405
  s_waitcnt vmcnt(5)
  s_cmp_ge_i32 s101, 5
  s_cbranch_scc1 L_b405
  s_waitcnt vmcnt(4)
L_b405:
  buffer_load_dwordx4 v[164:167], v2, s[12:15], s48 offen offset:0 nt
  v_mfma_f32_4x4x4_16b_bf16 v[60:63], v[46:47], v[136:137], v[60:63] cbsz:2 abid:1
  v_mfma_f32_4x4x4_16b_bf16 v[64:67], v[46:47], v[138:139], v[64:67] cbsz:2 abid:1
  s_waitcnt vmcnt(6)
  s_cmp_ge_i32 s101, 7
  s_cbranch_scc1 L_b406
  s_waitcnt vmcnt(5)
  s_cmp_ge_i32 s101, 4
  s_cbranch_scc1 L_b406
  s_waitcnt vmcnt(4)
L_b406:
  buffer_load_dwordx4 v[168:171], v2, s[12:15], s48 offen offset:1024 nt
  v_mfma_f32_4x4x4_16b_bf16 v[60:63], v[46:47], v[140:141], v[60:63] cbsz:2 abid:2
  v_mfma_f32_4x4x4_16b_bf16 v[64:67], v[46:47], v[142:143], v[64:67] cbsz:2 abid:2
  s_waitcnt vmcnt(6)
  s_cmp_ge_i32 s101, 8
  s_cbranch_scc1 L_b407
  s_waitcnt vmcnt(5)
  s_cmp_ge_i32 s101, 5
  s_cbranch_scc1 L_b407
  s_waitcnt vmcnt(4)
L_b407:
  buffer_load_dwordx4 v[172:175], v2, s[12:15], s48 offen offset:2048 nt
  v_mfma_f32_4x4x4_16b_bf16 v[60:63], v[46:47], v[144:145], v[60:63] cbsz:2 abid:3
  v_mfma_f32_4x4x4_16b_bf16 v[64:67], v[46:47], v[146:147], v[64:67] cbsz:2 abid:3
  s_waitcnt vmcnt(6)
  s_cmp_ge_i32 s101, 6
  s_cbranch_scc1 L_b408
  s_waitcnt vmcnt(5)
  s_cmp_ge_i32 s101, 2
  s_cbranch_scc1 L_b408
  s_waitcnt vmcnt(4)
L_b408:
  buffer_load_dwordx4 v[176:179], v2, s[12:15], s48 offen offset:3072 nt
  s_or_b32 s48, s48, 40960
  s_add_u32 s48, s48, 4096
  s_and_b32 s48, s48, 1003520
  v_mfma_f32_4x4x4_16b_bf16 v[60:63], v[44:45], v[148:149], v[60:63] cbsz:2 abid:0
  v_mfma_f32_4x4x4_16b_bf16 v[64:67], v[44:45], v[150:151], v[64:67] cbsz:2 abid:0
  v_and_b32_dpp v46, v37, v12 quad_perm:[3,3,3,3] row_mask:0xf bank_mask:0xf
  v_and_b32_dpp v47, v37, v13 quad_perm:[3,3,3,3] row_mask:0xf bank_mask:0xf
  s_waitcnt vmcnt(6)
  s_cmp_ge_i32 s101, 8
  s_cbranch_scc1 L_b409
  s_waitcnt vmcnt(5)
  s_cmp_ge_i32 s101, 5
  s_cbranch_scc1 L_b409
  s_waitcnt vmcnt(4)
L_b409:
  buffer_load_dwordx4 v[180:183], v0, s[12:15], s48 offen offset:0 nt
  v_mfma_f32_4x4x4_16b_bf16 v[60:63], v[44:45], v[152:153], v[60:63] cbsz:2 abid:1
  v_mfma_f32_4x4x4_16b_bf16 v[64:67], v[44:45], v[154:155], v[64:67] cbsz:2 abid:1
  s_waitcnt vmcnt(6)
  s_cmp_ge_i32 s101, 7
  s_cbranch_scc1 L_b410
  s_waitcnt vmcnt(5)
  s_cmp_ge_i32 s101, 4
  s_cbranch_scc1 L_b410
  s_waitcnt vmcnt(4)
L_b410:
  buffer_load_dwordx4 v[184:187], v0, s[12:15], s48 offen offset:1024 nt
  v_mfma_f32_4x4x4_16b_bf16 v[60:63], v[44:45], v[156:157], v[60:63] cbsz:2 abid:2
  v_mfma_f32_4x4x4_16b_bf16 v[64:67], v[44:45], v[158:159], v[64:67] cbsz:2 abid:2
  s_waitcnt vmcnt(6)
  s_cmp_ge_i32 s101, 8
  s_cbranch_scc1 L_b411
  s_waitcnt vmcnt(5)
  s_cmp_ge_i32 s101, 5
  s_cbranch_scc1 L_b411
  s_waitcnt vmcnt(4)
L_b411:
  buffer_load_dwordx4 v[188:191], v0, s[12:15], s48 offen offset:2048 nt
  v_mfma_f32_4x4x4_16b_bf16 v[60:63], v[44:45], v[160:161], v[60:63] cbsz:2 abid:3
  v_mfma_f32_4x4x4_16b_bf16 v[64:67], v[44:45], v[162:163], v[64:67] cbsz:2 abid:3
  s_waitcnt vmcnt(6)
  s_cmp_ge_i32 s101, 6
  s_cbranch_scc1 L_b412
  s_waitcnt vmcnt(5)
  s_cmp_ge_i32 s101, 3
  s_cbranch_scc1 L_b412
  s_waitcnt vmcnt(4)
L_b412:
  buffer_load_dwordx4 v[96:99], v0, s[12:15], s48 offen offset:3072 nt
  s_or_b32 s48, s48, 40960
  s_add_u32 s48, s48, 4096
  s_and_b32 s48, s48, 1003520
  v_mfma_f32_4x4x4_16b_bf16 v[60:63], v[46:47], v[164:165], v[60:63] cbsz:2 abid:0
  v_mfma_f32_4x4x4_16b_bf16 v[64:67], v[46:47], v[166:167], v[64:67] cbsz:2 abid:0
  v_and_b32_dpp v44, v38, v12 quad_perm:[0,0,0,0] row_mask:0xf bank_mask:0xf
  v_and_b32_dpp v45, v38, v13 quad_perm:[0,0,0,0] row_mask:0xf bank_mask:0xf
  s_waitcnt vmcnt(6)
  s_cmp_ge_i32 s101, 8
  s_cbranch_scc1 L_b413
  s_waitcnt vmcnt(5)
  s_cmp_ge_i32 s101, 5
  s_cbranch_scc1 L_b413
  s_waitcnt vmcnt(4)
L_b413:
  buffer_load_dwordx4 v[100:103], v0, s[12:15], s48 offen offset:0 nt
  v_mfma_f32_4x4x4_16b_bf16 v[60:63], v[46:47], v[168:169], v[60:63] cbsz:2 abid:1
  v_mfma_f32_4x4x4_16b_bf16 v[64:67], v[46:47], v[170:171], v[64:67] cbsz:2 abid:1
  s_waitcnt vmcnt(6)
  s_cmp_ge_i32 s101, 7
  s_cbranch_scc1 L_b414
  s_waitcnt vmcnt(5)
  s_cmp_ge_i32 s101, 4
  s_cbranch_scc1 L_b414
  s_waitcnt vmcnt(4)
L_b414:
  buffer_load_dwordx4 v[104:107], v0, s[12:15], s48 offen offset:1024 nt
  v_mfma_f32_4x4x4_16b_bf16 v[60:63], v[46:47], v[172:173], v[60:63] cbsz:2 abid:2
  v_mfma_f32_4x4x4_16b_bf16 v[64:67], v[46:47], v[174:175], v[64:67] cbsz:2 abid:2
  s_waitcnt vmcnt(6)
  s_cmp_ge_i32 s101, 8
  s_cbranch_scc1 L_b415
  s_waitcnt vmcnt(5)
  s_cmp_ge_i32 s101, 5
  s_cbranch_scc1 L_b415
  s_waitcnt vmcnt(4)
L_b415:
  buffer_load_dwordx4 v[108:111], v0, s[12:15], s48 offen offset:2048 nt
  v_mfma_f32_4x4x4_16b_bf16 v[60:63], v[46:47], v[176:177], v[60:63] cbsz:2 abid:3
  v_mfma_f32_4x4x4_16b_bf16 v[64:67], v[46:47], v[178:179], v[64:67] cbsz:2 abid:3
  s_waitcnt vmcnt(6)
  s_memrealtime s[80:81]
L_blk26:
  s_cmp_ge_i32 s101, 6
  s_cbranch_scc1 L_b416
  s_waitcnt vmcnt(5)
  s_cmp_ge_i32 s101, 1
  s_cbranch_scc1 L_b416
  s_waitcnt vmcnt(4)
L_b416:
  buffer_load_dwordx4 v[112:115], v0, s[12:15], s48 offen offset:3072 nt
  s_or_b32 s48, s48, 40960
  s_add_u32 s48, s48, 4096
  s_and_b32 s48, s48, 1003520
  v_mfma_f32_4x4x4_16b_bf16 v[60:63], v[44:45], v[180:181], v[60:63] cbsz:2 abid:0
  v_mfma_f32_4x4x4_16b_bf16 v[64:67], v[44:45], v[182:183], v[64:67] cbsz:2 abid:0
  v_and_b32_dpp v46, v38, v12 quad_perm:[1,1,1,1] row_mask:0xf bank_mask:0xf
  v_and_b32_dpp v47, v38, v13 quad_perm:[1,1,1,1] row_mask:0xf bank_mask:0xf
  s_waitcnt vmcnt(6)
  s_cmp_ge_i32 s101, 8
  s_cbranch_scc1 L_b417
  s_waitcnt vmcnt(5)
  s_cmp_ge_i32 s101, 5
  s_cbranch_scc1 L_b417
  s_waitcnt vmcnt(4)
L_b417:
  buffer_load_dwordx4 v[116:119], v0, s[12:15], s48 offen offset:0 nt
  v_mfma_f32_4x4x4_16b_bf16 v[60:63], v[44:45], v[184:185], v[60:63] cbsz:2 abid:1
  v_mfma_f32_4x4x4_16b_bf16 v[64:67], v[44:45], v[186:187], v[64:67] cbsz:2 abid:1
  s_waitcnt vmcnt(6)
  s_waitcnt lgkmcnt(0)
  s_sub_u32 s101, s80, s84
  s_sub_i32 s101, s101, 6019
  s_mul_i32 s101, s101, 2184
  s_ashr_i32 s101, s101, 16
  s_cmp_ge_i32 s101, 7
  s_cbranch_scc1 L_b418
  s_waitcnt vmcnt(5)
  s_cmp_ge_i32 s101, 4
  s_cbranch_scc1 L_b418
  s_waitcnt vmcnt(4)
L_b418:
  buffer_load_dwordx4 v[120:123], v0, s[12:15], s48 offen offset:1024 nt
  v_mfma_f32_4x4x4_16b_bf16 v[60:63], v[44:45], v[188:189], v[60:63] cbsz:2 abid:2
  v_mfma_f32_4x4x4_16b_bf16 v[64:67], v[44:45], v[190:191], v[64:67] cbsz:2 abid:2
  s_waitcnt vmcnt(6)
  s_mov_b32 s82, L_blk29-L_pc
  s_load_dword s83, s[78:79], s82 offset:0
  s_load_dword s83, s[78:79], s82 offset:512
  s_load_dword s83, s[78:79], s82 offset:1024
  s_cmp_ge_i32 s101, 8
  s_cbranch_scc1 L_b419
  s_waitcnt vmcnt(5)
  s_cmp_ge_i32 s101, 5
  s_cbranch_scc1 L_b419
  s_waitcnt vmcnt(4)
L_b419:
  buffer_load_dwordx4 v[124:127], v0, s[12:15], s48 offen offset:2048 nt
  v_mfma_f32_4x4x4_16b_bf16 v[60:63], v[44:45], v[96:97], v[60:63] cbsz:2 abid:3
  v_mfma_f32_4x4x4_16b_bf16 v[64:67], v[44:45], v[98:99], v[64:67] cbsz:2 abid:3
  s_waitcnt vmcnt(6)
  s_cmp_ge_i32 s101, 6
  s_cbranch_scc1 L_b420
  s_waitcnt vmcnt(5)
  s_cmp_ge_i32 s101, 3
  s_cbranch_scc1 L_b420
  s_waitcnt vmcnt(4)
L_b420:
  buffer_load_dwordx4 v[128:131], v0, s[12:15], s48 offen offset:3072 nt
  s_or_b32 s48, s48, 40960
  s_add_u32 s48, s48, 4096
  s_and_b32 s48, s48, 1003520
  v_mfma_f32_4x4x4_16b_bf16 v[60:63], v[46:47], v[100:101], v[60:63] cbsz:2 abid:0
  v_mfma_f32_4x4x4_16b_bf16 v[64:67], v[46:47], v[102:103], v[64:67] cbsz:2 abid:0
  v_and_b32_dpp v44, v38, v12 quad_perm:[2,2,2,2] row_mask:0xf bank_mask:0xf
  v_and_b32_dpp v45, v38, v13 quad_perm:[2,2,2,2] row_mask:0xf bank_mask:0xf
  s_waitcnt vmcnt(6)
  s_cmp_ge_i32 s101, 8
  s_cbranch_scc1 L_b421
  s_waitcnt vmcnt(5)
  s_cmp_ge_i32 s101, 5
  s_cbranch_scc1 L_b421
  s_waitcnt vmcnt(4)
L_b421:
  buffer_load_dwordx4 v[132:135], v0, s[12:15], s48 offen offset:0 nt
  v_mfma_f32_4x4x4_16b_bf16 v[60:63], v[46:47], v[104:105], v[60:63] cbsz:2 abid:1
  v_mfma_f32_4x4x4_16b_bf16 v[64:67], v[46:47], v[106:107], v[64:67] cbsz:2 abid:1
  s_waitcnt vmcnt(6)
  s_cmp_ge_i32 s101, 7
  s_cbranch_scc1 L_b422
  s_waitcnt vmcnt(5)
  s_cmp_ge_i32 s101, 4
  s_cbranch_scc1 L_b422
  s_waitcnt vmcnt(4)
L_b422:
  buffer_load_dwordx4 v[136:139], v0, s[12:15], s48 offen offset:1024 nt
  v_mfma_f32_4x4x4_16b_bf16 v[60:63], v[46:47], v[108:109], v[60:63] cbsz:2 abid:2
  v_mfma_f32_4x4x4_16b_bf16 v[64:67], v[46:47], v[110:111], v[64:67] cbsz:2 abid:2
  s_waitcnt vmcnt(6)
  s_cmp_ge_i32 s101, 8
  s_cbranch_scc1 L_b423
  s_waitcnt vmcnt(5)
  s_cmp_ge_i32 s101, 5
  s_cbranch_scc1 L_b423
  s_waitcnt vmcnt(4)
L_b423:
  buffer_load_dwordx4 v[140:143], v0, s[12:15], s48 offen offset:2048 nt
  v_mfma_f32_4x4x4_16b_bf16 v[60:63], v[46:47], v[112:113], v[60:63] cbsz:2 abid:3
  v_mfma_f32_4x4x4_16b_bf16 v[64:67], v[46:47], v[114:115], v[64:67] cbsz:2 abid:3
  s_waitcnt vmcnt(6)
  s_cmp_ge_i32 s101, 6
  s_cbranch_scc1 L_b424
  s_waitcnt vmcnt(5)
  s_cmp_ge_i32 s101, 2
  s_cbranch_scc1 L_b424
  s_waitcnt vmcnt(4)
L_b424:
  buffer_load_dwordx4 v[144:147], v0, s[12:15], s48 offen offset:3072 nt
  s_or_b32 s48, s48, 40960
  s_add_u32 s48, s48, 4096
  s_and_b32 s48, s48, 1003520
  v_mfma_f32_4x4x4_16b_bf16 v[60:63], v[44:45], v[116:117], v[60:63] cbsz:2 abid:0
  v_mfma_f32_4x4x4_16b_bf16 v[64:67], v[44:45], v[118:119], v[64:67] cbsz:2 abid:0
  v_and_b32_dpp v46, v38, v12 quad_perm:[3,3,3,3] row_mask:0xf bank_mask:0xf
  v_and_b32_dpp v47, v38, v13 quad_perm:[3,3,3,3] row_mask:0xf bank_mask:0xf
  s_waitcnt vmcnt(6)
  s_cmp_ge_i32 s101, 8
  s_cbranch_scc1 L_b425
  s_waitcnt vmcnt(5)
  s_cmp_ge_i32 s101, 5
  s_cbranch_scc1 L_b425
  s_waitcnt vmcnt(4)
L_b425:
  buffer_load_dwordx4 v[148:151], v0, s[12:15], s48 offen offset:0 nt
  v_mfma_f32_4x4x4_16b_bf16 v[60:63], v[44:45], v[120:121], v[60:63] cbsz:2 abid:1
  v_mfma_f32_4x4x4_16b_bf16 v[64:67], v[44:45], v[122:123], v[64:67] cbsz:2 abid:1
  s_waitcnt vmcnt(6)
  s_cmp_ge_i32 s101, 7
  s_cbranch_scc1 L_b426
  s_waitcnt vmcnt(5)
  s_cmp_ge_i32 s101, 4
  s_cbranch_scc1 L_b426
  s_waitcnt vmcnt(4)
L_b426:
  buffer_load_dwordx4 v[152:155], v0, s[12:15], s48 offen offset:1024 nt
  v_mfma_f32_4x4x4_16b_bf16 v[60:63], v[44:45], v[124:125], v[60:63] cbsz:2 abid:2
  v_mfma_f32_4x4x4_16b_bf16 v[64:67], v[44:45], v[126:127], v[64:67] cbsz:2 abid:2
  s_waitcnt vmcnt(6)
  s_cmp_ge_i32 s101, 8
  s_cbranch_scc1 L_b427
  s_waitcnt vmcnt(5)
  s_cmp_ge_i32 s101, 5
  s_cbranch_scc1 L_b427
  s_waitcnt vmcnt(4)
L_b427:
  buffer_load_dwordx4 v[156:159], v0, s[12:15], s48 offen offset:2048 nt
  v_mfma_f32_4x4x4_16b_bf16 v[60:63], v[44:45], v[128:129], v[60:63] cbsz:2 abid:3
  v_mfma_f32_4x4x4_16b_bf16 v[64:67], v[44:45], v[130:131], v[64:67] cbsz:2 abid:3
  s_waitcnt vmcnt(6)
  s_cmp_ge_i32 s101, 6
  s_cbranch_scc1 L_b428
  s_waitcnt vmcnt(5)
  s_cmp_ge_i32 s101, 3
  s_cbranch_scc1 L_b428
  s_waitcnt vmcnt(4)
L_b428:
  buffer_load_dwordx4 v[160:163], v0, s[12:15], s48 offen offset:3072 nt
  s_or_b32 s48, s48, 40960
  s_add_u32 s48, s48, 4096
  s_and_b32 s48, s48, 1003520
  v_mfma_f32_4x4x4_16b_bf16 v[60:63], v[46:47], v[132:133], v[60:63] cbsz:2 abid:0
  v_mfma_f32_4x4x4_16b_bf16 v[64:67], v[46:47], v[134:135], v[64:67] cbsz:2 abid:0
  v_and_b32_dpp v44, v39, v12 quad_perm:[0,0,0,0] row_mask:0xf bank_mask:0xf
  v_and_b32_dpp v45, v39, v13 quad_perm:[0,0,0,0] row_mask:0xf bank_mask:0xf
  s_waitcnt vmcnt(6)
  s_cmp_ge_i32 s101, 8
  s_cbranch_scc1 L_b429
  s_waitcnt vmcnt(5)
  s_cmp_ge_i32 s101, 5
  s_cbranch_scc1 L_b429
  s_waitcnt vmcnt(4)
L_b429:
  buffer_load_dwordx4 v[164:167], v0, s[12:15], s48 offen offset:0 nt
  v_mfma_f32_4x4x4_16b_bf16 v[60:63], v[46:47], v[136:137], v[60:63] cbsz:2 abid:1
  v_mfma_f32_4x4x4_16b_bf16 v[64:67], v[46:47], v[138:139], v[64:67] cbsz:2 abid:1
  s_waitcnt vmcnt(6)
  s_cmp_ge_i32 s101, 7
  s_cbranch_scc1 L_b430
  s_waitcnt vmcnt(5)
  s_cmp_ge_i32 s101, 4
  s_cbranch_scc1 L_b430
  s_waitcnt vmcnt(4)
L_b430:
  buffer_load_dwordx4 v[168:171], v0, s[12:15], s48 offen offset:1024 nt
  v_mfma_f32_4x4x4_16b_bf16 v[60:63], v[46:47], v[140:141], v[60:63] cbsz:2 abid:2
  v_mfma_f32_4x4x4_16b_bf16 v[64:67], v[46:47], v[142:143], v[64:67] cbsz:2 abid:2
  s_waitcnt vmcnt(6)
  s_cmp_ge_i32 s101, 8
  s_cbranch_scc1 L_b431
  s_waitcnt vmcnt(5)
  s_cmp_ge_i32 s101, 5
  s_cbranch_scc1 L_b431
  s_waitcnt vmcnt(4)
L_b431:
  buffer_load_dwordx4 v[172:175], v0, s[12:15], s48 offen offset:2048 nt
  v_mfma_f32_4x4x4_16b_bf16 v[60:63], v[46:47], v[144:145], v[60:63] cbsz:2 abid:3
  v_mfma_f32_4x4x4_16b_bf16 v[64:67], v[46:47], v[146:147], v[64:67] cbsz:2 abid:3
  s_waitcnt vmcnt(6)
  s_memrealtime s[80:81]
L_blk27:
  s_cmp_ge_i32 s101, 6
  s_cbranch_scc1 L_b432
  s_waitcnt vmcnt(5)
  s_cmp_ge_i32 s101, 1
  s_cbranch_scc1 L_b432
  s_waitcnt vmcnt(4)
L_b432:
  buffer_load_dwordx4 v[176:179], v0, s[12:15], s48 offen offset:3072 nt
  s_or_b32 s48, s48, 40960
  s_add_u32 s48, s48, 4096
  s_and_b32 s48, s48, 1003520
  v_mfma_f32_4x4x4_16b_bf16 v[60:63], v[44:45], v[148:149], v[60:63] cbsz:2 abid:0
  v_mfma_f32_4x4x4_16b_bf16 v[64:67], v[44:45], v[150:151], v[64:67] cbsz:2 abid:0
  v_and_b32_dpp v46, v39, v12 quad_perm:[1,1,1,1] row_mask:0xf bank_mask:0xf
  v_and_b32_dpp v47, v39, v13 quad_perm:[1,1,1,1] row_mask:0xf bank_mask:0xf
  s_waitcnt vmcnt(6)
  s_cmp_ge_i32 s101, 8
  s_cbranch_scc1 L_b433
  s_waitcnt vmcnt(5)
  s_cmp_ge_i32 s101, 5
  s_cbranch_scc1 L_b433
  s_waitcnt vmcnt(4)
L_b433:
  buffer_load_dwordx4 v[180:183], v0, s[12:15], s48 offen offset:0 nt
  v_mfma_f32_4x4x4_16b_bf16 v[60:63], v[44:45], v[152:153], v[60:63] cbsz:2 abid:1
  v_mfma_f32_4x4x4_16b_bf16 v[64:67], v[44:45], v[154:155], v[64:67] cbsz:2 abid:1
  s_waitcnt vmcnt(6)
  s_waitcnt lgkmcnt(0)
  s_sub_u32 s101, s80, s84
  s_sub_i32 s101, s101, 6236
  s_mul_i32 s101, s101, 2184
  s_ashr_i32 s101, s101, 16
  s_cmp_ge_i32 s101, 7
  s_cbranch_scc1 L_b434
  s_waitcnt vmcnt(5)
  s_cmp_ge_i32 s101, 4
  s_cbranch_scc1 L_b434
  s_waitcnt vmcnt(4)
L_b434:
  buffer_load_dwordx4 v[184:187], v0, s[12:15], s48 offen offset:1024 nt
  v_mfma_f32_4x4x4_16b_bf16 v[60:63], v[44:45], v[156:157], v[60:63] cbsz:2 abid:2
  v_mfma_f32_4x4x4_16b_bf16 v[64:67], v[44:45], v[158:159], v[64:67] cbsz:2 abid:2
  s_waitcnt vmcnt(6)
  s_mov_b32 s82, L_blk30-L_pc
  s_load_dword s83, s[78:79], s82 offset:0
  s_load_dword s83, s[78:79], s82 offset:512
  s_load_dword s83, s[78:79], s82 offset:1024
  s_cmp_ge_i32 s101, 8
  s_cbranch_scc1 L_b435
  s_waitcnt vmcnt(5)
  s_cmp_ge_i32 s101, 5
  s_cbranch_scc1 L_b435
  s_waitcnt vmcnt(4)
L_b435:
  buffer_load_dwordx4 v[188:191], v0, s[12:15], s48 offen offset:2048 nt
  v_mfma_f32_4x4x4_16b_bf16 v[60:63], v[44:45], v[160:161], v[60:63] cbsz:2 abid:3
  v_mfma_f32_4x4x4_16b_bf16 v[64:67], v[44:45], v[162:163], v[64:67] cbsz:2 abid:3
  s_waitcnt vmcnt(6)
  s_cmp_ge_i32 s101, 6
  s_cbranch_scc1 L_b436
  s_waitcnt vmcnt(5)
  s_cmp_ge_i32 s101, 3
  s_cbranch_scc1 L_b436
  s_waitcnt vmcnt(4)
L_b436:
  buffer_load_dwordx4 v[96:99], v0, s[12:15], s48 offen offset:3072 nt
  s_or_b32 s48, s48, 40960
  s_add_u32 s48, s48, 4096
  s_and_b32 s48, s48, 1003520
  v_mfma_f32_4x4x4_16b_bf16 v[60:63], v[46:47], v[164:165], v[60:63] cbsz:2 abid:0
  v_mfma_f32_4x4x4_16b_bf16 v[64:67], v[46:47], v[166:167], v[64:67] cbsz:2 abid:0
  v_and_b32_dpp v44, v39, v12 quad_perm:[2,2,2,2] row_mask:0xf bank_mask:0xf
  v_and_b32_dpp v45, v39, v13 quad_perm:[2,2,2,2] row_mask:0xf bank_mask:0xf
  s_waitcnt vmcnt(6)
  s_cmp_ge_i32 s101, 8
  s_cbranch_scc1 L_b437
  s_waitcnt vmcnt(5)
  s_cmp_ge_i32 s101, 5
  s_cbranch_scc1 L_b437
  s_waitcnt vmcnt(4)
L_b437:
  buffer_load_dwordx4 v[100:103], v0, s[12:15], s48 offen offset:0 nt
  v_mfma_f32_4x4x4_16b_bf16 v[60:63], v[46:47], v[168:169], v[60:63] cbsz:2 abid:1
  v_mfma_f32_4x4x4_16b_bf16 v[64:67], v[46:47], v[170:171], v[64:67] cbsz:2 abid:1
  s_waitcnt vmcnt(6)
  s_cmp_ge_i32 s101, 7
  s_cbranch_scc1 L_b438
  s_waitcnt vmcnt(5)
  s_cmp_ge_i32 s101, 4
  s_cbranch_scc1 L_b438
  s_waitcnt vmcnt(4)
L_b438:
  buffer_load_dwordx4 v[104:107], v0, s[12:15], s48 offen offset:1024 nt
  v_mfma_f32_4x4x4_16b_bf16 v[60:63], v[46:47], v[172:173], v[60:63] cbsz:2 abid:2
  v_mfma_f32_4x4x4_16b_bf16 v[64:67], v[46:47], v[174:175], v[64:67] cbsz:2 abid:2
  s_waitcnt vmcnt(6)
  s_cmp_ge_i32 s101, 8
  s_cbranch_scc1 L_b439
  s_waitcnt vmcnt(5)
  s_cmp_ge_i32 s101, 5
  s_cbranch_scc1 L_b439
  s_waitcnt vmcnt(4)
L_b439:
  buffer_load_dwordx4 v[108:111], v0, s[12:15], s48 offen offset:2048 nt
  v_mfma_f32_4x4x4_16b_bf16 v[60:63], v[46:47], v[176:177], v[60:63] cbsz:2 abid:3
  v_mfma_f32_4x4x4_16b_bf16 v[64:67], v[46:47], v[178:179], v[64:67] cbsz:2 abid:3
  s_waitcnt vmcnt(6)
  s_cmp_ge_i32 s101, 6
  s_cbranch_scc1 L_b440
  s_waitcnt vmcnt(5)
  s_cmp_ge_i32 s101, 2
  s_cbranch_scc1 L_b440
  s_waitcnt vmcnt(4)
L_b440:
  buffer_load_dwordx4 v[112:115], v0, s[12:15], s48 offen offset:3072 nt
  s_or_b32 s48, s48, 40960
  s_add_u32 s48, s48, 4096
  s_and_b32 s48, s48, 1003520
  v_mfma_f32_4x4x4_16b_bf16 v[60:63], v[44:45], v[180:181], v[60:63] cbsz:2 abid:0
  v_mfma_f32_4x4x4_16b_bf16 v[64:67], v[44:45], v[182:183], v[64:67] cbsz:2 abid:0
  v_and_b32_dpp v46, v39, v12 quad_perm:[3,3,3,3] row_mask:0xf bank_mask:0xf
  v_and_b32_dpp v47, v39, v13 quad_perm:[3,3,3,3] row_mask:0xf bank_mask:0xf
  s_waitcnt vmcnt(6)
  s_cmp_ge_i32 s101, 8
  s_cbranch_scc1 L_b441
  s_waitcnt vmcnt(5)
  s_cmp_ge_i32 s101, 5
  s_cbranch_scc1 L_b441
  s_waitcnt vmcnt(4)
L_b441:
  buffer_load_dwordx4 v[116:119], v2, s[12:15], s48 offen offset:0 nt
  v_mfma_f32_4x4x4_16b_bf16 v[60:63], v[44:45], v[184:185], v[60:63] cbsz:2 abid:1
  v_mfma_f32_4x4x4_16b_bf16 v[64:67], v[44:45], v[186:187], v[64:67] cbsz:2 abid:1
  s_waitcnt vmcnt(6)
  s_cmp_ge_i32 s101, 7
  s_cbranch_scc1 L_b442
  s_waitcnt vmcnt(5)
  s_cmp_ge_i32 s101, 4
  s_cbranch_scc1 L_b442
  s_waitcnt vmcnt(4)
L_b442:
  buffer_load_dwordx4 v[120:123], v2, s[12:15], s48 offen offset:1024 nt
  v_mfma_f32_4x4x4_16b_bf16 v[60:63], v[44:45], v[188:189], v[60:63] cbsz:2 abid:2
  v_mfma_f32_4x4x4_16b_bf16 v[64:67], v[44:45], v[190:191], v[64:67] cbsz:2 abid:2
  s_waitcnt vmcnt(6)
  s_cmp_ge_i32 s101, 8
  s_cbranch_scc1 L_b443
  s_waitcnt vmcnt(5)
  s_cmp_ge_i32 s101, 5
  s_cbranch_scc1 L_b443
  s_waitcnt vmcnt(4)
L_b443:
  buffer_load_dwordx4 v[124:127], v2, s[12:15], s48 offen offset:2048 nt
  v_mfma_f32_4x4x4_16b_bf16 v[60:63], v[44:45], v[96:97], v[60:63] cbsz:2 abid:3
  v_mfma_f32_4x4x4_16b_bf16 v[64:67], v[44:45], v[98:99], v[64:67] cbsz:2 abid:3
  s_waitcnt vmcnt(6)
  s_cmp_ge_i32 s101, 6
  s_cbranch_scc1 L_b444
  s_waitcnt vmcnt(5)
  s_cmp_ge_i32 s101, 3
  s_cbranch_scc1 L_b444
  s_waitcnt vmcnt(4)
L_b444:
  buffer_load_dwordx4 v[128:131], v2, s[12:15], s48 offen offset:3072 nt
  s_or_b32 s48, s48, 40960
  s_add_u32 s48, s48, 4096
  s_and_b32 s48, s48, 1003520
  v_mfma_f32_4x4x4_16b_bf16 v[60:63], v[46:47], v[100:101], v[60:63] cbsz:2 abid:0
  v_mfma_f32_4x4x4_16b_bf16 v[64:67], v[46:47], v[102:103], v[64:67] cbsz:2 abid:0
  v_and_b32_dpp v44, v40, v12 quad_perm:[0,0,0,0] row_mask:0xf bank_mask:0xf
  v_and_b32_dpp v45, v40, v13 quad_perm:[0,0,0,0] row_mask:0xf bank_mask:0xf
  s_waitcnt vmcnt(6)
  s_cmp_ge_i32 s101, 8
  s_cbranch_scc1 L_b445
  s_waitcnt vmcnt(5)
  s_cmp_ge_i32 s101, 5
  s_cbranch_scc1 L_b445
  s_waitcnt vmcnt(4)
L_b445:
  buffer_load_dwordx4 v[132:135], v2, s[12:15], s48 offen offset:0 nt
  v_mfma_f32_4x4x4_16b_bf16 v[60:63], v[46:47], v[104:105], v[60:63] cbsz:2 abid:1
  v_mfma_f32_4x4x4_16b_bf16 v[64:67], v[46:47], v[106:107], v[64:67] cbsz:2 abid:1
  s_waitcnt vmcnt(6)
  s_cmp_ge_i32 s101, 7
  s_cbranch_scc1 L_b446
  s_waitcnt vmcnt(5)
  s_cmp_ge_i32 s101, 4
  s_cbranch_scc1 L_b446
  s_waitcnt vmcnt(4)
L_b446:
  buffer_load_dwordx4 v[136:139], v2, s[12:15], s48 offen offset:1024 nt
  v_mfma_f32_4x4x4_16b_bf16 v[60:63], v[46:47], v[108:109], v[60:63] cbsz:2 abid:2
  v_mfma_f32_4x4x4_16b_bf16 v[64:67], v[46:47], v[110:111], v[64:67] cbsz:2 abid:2
  s_waitcnt vmcnt(6)
  s_cmp_ge_i32 s101, 8
  s_cbranch_scc1 L_b447
  s_waitcnt vmcnt(5)
  s_cmp_ge_i32 s101, 5
  s_cbranch_scc1 L_b447
  s_waitcnt vmcnt(4)
L_b447:
  buffer_load_dwordx4 v[140:143], v2, s[12:15], s48 offen offset:2048 nt
  v_mfma_f32_4x4x4_16b_bf16 v[60:63], v[46:47], v[112:113], v[60:63] cbsz:2 abid:3
  v_mfma_f32_4x4x4_16b_bf16 v[64:67], v[46:47], v[114:115], v[64:67] cbsz:2 abid:3
  s_waitcnt vmcnt(6)
  s_memrealtime s[80:81]
L_blk28:
  s_cmp_ge_i32 s101, 6
  s_cbranch_scc1 L_b448
  s_waitcnt vmcnt(5)
  s_cmp_ge_i32 s101, 1
  s_cbranch_scc1 L_b448
  s_waitcnt vmcnt(4)
L_b448:
  buffer_load_dwordx4 v[144:147], v2, s[12:15], s48 offen offset:3072 nt
  s_or_b32 s48, s48, 40960
  s_add_u32 s48, s48, 4096
  s_and_b32 s48, s48, 1003520
  v_mfma_f32_4x4x4_16b_bf16 v[60:63], v[44:45], v[116:117], v[60:63] cbsz:2 abid:0
  v_mfma_f32_4x4x4_16b_bf16 v[64:67], v[44:45], v[118:119], v[64:67] cbsz:2 abid:0
  v_and_b32_dpp v46, v40, v12 quad_perm:[1,1,1,1] row_mask:0xf bank_mask:0xf
  v_and_b32_dpp v47, v40, v13 quad_perm:[1,1,1,1] row_mask:0xf bank_mask:0xf
  s_waitcnt vmcnt(6)
  s_cmp_ge_i32 s101, 8
  s_cbranch_scc1 L_b449
  s_waitcnt vmcnt(5)
  s_cmp_ge_i32 s101, 5
  s_cbranch_scc1 L_b449
  s_waitcnt vmcnt(4)
L_b449:
  buffer_load_dwordx4 v[148:151], v2, s[12:15], s48 offen offset:0 nt
  v_mfma_f32_4x4x4_16b_bf16 v[60:63], v[44:45], v[120:121], v[60:63] cbsz:2 abid:1
  v_mfma_f32_4x4x4_16b_bf16 v[64:67], v[44:45], v[122:123], v[64:67] cbsz:2 abid:1
  s_waitcnt vmcnt(6)
  s_waitcnt lgkmcnt(0)
  s_sub_u32 s101, s80, s84
  s_sub_i32 s101, s101, 6454
  s_mul_i32 s101, s101, 2184
  s_ashr_i32 s101, s101, 16
  s_cmp_ge_i32 s101, 7
  s_cbranch_scc1 L_b450
  s_waitcnt vmcnt(5)
  s_cmp_ge_i32 s101, 4
  s_cbranch_scc1 L_b450
  s_waitcnt vmcnt(4)
L_b450:
  buffer_load_dwordx4 v[152:155], v2, s[12:15], s48 offen offset:1024 nt
  v_mfma_f32_4x4x4_16b_bf16 v[60:63], v[44:45], v[124:125], v[60:63] cbsz:2 abid:2
  v_mfma_f32_4x4x4_16b_bf16 v[64:67], v[44:45], v[126:127], v[64:67] cbsz:2 abid:2
  s_waitcnt vmcnt(6)
  s_mov_b32 s82, L_blk31-L_pc
  s_load_dword s83, s[78:79], s82 offset:0
  s_load_dword s83, s[78:79], s82 offset:512
  s_load_dword s83, s[78:79], s82 offset:1024
  s_mov_b32 s82, L_tail-L_pc
  s_load_dword s83, s[78:79], s82 offset:0
  s_load_dword s83, s[78:79], s82 offset:512
  s_load_dword s83, s[78:79], s82 offset:1024
  s_load_dword s83, s[78:79], s82 offset:1536
  s_load_dword s83, s[78:79], s82 offset:2048
  s_load_dword s83, s[78:79], s82 offset:2560
  s_cmp_ge_i32 s101, 8
  s_cbranch_scc1 L_b451
  s_waitcnt vmcnt(5)
  s_cmp_ge_i32 s101, 5
  s_cbranch_scc1 L_b451
  s_waitcnt vmcnt(4)
L_b451:
  buffer_load_dwordx4 v[156:159], v2, s[12:15], s48 offen offset:2048 nt
  v_mfma_f32_4x4x4_16b_bf16 v[60:63], v[44:45], v[128:129], v[60:63] cbsz:2 abid:3
  v_mfma_f32_4x4x4_16b_bf16 v[64:67], v[44:45], v[130:131], v[64:67] cbsz:2 abid:3
  s_waitcnt vmcnt(6)
  s_cmp_ge_i32 s101, 6
  s_cbranch_scc1 L_b452
  s_waitcnt vmcnt(5)
  s_cmp_ge_i32 s101, 3
  s_cbranch_scc1 L_b452
  s_waitcnt vmcnt(4)
L_b452:
  buffer_load_dwordx4 v[160:163], v2, s[12:15], s48 offen offset:3072 nt
  s_or_b32 s48, s48, 40960
  s_add_u32 s48, s48, 4096
  s_and_b32 s48, s48, 1003520
  v_mfma_f32_4x4x4_16b_bf16 v[60:63], v[46:47], v[132:133], v[60:63] cbsz:2 abid:0
  v_mfma_f32_4x4x4_16b_bf16 v[64:67], v[46:47], v[134:135], v[64:67] cbsz:2 abid:0
  v_and_b32_dpp v44, v40, v12 quad_perm:[2,2,2,2] row_mask:0xf bank_mask:0xf
  v_and_b32_dpp v45, v40, v13 quad_perm:[2,2,2,2] row_mask:0xf bank_mask:0xf
  s_waitcnt vmcnt(6)
  s_cmp_ge_i32 s101, 8
  s_cbranch_scc1 L_b453
  s_waitcnt vmcnt(5)
  s_cmp_ge_i32 s101, 5
  s_cbranch_scc1 L_b453
  s_waitcnt vmcnt(4)
L_b453:
  buffer_load_dwordx4 v[164:167], v2, s[12:15], s48 offen offset:0 nt
  v_mfma_f32_4x4x4_16b_bf16 v[60:63], v[46:47], v[136:137], v[60:63] cbsz:2 abid:1
  v_mfma_f32_4x4x4_16b_bf16 v[64:67], v[46:47], v[138:139], v[64:67] cbsz:2 abid:1
  s_waitcnt vmcnt(6)
  s_cmp_ge_i32 s101, 7
  s_cbranch_scc1 L_b454
  s_waitcnt vmcnt(5)
  s_cmp_ge_i32 s101, 4
  s_cbranch_scc1 L_b454
  s_waitcnt vmcnt(4)
L_b454:
  buffer_load_dwordx4 v[168:171], v2, s[12:15], s48 offen offset:1024 nt
  v_mfma_f32_4x4x4_16b_bf16 v[60:63], v[46:47], v[140:141], v[60:63] cbsz:2 abid:2
  v_mfma_f32_4x4x4_16b_bf16 v[64:67], v[46:47], v[142:143], v[64:67] cbsz:2 abid:2
  s_waitcnt vmcnt(6)
  s_cmp_ge_i32 s101, 8
  s_cbranch_scc1 L_b455
  s_waitcnt vmcnt(5)
  s_cmp_ge_i32 s101, 5
  s_cbranch_scc1 L_b455
  s_waitcnt vmcnt(4)
L_b455:
  buffer_load_dwordx4 v[172:175], v2, s[12:15], s48 offen offset:2048 nt
  v_mfma_f32_4x4x4_16b_bf16 v[60:63], v[46:47], v[144:145], v[60:63] cbsz:2 abid:3
  v_mfma_f32_4x4x4_16b_bf16 v[64:67], v[46:47], v[146:147], v[64:67] cbsz:2 abid:3
  s_waitcnt vmcnt(6)
  s_cmp_ge_i32 s101, 6
  s_cbranch_scc1 L_b456
  s_waitcnt vmcnt(5)
  s_cmp_ge_i32 s101, 2
  s_cbranch_scc1 L_b456
  s_waitcnt vmcnt(4)
L_b456:
  buffer_load_dwordx4 v[176:179], v2, s[12:15], s48 offen offset:3072 nt
  s_or_b32 s48, s48, 40960
  s_add_u32 s48, s48, 4096
  s_and_b32 s48, s48, 1003520
  v_mfma_f32_4x4x4_16b_bf16 v[60:63], v[44:45], v[148:149], v[60:63] cbsz:2 abid:0
  v_mfma_f32_4x4x4_16b_bf16 v[64:67], v[44:45], v[150:151], v[64:67] cbsz:2 abid:0
  v_and_b32_dpp v46, v40, v12 quad_perm:[3,3,3,3] row_mask:0xf bank_mask:0xf
  v_and_b32_dpp v47, v40, v13 quad_perm:[3,3,3,3] row_mask:0xf bank_mask:0xf
  s_waitcnt vmcnt(6)
  s_cmp_ge_i32 s101, 8
  s_cbranch_scc1 L_b457
  s_waitcnt vmcnt(5)
  s_cmp_ge_i32 s101, 5
  s_cbranch_scc1 L_b457
  s_waitcnt vmcnt(4)
L_b457:
  buffer_load_dwordx4 v[180:183], v2, s[12:15], s48 offen offset:0 nt
  v_mfma_f32_4x4x4_16b_bf16 v[60:63], v[44:45], v[152:153], v[60:63] cbsz:2 abid:1
  v_mfma_f32_4x4x4_16b_bf16 v[64:67], v[44:45], v[154:155], v[64:67] cbsz:2 abid:1
  s_waitcnt vmcnt(6)
  s_cmp_ge_i32 s101, 7
  s_cbranch_scc1 L_b458
  s_waitcnt vmcnt(5)
  s_cmp_ge_i32 s101, 4
  s_cbranch_scc1 L_b458
  s_waitcnt vmcnt(4)
L_b458:
  buffer_load_dwordx4 v[184:187], v2, s[12:15], s48 offen offset:1024 nt
  v_mfma_f32_4x4x4_16b_bf16 v[60:63], v[44:45], v[156:157], v[60:63] cbsz:2 abid:2
  v_mfma_f32_4x4x4_16b_bf16 v[64:67], v[44:45], v[158:159], v[64:67] cbsz:2 abid:2
  s_waitcnt vmcnt(6)
  s_cmp_ge_i32 s101, 8
  s_cbranch_scc1 L_b459
  s_waitcnt vmcnt(5)
  s_cmp_ge_i32 s101, 5
  s_cbranch_scc1 L_b459
  s_waitcnt vmcnt(4)
L_b459:
  buffer_load_dwordx4 v[188:191], v2, s[12:15], s48 offen offset:2048 nt
  v_mfma_f32_4x4x4_16b_bf16 v[60:63], v[44:45], v[160:161], v[60:63] cbsz:2 abid:3
  v_mfma_f32_4x4x4_16b_bf16 v[64:67], v[44:45], v[162:163], v[64:67] cbsz:2 abid:3
  s_waitcnt vmcnt(6)
  s_cmp_ge_i32 s101, 6
  s_cbranch_scc1 L_b460
  s_waitcnt vmcnt(5)
  s_cmp_ge_i32 s101, 3
  s_cbranch_scc1 L_b460
  s_waitcnt vmcnt(4)
L_b460:
  buffer_load_dwordx4 v[96:99], v2, s[12:15], s48 offen offset:3072 nt
  s_or_b32 s48, s48, 40960
  s_add_u32 s48, s48, 4096
  s_and_b32 s48, s48, 1003520
  v_mfma_f32_4x4x4_16b_bf16 v[60:63], v[46:47], v[164:165], v[60:63] cbsz:2 abid:0
  v_mfma_f32_4x4x4_16b_bf16 v[64:67], v[46:47], v[166:167], v[64:67] cbsz:2 abid:0
  v_and_b32_dpp v44, v41, v12 quad_perm:[0,0,0,0] row_mask:0xf bank_mask:0xf
  v_and_b32_dpp v45, v41, v13 quad_perm:[0,0,0,0] row_mask:0xf bank_mask:0xf
  s_waitcnt vmcnt(6)
  s_cmp_ge_i32 s101, 8
  s_cbranch_scc1 L_b461
  s_waitcnt vmcnt(5)
  s_cmp_ge_i32 s101, 5
  s_cbranch_scc1 L_b461
  s_waitcnt vmcnt(4)
L_b461:
  buffer_load_dwordx4 v[100:103], v2, s[12:15], s48 offen offset:0 nt
  v_mfma_f32_4x4x4_16b_bf16 v[60:63], v[46:47], v[168:169], v[60:63] cbsz:2 abid:1
  v_mfma_f32_4x4x4_16b_bf16 v[64:67], v[46:47], v[170:171], v[64:67] cbsz:2 abid:1
  s_waitcnt vmcnt(6)
  s_cmp_ge_i32 s101, 7
  s_cbranch_scc1 L_b462
  s_waitcnt vmcnt(5)
  s_cmp_ge_i32 s101, 4
  s_cbranch_scc1 L_b462
  s_waitcnt vmcnt(4)
L_b462:
  buffer_load_dwordx4 v[104:107], v2, s[12:15], s48 offen offset:1024 nt
  v_mfma_f32_4x4x4_16b_bf16 v[60:63], v[46:47], v[172:173], v[60:63] cbsz:2 abid:2
  v_mfma_f32_4x4x4_16b_bf16 v[64:67], v[46:47], v[174:175], v[64:67] cbsz:2 abid:2
  s_waitcnt vmcnt(6)
  s_cmp_ge_i32 s101, 8
  s_cbranch_scc1 L_b463
  s_waitcnt vmcnt(5)
  s_cmp_ge_i32 s101, 5
  s_cbranch_scc1 L_b463
  s_waitcnt vmcnt(4)
L_b463:
  buffer_load_dwordx4 v[108:111], v2, s[12:15], s48 offen offset:2048 nt
  v_mfma_f32_4x4x4_16b_bf16 v[60:63], v[46:47], v[176:177], v[60:63] cbsz:2 abid:3
  v_mfma_f32_4x4x4_16b_bf16 v[64:67], v[46:47], v[178:179], v[64:67] cbsz:2 abid:3
  s_waitcnt vmcnt(6)
  s_memrealtime s[80:81]
L_blk29:
  s_cmp_ge_i32 s101, 6
  s_cbranch_scc1 L_b464
  s_waitcnt vmcnt(5)
  s_cmp_ge_i32 s101, 1
  s_cbranch_scc1 L_b464
  s_waitcnt vmcnt(4)
L_b464:
  buffer_load_dwordx4 v[112:115], v2, s[12:15], s48 offen offset:3072 nt
  s_or_b32 s48, s48, 40960
  s_add_u32 s48, s48, 4096
  s_and_b32 s48, s48, 1003520
  v_mfma_f32_4x4x4_16b_bf16 v[60:63], v[44:45], v[180:181], v[60:63] cbsz:2 abid:0
  v_mfma_f32_4x4x4_16b_bf16 v[64:67], v[44:45], v[182:183], v[64:67] cbsz:2 abid:0
  v_and_b32_dpp v46, v41, v12 quad_perm:[1,1,1,1] row_mask:0xf bank_mask:0xf
  v_and_b32_dpp v47, v41, v13 quad_perm:[1,1,1,1] row_mask:0xf bank_mask:0xf
  s_waitcnt vmcnt(6)
  s_cmp_ge_i32 s101, 8
  s_cbranch_scc1 L_b465
  s_waitcnt vmcnt(5)
  s_cmp_ge_i32 s101, 5
  s_cbranch_scc1 L_b465
  s_waitcnt vmcnt(4)
L_b465:
  buffer_load_dwordx4 v[116:119], v2, s[12:15], s48 offen offset:0 nt
  v_mfma_f32_4x4x4_16b_bf16 v[60:63], v[44:45], v[184:185], v[60:63] cbsz:2 abid:1
  v_mfma_f32_4x4x4_16b_bf16 v[64:67], v[44:45], v[186:187], v[64:67] cbsz:2 abid:1
  s_waitcnt vmcnt(6)
  s_waitcnt lgkmcnt(0)
  s_sub_u32 s101, s80, s84
  s_sub_i32 s101, s101, 6672
  s_mul_i32 s101, s101, 2184
  s_ashr_i32 s101, s101, 16
  s_cmp_ge_i32 s101, 7
  s_cbranch_scc1 L_b466
  s_waitcnt vmcnt(5)
  s_cmp_ge_i32 s101, 4
  s_cbranch_scc1 L_b466
  s_waitcnt vmcnt(4)
L_b466:
  buffer_load_dwordx4 v[120:123], v2, s[12:15], s48 offen offset:1024 nt
  v_mfma_f32_4x4x4_16b_bf16 v[60:63], v[44:45], v[188:189], v[60:63] cbsz:2 abid:2
  v_mfma_f32_4x4x4_16b_bf16 v[64:67], v[44:45], v[190:191], v[64:67] cbsz:2 abid:2
  s_waitcnt vmcnt(6)
  s_cmp_ge_i32 s101, 8
  s_cbranch_scc1 L_b467
  s_waitcnt vmcnt(5)
  s_cmp_ge_i32 s101, 5
  s_cbranch_scc1 L_b467
  s_waitcnt vmcnt(4)
L_b467:
  buffer_load_dwordx4 v[124:127], v2, s[12:15], s48 offen offset:2048 nt
  v_mfma_f32_4x4x4_16b_bf16 v[60:63], v[44:45], v[96:97], v[60:63] cbsz:2 abid:3
  v_mfma_f32_4x4x4_16b_bf16 v[64:67], v[44:45], v[98:99], v[64:67] cbsz:2 abid:3
  s_waitcnt vmcnt(6)
  s_cmp_ge_i32 s101, 6
  s_cbranch_scc1 L_b468
  s_waitcnt vmcnt(5)
  s_cmp_ge_i32 s101, 3
  s_cbranch_scc1 L_b468
  s_waitcnt vmcnt(4)
L_b468:
  buffer_load_dwordx4 v[128:131], v2, s[12:15], s48 offen offset:3072 nt
  s_or_b32 s48, s48, 40960
  s_add_u32 s48, s48, 4096
  s_and_b32 s48, s48, 1003520
  v_mfma_f32_4x4x4_16b_bf16 v[60:63], v[46:47], v[100:101], v[60:63] cbsz:2 abid:0
  v_mfma_f32_4x4x4_16b_bf16 v[64:67], v[46:47], v[102:103], v[64:67] cbsz:2 abid:0
  v_and_b32_dpp v44, v41, v12 quad_perm:[2,2,2,2] row_mask:0xf bank_mask:0xf
  v_and_b32_dpp v45, v41, v13 quad_perm:[2,2,2,2] row_mask:0xf bank_mask:0xf
  s_waitcnt vmcnt(6)
  s_cmp_ge_i32 s101, 8
  s_cbranch_scc1 L_b469
  s_waitcnt vmcnt(5)
  s_cmp_ge_i32 s101, 5
  s_cbranch_scc1 L_b469
  s_waitcnt vmcnt(4)
L_b469:
  buffer_load_dwordx4 v[132:135], v2, s[12:15], s48 offen offset:0 nt
  v_mfma_f32_4x4x4_16b_bf16 v[60:63], v[46:47], v[104:105], v[60:63] cbsz:2 abid:1
  v_mfma_f32_4x4x4_16b_bf16 v[64:67], v[46:47], v[106:107], v[64:67] cbsz:2 abid:1
  s_waitcnt vmcnt(6)
  s_cmp_ge_i32 s101, 7
  s_cbranch_scc1 L_b470
  s_waitcnt vmcnt(5)
  s_cmp_ge_i32 s101, 4
  s_cbranch_scc1 L_b470
  s_waitcnt vmcnt(4)
L_b470:
  buffer_load_dwordx4 v[136:139], v2, s[12:15], s48 offen offset:1024 nt
  v_mfma_f32_4x4x4_16b_bf16 v[60:63], v[46:47], v[108:109], v[60:63] cbsz:2 abid:2
  v_mfma_f32_4x4x4_16b_bf16 v[64:67], v[46:47], v[110:111], v[64:67] cbsz:2 abid:2
  s_waitcnt vmcnt(6)
  s_cmp_ge_i32 s101, 8
  s_cbranch_scc1 L_b471
  s_waitcnt vmcnt(5)
  s_cmp_ge_i32 s101, 5
  s_cbranch_scc1 L_b471
  s_waitcnt vmcnt(4)
L_b471:
  buffer_load_dwordx4 v[140:143], v2, s[12:15], s48 offen offset:2048 nt
  v_mfma_f32_4x4x4_16b_bf16 v[60:63], v[46:47], v[112:113], v[60:63] cbsz:2 abid:3
  v_mfma_f32_4x4x4_16b_bf16 v[64:67], v[46:47], v[114:115], v[64:67] cbsz:2 abid:3
  s_waitcnt vmcnt(6)
  s_cmp_ge_i32 s101, 6
  s_cbranch_scc1 L_b472
  s_waitcnt vmcnt(5)
  s_cmp_ge_i32 s101, 2
  s_cbranch_scc1 L_b472
  s_waitcnt vmcnt(4)
L_b472:
  buffer_load_dwordx4 v[144:147], v2, s[12:15], s48 offen offset:3072 nt
  s_or_b32 s48, s48, 40960
  s_add_u32 s48, s48, 4096
  s_and_b32 s48, s48, 1003520
  v_mfma_f32_4x4x4_16b_bf16 v[60:63], v[44:45], v[116:117], v[60:63] cbsz:2 abid:0
  v_mfma_f32_4x4x4_16b_bf16 v[64:67], v[44:45], v[118:119], v[64:67] cbsz:2 abid:0
  v_and_b32_dpp v46, v41, v12 quad_perm:[3,3,3,3] row_mask:0xf bank_mask:0xf
  v_and_b32_dpp v47, v41, v13 quad_perm:[3,3,3,3] row_mask:0xf bank_mask:0xf
  s_waitcnt vmcnt(6)
  s_cmp_ge_i32 s101, 8
  s_cbranch_scc1 L_b473
  s_waitcnt vmcnt(5)
  s_cmp_ge_i32 s101, 5
  s_cbranch_scc1 L_b473
  s_waitcnt vmcnt(4)
L_b473:
  buffer_load_dwordx4 v[148:151], v0, s[12:15], s48 offen offset:0 nt
  v_mfma_f32_4x4x4_16b_bf16 v[60:63], v[44:45], v[120:121], v[60:63] cbsz:2 abid:1
  v_mfma_f32_4x4x4_16b_bf16 v[64:67], v[44:45], v[122:123], v[64:67] cbsz:2 abid:1
  s_waitcnt vmcnt(6)
  s_cmp_ge_i32 s101, 7
  s_cbranch_scc1 L_b474
  s_waitcnt vmcnt(5)
  s_cmp_ge_i32 s101, 4
  s_cbranch_scc1 L_b474
  s_waitcnt vmcnt(4)
L_b474:
  buffer_load_dwordx4 v[152:155], v0, s[12:15], s48 offen offset:1024 nt
  v_mfma_f32_4x4x4_16b_bf16 v[60:63], v[44:45], v[124:125], v[60:63] cbsz:2 abid:2
  v_mfma_f32_4x4x4_16b_bf16 v[64:67], v[44:45], v[126:127], v[64:67] cbsz:2 abid:2
  s_waitcnt vmcnt(6)
  s_cmp_ge_i32 s101, 8
  s_cbranch_scc1 L_b475
  s_waitcnt vmcnt(5)
  s_cmp_ge_i32 s101, 5
  s_cbranch_scc1 L_b475
  s_waitcnt vmcnt(4)
L_b475:
  buffer_load_dwordx4 v[156:159], v0, s[12:15], s48 offen offset:2048 nt
  v_mfma_f32_4x4x4_16b_bf16 v[60:63], v[44:45], v[128:129], v[60:63] cbsz:2 abid:3
  v_mfma_f32_4x4x4_16b_bf16 v[64:67], v[44:45], v[130:131], v[64:67] cbsz:2 abid:3
  s_waitcnt vmcnt(6)
  s_cmp_ge_i32 s101, 6
  s_cbranch_scc1 L_b476
  s_waitcnt vmcnt(5)
  s_cmp_ge_i32 s101, 3
  s_cbranch_scc1 L_b476
  s_waitcnt vmcnt(4)
L_b476:
  buffer_load_dwordx4 v[160:163], v0, s[12:15], s48 offen offset:3072 nt
  s_or_b32 s48, s48, 40960
  s_add_u32 s48, s48, 4096
  s_and_b32 s48, s48, 1003520
  v_mfma_f32_4x4x4_16b_bf16 v[60:63], v[46:47], v[132:133], v[60:63] cbsz:2 abid:0
  v_mfma_f32_4x4x4_16b_bf16 v[64:67], v[46:47], v[134:135], v[64:67] cbsz:2 abid:0
  v_and_b32_dpp v44, v42, v12 quad_perm:[0,0,0,0] row_mask:0xf bank_mask:0xf
  v_and_b32_dpp v45, v42, v13 quad_perm:[0,0,0,0] row_mask:0xf bank_mask:0xf
  s_waitcnt vmcnt(6)
  s_cmp_ge_i32 s101, 8
  s_cbranch_scc1 L_b477
  s_waitcnt vmcnt(5)
  s_cmp_ge_i32 s101, 5
  s_cbranch_scc1 L_b477
  s_waitcnt vmcnt(4)
L_b477:
  buffer_load_dwordx4 v[164:167], v0, s[12:15], s48 offen offset:0 nt
  v_mfma_f32_4x4x4_16b_bf16 v[60:63], v[46:47], v[136:137], v[60:63] cbsz:2 abid:1
  v_mfma_f32_4x4x4_16b_bf16 v[64:67], v[46:47], v[138:139], v[64:67] cbsz:2 abid:1
  s_waitcnt vmcnt(6)
  s_cmp_ge_i32 s101, 7
  s_cbranch_scc1 L_b478
  s_waitcnt vmcnt(5)
  s_cmp_ge_i32 s101, 4
  s_cbranch_scc1 L_b478
  s_waitcnt vmcnt(4)
L_b478:
  buffer_load_dwordx4 v[168:171], v0, s[12:15], s48 offen offset:1024 nt
  v_mfma_f32_4x4x4_16b_bf16 v[60:63], v[46:47], v[140:141], v[60:63] cbsz:2 abid:2
  v_mfma_f32_4x4x4_16b_bf16 v[64:67], v[46:47], v[142:143], v[64:67] cbsz:2 abid:2
  s_waitcnt vmcnt(6)
  s_cmp_ge_i32 s101, 8
  s_cbranch_scc1 L_b479
  s_waitcnt vmcnt(5)
  s_cmp_ge_i32 s101, 5
  s_cbranch_scc1 L_b479
  s_waitcnt vmcnt(4)
L_b479:
  buffer_load_dwordx4 v[172:175], v0, s[12:15], s48 offen offset:2048 nt
  v_mfma_f32_4x4x4_16b_bf16 v[60:63], v[46:47], v[144:145], v[60:63] cbsz:2 abid:3
  v_mfma_f32_4x4x4_16b_bf16 v[64:67], v[46:47], v[146:147], v[64:67] cbsz:2 abid:3
  s_waitcnt vmcnt(6)
  s_memrealtime s[80:81]
L_blk30:
  s_cmp_ge_i32 s101, 6
  s_cbranch_scc1 L_b480
  s_waitcnt vmcnt(5)
  s_cmp_ge_i32 s101, 1
  s_cbranch_scc1 L_b480
  s_waitcnt vmcnt(4)
L_b480:
  buffer_load_dwordx4 v[176:179], v0, s[12:15], s48 offen offset:3072 nt
  s_or_b32 s48, s48, 40960
  s_add_u32 s48, s48, 4096
  s_and_b32 s48, s48, 1003520
  v_mfma_f32_4x4x4_16b_bf16 v[60:63], v[44:45], v[148:149], v[60:63] cbsz:2 abid:0
  v_mfma_f32_4x4x4_16b_bf16 v[64:67], v[44:45], v[150:151], v[64:67] cbsz:2 abid:0
  v_and_b32_dpp v46, v42, v12 quad_perm:[1,1,1,1] row_mask:0xf bank_mask:0xf
  v_and_b32_dpp v47, v42, v13 quad_perm:[1,1,1,1] row_mask:0xf bank_mask:0xf
  s_waitcnt vmcnt(6)
  s_cmp_ge_i32 s101, 8
  s_cbranch_scc1 L_b481
  s_waitcnt vmcnt(5)
  s_cmp_ge_i32 s101, 5
  s_cbranch_scc1 L_b481
  s_waitcnt vmcnt(4)
L_b481:
  buffer_load_dwordx4 v[180:183], v0, s[12:15], s48 offen offset:0 nt
  v_mfma_f32_4x4x4_16b_bf16 v[60:63], v[44:45], v[152:153], v[60:63] cbsz:2 abid:1
  v_mfma_f32_4x4x4_16b_bf16 v[64:67], v[44:45], v[154:155], v[64:67] cbsz:2 abid:1
  s_waitcnt vmcnt(6)
  s_waitcnt lgkmcnt(0)
  s_sub_u32 s101, s80, s84
  s_sub_i32 s101, s101, 6889
  s_mul_i32 s101, s101, 2184
  s_ashr_i32 s101, s101, 16
  s_cmp_ge_i32 s101, 7
  s_cbranch_scc1 L_b482
  s_waitcnt vmcnt(5)
  s_cmp_ge_i32 s101, 4
  s_cbranch_scc1 L_b482
  s_waitcnt vmcnt(4)
L_b482:
  buffer_load_dwordx4 v[184:187], v0, s[12:15], s48 offen offset:1024 nt
  v_mfma_f32_4x4x4_16b_bf16 v[60:63], v[44:45], v[156:157], v[60:63] cbsz:2 abid:2
  v_mfma_f32_4x4x4_16b_bf16 v[64:67], v[44:45], v[158:159], v[64:67] cbsz:2 abid:2
  s_waitcnt vmcnt(6)
  s_cmp_ge_i32 s101, 8
  s_cbranch_scc1 L_b483
  s_waitcnt vmcnt(5)
  s_cmp_ge_i32 s101, 5
  s_cbranch_scc1 L_b483
  s_waitcnt vmcnt(4)
L_b483:
  buffer_load_dwordx4 v[188:191], v0, s[12:15], s48 offen offset:2048 nt
  v_mfma_f32_4x4x4_16b_bf16 v[60:63], v[44:45], v[160:161], v[60:63] cbsz:2 abid:3
  v_mfma_f32_4x4x4_16b_bf16 v[64:67], v[44:45], v[162:163], v[64:67] cbsz:2 abid:3
  s_waitcnt vmcnt(6)
  s_cmp_ge_i32 s101, 6
  s_cbranch_scc1 L_b484
  s_waitcnt vmcnt(5)
  s_cmp_ge_i32 s101, 3
  s_cbranch_scc1 L_b484
  s_waitcnt vmcnt(4)
L_b484:
  buffer_load_dwordx4 v[96:99], v0, s[12:15], s48 offen offset:3072 nt
  s_or_b32 s48, s48, 40960
  s_add_u32 s48, s48, 4096
  s_and_b32 s48, s48, 1003520
  v_mfma_f32_4x4x4_16b_bf16 v[60:63], v[46:47], v[164:165], v[60:63] cbsz:2 abid:0
  v_mfma_f32_4x4x4_16b_bf16 v[64:67], v[46:47], v[166:167], v[64:67] cbsz:2 abid:0
  v_and_b32_dpp v44, v42, v12 quad_perm:[2,2,2,2] row_mask:0xf bank_mask:0xf
  v_and_b32_dpp v45, v42, v13 quad_perm:[2,2,2,2] row_mask:0xf bank_mask:0xf
  s_waitcnt vmcnt(6)
  s_cmp_ge_i32 s101, 8
  s_cbranch_scc1 L_b485
  s_waitcnt vmcnt(5)
  s_cmp_ge_i32 s101, 5
  s_cbranch_scc1 L_b485
  s_waitcnt vmcnt(4)
L_b485:
  buffer_load_dwordx4 v[100:103], v0, s[12:15], s48 offen offset:0 nt
  v_mfma_f32_4x4x4_16b_bf16 v[60:63], v[46:47], v[168:169], v[60:63] cbsz:2 abid:1
  v_mfma_f32_4x4x4_16b_bf16 v[64:67], v[46:47], v[170:171], v[64:67] cbsz:2 abid:1
  s_waitcnt vmcnt(6)
  s_cmp_ge_i32 s101, 7
  s_cbranch_scc1 L_b486
  s_waitcnt vmcnt(5)
  s_cmp_ge_i32 s101, 4
  s_cbranch_scc1 L_b486
  s_waitcnt vmcnt(4)
L_b486:
  buffer_load_dwordx4 v[104:107], v0, s[12:15], s48 offen offset:1024 nt
  v_mfma_f32_4x4x4_16b_bf16 v[60:63], v[46:47], v[172:173], v[60:63] cbsz:2 abid:2
  v_mfma_f32_4x4x4_16b_bf16 v[64:67], v[46:47], v[174:175], v[64:67] cbsz:2 abid:2
  s_waitcnt vmcnt(6)
  s_cmp_ge_i32 s101, 8
  s_cbranch_scc1 L_b487
  s_waitcnt vmcnt(5)
  s_cmp_ge_i32 s101, 5
  s_cbranch_scc1 L_b487
  s_waitcnt vmcnt(4)
L_b487:
  buffer_load_dwordx4 v[108:111], v0, s[12:15], s48 offen offset:2048 nt
  v_mfma_f32_4x4x4_16b_bf16 v[60:63], v[46:47], v[176:177], v[60:63] cbsz:2 abid:3
  v_mfma_f32_4x4x4_16b_bf16 v[64:67], v[46:47], v[178:179], v[64:67] cbsz:2 abid:3
  s_waitcnt vmcnt(6)
  buffer_load_dwordx4 v[112:115], v0, s[12:15], s48 offen offset:3072 nt
  s_or_b32 s48, s48, 40960
  s_add_u32 s48, s48, 4096
  s_and_b32 s48, s48, 1003520
  buffer_load_dwordx4 v[116:119], v0, s[12:15], s48 offen offset:0 nt
  v_mfma_f32_4x4x4_16b_bf16 v[60:63], v[44:45], v[180:181], v[60:63] cbsz:2 abid:0
  v_mfma_f32_4x4x4_16b_bf16 v[64:67], v[44:45], v[182:183], v[64:67] cbsz:2 abid:0
  v_and_b32_dpp v46, v42, v12 quad_perm:[3,3,3,3] row_mask:0xf bank_mask:0xf
  v_and_b32_dpp v47, v42, v13 quad_perm:[3,3,3,3] row_mask:0xf bank_mask:0xf
  s_waitcnt vmcnt(7)
  buffer_load_dwordx4 v[120:123], v0, s[12:15], s48 offen offset:1024 nt
  v_mfma_f32_4x4x4_16b_bf16 v[60:63], v[44:45], v[184:185], v[60:63] cbsz:2 abid:1
  v_mfma_f32_4x4x4_16b_bf16 v[64:67], v[44:45], v[186:187], v[64:67] cbsz:2 abid:1
  s_waitcnt vmcnt(7)
  buffer_load_dwordx4 v[124:127], v0, s[12:15], s48 offen offset:2048 nt
  v_mfma_f32_4x4x4_16b_bf16 v[60:63], v[44:45], v[188:189], v[60:63] cbsz:2 abid:2
  v_mfma_f32_4x4x4_16b_bf16 v[64:67], v[44:45], v[190:191], v[64:67] cbsz:2 abid:2
  s_waitcnt vmcnt(7)
  buffer_load_dwordx4 v[128:131], v0, s[12:15], s48 offen offset:3072 nt
  s_or_b32 s48, s48, 40960
  s_add_u32 s48, s48, 4096
  s_and_b32 s48, s48, 1003520
  v_mfma_f32_4x4x4_16b_bf16 v[60:63], v[44:45], v[96:97], v[60:63] cbsz:2 abid:3
  v_mfma_f32_4x4x4_16b_bf16 v[64:67], v[44:45], v[98:99], v[64:67] cbsz:2 abid:3
  s_waitcnt vmcnt(7)
  buffer_load_dwordx4 v[132:135], v0, s[12:15], s48 offen offset:0 nt
  v_mfma_f32_4x4x4_16b_bf16 v[60:63], v[46:47], v[100:101], v[60:63] cbsz:2 abid:0
  v_mfma_f32_4x4x4_16b_bf16 v[64:67], v[46:47], v[102:103], v[64:67] cbsz:2 abid:0
  v_and_b32_dpp v44, v43, v12 quad_perm:[0,0,0,0] row_mask:0xf bank_mask:0xf
  v_and_b32_dpp v45, v43, v13 quad_perm:[0,0,0,0] row_mask:0xf bank_mask:0xf
  s_waitcnt vmcnt(7)
  buffer_load_dwordx4 v[136:139], v0, s[12:15], s48 offen offset:1024 nt
  v_mfma_f32_4x4x4_16b_bf16 v[60:63], v[46:47], v[104:105], v[60:63] cbsz:2 abid:1
  v_mfma_f32_4x4x4_16b_bf16 v[64:67], v[46:47], v[106:107], v[64:67] cbsz:2 abid:1
  s_waitcnt vmcnt(7)
  buffer_load_dwordx4 v[140:143], v0, s[12:15], s48 offen offset:2048 nt
  v_mfma_f32_4x4x4_16b_bf16 v[60:63], v[46:47], v[108:109], v[60:63] cbsz:2 abid:2
  v_mfma_f32_4x4x4_16b_bf16 v[64:67], v[46:47], v[110:111], v[64:67] cbsz:2 abid:2
  s_waitcnt vmcnt(7)
  buffer_load_dwordx4 v[144:147], v0, s[12:15], s48 offen offset:3072 nt
  s_or_b32 s48, s48, 40960
  s_add_u32 s48, s48, 4096
  s_and_b32 s48, s48, 1003520
  v_mfma_f32_4x4x4_16b_bf16 v[60:63], v[46:47], v[112:113], v[60:63] cbsz:2 abid:3
  v_mfma_f32_4x4x4_16b_bf16 v[64:67], v[46:47], v[114:115], v[64:67] cbsz:2 abid:3
  s_waitcnt vmcnt(7)
L_blk31:
  buffer_load_dwordx4 v[148:151], v0, s[12:15], s48 offen offset:0 nt
  v_mfma_f32_4x4x4_16b_bf16 v[60:63], v[44:45], v[116:117], v[60:63] cbsz:2 abid:0
  v_mfma_f32_4x4x4_16b_bf16 v[64:67], v[44:45], v[118:119], v[64:67] cbsz:2 abid:0
  v_and_b32_dpp v46, v43, v12 quad_perm:[1,1,1,1] row_mask:0xf bank_mask:0xf
  v_and_b32_dpp v47, v43, v13 quad_perm:[1,1,1,1] row_mask:0xf bank_mask:0xf
  s_waitcnt vmcnt(7)
  buffer_load_dwordx4 v[152:155], v0, s[12:15], s48 offen offset:1024 nt
  v_mfma_f32_4x4x4_16b_bf16 v[60:63], v[44:45], v[120:121], v[60:63] cbsz:2 abid:1
  v_mfma_f32_4x4x4_16b_bf16 v[64:67], v[44:45], v[122:123], v[64:67] cbsz:2 abid:1
  s_waitcnt vmcnt(7)
  buffer_load_dwordx4 v[156:159], v0, s[12:15], s48 offen offset:2048 nt
  v_mfma_f32_4x4x4_16b_bf16 v[60:63], v[44:45], v[124:125], v[60:63] cbsz:2 abid:2
  v_mfma_f32_4x4x4_16b_bf16 v[64:67], v[44:45], v[126:127], v[64:67] cbsz:2 abid:2
  s_waitcnt vmcnt(7)
  buffer_load_dwordx4 v[160:163], v0, s[12:15], s48 offen offset:3072 nt
  s_or_b32 s48, s48, 40960
  s_add_u32 s48, s48, 4096
  s_and_b32 s48, s48, 1003520
  v_mfma_f32_4x4x4_16b_bf16 v[60:63], v[44:45], v[128:129], v[60:63] cbsz:2 abid:3
  v_mfma_f32_4x4x4_16b_bf16 v[64:67], v[44:45], v[130:131], v[64:67] cbsz:2 abid:3
  s_waitcnt vmcnt(7)
  buffer_load_dwordx4 v[164:167], v0, s[12:15], s48 offen offset:0 nt
  v_mfma_f32_4x4x4_16b_bf16 v[60:63], v[46:47], v[132:133], v[60:63] cbsz:2 abid:0
  v_mfma_f32_4x4x4_16b_bf16 v[64:67], v[46:47], v[134:135], v[64:67] cbsz:2 abid:0
  v_and_b32_dpp v44, v43, v12 quad_perm:[2,2,2,2] row_mask:0xf bank_mask:0xf
  v_and_b32_dpp v45, v43, v13 quad_perm:[2,2,2,2] row_mask:0xf bank_mask:0xf
  s_waitcnt vmcnt(7)
  buffer_load_dwordx4 v[168:171], v0, s[12:15], s48 offen offset:1024 nt
  v_mfma_f32_4x4x4_16b_bf16 v[60:63], v[46:47], v[136:137], v[60:63] cbsz:2 abid:1
  v_mfma_f32_4x4x4_16b_bf16 v[64:67], v[46:47], v[138:139], v[64:67] cbsz:2 abid:1
  s_waitcnt vmcnt(7)
  buffer_load_dwordx4 v[172:175], v0, s[12:15], s48 offen offset:2048 nt
  v_mfma_f32_4x4x4_16b_bf16 v[60:63], v[46:47], v[140:141], v[60:63] cbsz:2 abid:2
  v_mfma_f32_4x4x4_16b_bf16 v[64:67], v[46:47], v[142:143], v[64:67] cbsz:2 abid:2
  s_waitcnt vmcnt(7)
  buffer_load_dwordx4 v[176:179], v0, s[12:15], s48 offen offset:3072 nt
  v_mfma_f32_4x4x4_16b_bf16 v[60:63], v[46:47], v[144:145], v[60:63] cbsz:2 abid:3
  v_mfma_f32_4x4x4_16b_bf16 v[64:67], v[46:47], v[146:147], v[64:67] cbsz:2 abid:3
  s_waitcnt vmcnt(7)
  v_mfma_f32_4x4x4_16b_bf16 v[60:63], v[44:45], v[148:149], v[60:63] cbsz:2 abid:0
  v_mfma_f32_4x4x4_16b_bf16 v[64:67], v[44:45], v[150:151], v[64:67] cbsz:2 abid:0
  v_and_b32_dpp v46, v43, v12 quad_perm:[3,3,3,3] row_mask:0xf bank_mask:0xf
  v_and_b32_dpp v47, v43, v13 quad_perm:[3,3,3,3] row_mask:0xf bank_mask:0xf
  s_waitcnt vmcnt(6)
  v_mfma_f32_4x4x4_16b_bf16 v[60:63], v[44:45], v[152:153], v[60:63] cbsz:2 abid:1
  v_mfma_f32_4x4x4_16b_bf16 v[64:67], v[44:45], v[154:155], v[64:67] cbsz:2 abid:1
  s_waitcnt vmcnt(5)
  v_mfma_f32_4x4x4_16b_bf16 v[60:63], v[44:45], v[156:157], v[60:63] cbsz:2 abid:2
  v_mfma_f32_4x4x4_16b_bf16 v[64:67], v[44:45], v[158:159], v[64:67] cbsz:2 abid:2
  s_waitcnt vmcnt(4)
  v_mfma_f32_4x4x4_16b_bf16 v[60:63], v[44:45], v[160:161], v[60:63] cbsz:2 abid:3
  v_mfma_f32_4x4x4_16b_bf16 v[64:67], v[44:45], v[162:163], v[64:67] cbsz:2 abid:3
  s_waitcnt vmcnt(3)
  v_mfma_f32_4x4x4_16b_bf16 v[60:63], v[46:47], v[164:165], v[60:63] cbsz:2 abid:0
  v_mfma_f32_4x4x4_16b_bf16 v[64:67], v[46:47], v[166:167], v[64:67] cbsz:2 abid:0
  s_waitcnt vmcnt(2)
  v_mfma_f32_4x4x4_16b_bf16 v[60:63], v[46:47], v[168:169], v[60:63] cbsz:2 abid:1
  v_mfma_f32_4x4x4_16b_bf16 v[64:67], v[46:47], v[170:171], v[64:67] cbsz:2 abid:1
  s_waitcnt vmcnt(1)
  v_mfma_f32_4x4x4_16b_bf16 v[60:63], v[46:47], v[172:173], v[60:63] cbsz:2 abid:2
  v_mfma_f32_4x4x4_16b_bf16 v[64:67], v[46:47], v[174:175], v[64:67] cbsz:2 abid:2
  s_waitcnt vmcnt(0)
  v_mfma_f32_4x4x4_16b_bf16 v[60:63], v[46:47], v[176:177], v[60:63] cbsz:2 abid:3
  v_mfma_f32_4x4x4_16b_bf16 v[64:67], v[46:47], v[178:179], v[64:67] cbsz:2 abid:3
L_tail:
  s_nop 4
  v_permlane32_swap_b32 v60, v64
  v_permlane32_swap_b32 v61, v65
  v_permlane32_swap_b32 v62, v66
  v_permlane32_swap_b32 v63, v67
  v_add_f32 v60, v60, v64
  v_add_f32 v61, v61, v65
  v_add_f32 v62, v62, v66
  v_add_f32 v63, v63, v67
  s_nop 0
  v_permlane16_swap_b32 v60, v62
  v_permlane16_swap_b32 v61, v63
  v_add_f32 v68, v60, v62
  v_add_f32 v69, v61, v63
  ds_write_b64 v11, v[68:69] offset:4096
  s_waitcnt lgkmcnt(0)
  s_barrier
  ds_read2_b64 v[68:71], v84 offset0:0 offset1:64
  ds_read2_b64 v[72:75], v84 offset0:128 offset1:192
  ds_read2st64_b32 v[28:29], v85 offset0:8 offset1:9
  ds_read2st64_b32 v[30:31], v85 offset0:10 offset1:11
  ds_read2st64_b32 v[32:33], v85 offset0:12 offset1:13
  ds_read2st64_b32 v[34:35], v85 offset0:14 offset1:15
  s_waitcnt lgkmcnt(4)
  v_add_f32 v68, v68, v70
  v_add_f32 v69, v69, v71
  v_add_f32 v72, v72, v74
  v_add_f32 v73, v73, v75
  v_add_f32 v68, v68, v72
  v_add_f32 v69, v69, v73
  v_cvt_pk_bf16_f32 v20, v68, v68
  v_cvt_pk_bf16_f32 v21, v69, v69
  s_nop 0
  v_and_b32_dpp v44, v20, v12 quad_perm:[0,0,0,0] row_mask:0xf bank_mask:0xf
  v_and_b32_dpp v45, v20, v13 quad_perm:[0,0,0,0] row_mask:0xf bank_mask:0xf
  s_nop 1
  v_mfma_f32_4x4x4_16b_bf16 v[60:63], v[44:45], a[128:129], 0 cbsz:2 abid:0
  v_mfma_f32_4x4x4_16b_bf16 v[64:67], v[44:45], a[130:131], 0 cbsz:2 abid:0
  v_and_b32_dpp v46, v21, v12 quad_perm:[0,0,0,0] row_mask:0xf bank_mask:0xf
  v_mfma_f32_4x4x4_16b_bf16 v[60:63], v[44:45], a[160:161], v[60:63] cbsz:2 abid:1
  v_mfma_f32_4x4x4_16b_bf16 v[64:67], v[44:45], a[162:163], v[64:67] cbsz:2 abid:1
  v_and_b32_dpp v47, v21, v13 quad_perm:[0,0,0,0] row_mask:0xf bank_mask:0xf
  v_mfma_f32_4x4x4_16b_bf16 v[60:63], v[44:45], a[192:193], v[60:63] cbsz:2 abid:2
  v_mfma_f32_4x4x4_16b_bf16 v[64:67], v[44:45], a[194:195], v[64:67] cbsz:2 abid:2
  s_nop 0
  v_mfma_f32_4x4x4_16b_bf16 v[60:63], v[44:45], a[224:225], v[60:63] cbsz:2 abid:3
  v_mfma_f32_4x4x4_16b_bf16 v[64:67], v[44:45], a[226:227], v[64:67] cbsz:2 abid:3
  s_nop 0
  v_mfma_f32_4x4x4_16b_bf16 v[60:63], v[46:47], a[132:133], v[60:63] cbsz:2 abid:0
  v_mfma_f32_4x4x4_16b_bf16 v[64:67], v[46:47], a[134:135], v[64:67] cbsz:2 abid:0
  v_and_b32_dpp v44, v20, v12 quad_perm:[1,1,1,1] row_mask:0xf bank_mask:0xf
  v_mfma_f32_4x4x4_16b_bf16 v[60:63], v[46:47], a[164:165], v[60:63] cbsz:2 abid:1
  v_mfma_f32_4x4x4_16b_bf16 v[64:67], v[46:47], a[166:167], v[64:67] cbsz:2 abid:1
  v_and_b32_dpp v45, v20, v13 quad_perm:[1,1,1,1] row_mask:0xf bank_mask:0xf
  v_mfma_f32_4x4x4_16b_bf16 v[60:63], v[46:47], a[196:197], v[60:63] cbsz:2 abid:2
  v_mfma_f32_4x4x4_16b_bf16 v[64:67], v[46:47], a[198:199], v[64:67] cbsz:2 abid:2
  s_nop 0
  v_mfma_f32_4x4x4_16b_bf16 v[60:63], v[46:47], a[228:229], v[60:63] cbsz:2 abid:3
  v_mfma_f32_4x4x4_16b_bf16 v[64:67], v[46:47], a[230:231], v[64:67] cbsz:2 abid:3
  s_nop 0
  v_mfma_f32_4x4x4_16b_bf16 v[60:63], v[44:45], a[136:137], v[60:63] cbsz:2 abid:0
  v_mfma_f32_4x4x4_16b_bf16 v[64:67], v[44:45], a[138:139], v[64:67] cbsz:2 abid:0
  v_and_b32_dpp v46, v21, v12 quad_perm:[1,1,1,1] row_mask:0xf bank_mask:0xf
  v_mfma_f32_4x4x4_16b_bf16 v[60:63], v[44:45], a[168:169], v[60:63] cbsz:2 abid:1
  v_mfma_f32_4x4x4_16b_bf16 v[64:67], v[44:45], a[170:171], v[64:67] cbsz:2 abid:1
  v_and_b32_dpp v47, v21, v13 quad_perm:[1,1,1,1] row_mask:0xf bank_mask:0xf
  v_mfma_f32_4x4x4_16b_bf16 v[60:63], v[44:45], a[200:201], v[60:63] cbsz:2 abid:2
  v_mfma_f32_4x4x4_16b_bf16 v[64:67], v[44:45], a[202:203], v[64:67] cbsz:2 abid:2
  s_nop 0
  v_mfma_f32_4x4x4_16b_bf16 v[60:63], v[44:45], a[232:233], v[60:63] cbsz:2 abid:3
  v_mfma_f32_4x4x4_16b_bf16 v[64:67], v[44:45], a[234:235], v[64:67] cbsz:2 abid:3
  s_nop 0
  v_mfma_f32_4x4x4_16b_bf16 v[60:63], v[46:47], a[140:141], v[60:63] cbsz:2 abid:0
  v_mfma_f32_4x4x4_16b_bf16 v[64:67], v[46:47], a[142:143], v[64:67] cbsz:2 abid:0
  v_and_b32_dpp v44, v20, v12 quad_perm:[2,2,2,2] row_mask:0xf bank_mask:0xf
  v_mfma_f32_4x4x4_16b_bf16 v[60:63], v[46:47], a[172:173], v[60:63] cbsz:2 abid:1
  v_mfma_f32_4x4x4_16b_bf16 v[64:67], v[46:47], a[174:175], v[64:67] cbsz:2 abid:1
  v_and_b32_dpp v45, v20, v13 quad_perm:[2,2,2,2] row_mask:0xf bank_mask:0xf
  v_mfma_f32_4x4x4_16b_bf16 v[60:63], v[46:47], a[204:205], v[60:63] cbsz:2 abid:2
  v_mfma_f32_4x4x4_16b_bf16 v[64:67], v[46:47], a[206:207], v[64:67] cbsz:2 abid:2
  s_nop 0
  v_mfma_f32_4x4x4_16b_bf16 v[60:63], v[46:47], a[236:237], v[60:63] cbsz:2 abid:3
  v_mfma_f32_4x4x4_16b_bf16 v[64:67], v[46:47], a[238:239], v[64:67] cbsz:2 abid:3
  s_nop 0
  v_mfma_f32_4x4x4_16b_bf16 v[60:63], v[44:45], a[144:145], v[60:63] cbsz:2 abid:0
  v_mfma_f32_4x4x4_16b_bf16 v[64:67], v[44:45], a[146:147], v[64:67] cbsz:2 abid:0
  v_and_b32_dpp v46, v21, v12 quad_perm:[2,2,2,2] row_mask:0xf bank_mask:0xf
  v_mfma_f32_4x4x4_16b_bf16 v[60:63], v[44:45], a[176:177], v[60:63] cbsz:2 abid:1
  v_mfma_f32_4x4x4_16b_bf16 v[64:67], v[44:45], a[178:179], v[64:67] cbsz:2 abid:1
  v_and_b32_dpp v47, v21, v13 quad_perm:[2,2,2,2] row_mask:0xf bank_mask:0xf
  v_mfma_f32_4x4x4_16b_bf16 v[60:63], v[44:45], a[208:209], v[60:63] cbsz:2 abid:2
  v_mfma_f32_4x4x4_16b_bf16 v[64:67], v[44:45], a[210:211], v[64:67] cbsz:2 abid:2
  s_nop 0
  v_mfma_f32_4x4x4_16b_bf16 v[60:63], v[44:45], a[240:241], v[60:63] cbsz:2 abid:3
  v_mfma_f32_4x4x4_16b_bf16 v[64:67], v[44:45], a[242:243], v[64:67] cbsz:2 abid:3
  s_nop 0
  v_mfma_f32_4x4x4_16b_bf16 v[60:63], v[46:47], a[148:149], v[60:63] cbsz:2 abid:0
  v_mfma_f32_4x4x4_16b_bf16 v[64:67], v[46:47], a[150:151], v[64:67] cbsz:2 abid:0
  v_and_b32_dpp v44, v20, v12 quad_perm:[3,3,3,3] row_mask:0xf bank_mask:0xf
  v_mfma_f32_4x4x4_16b_bf16 v[60:63], v[46:47], a[180:181], v[60:63] cbsz:2 abid:1
  v_mfma_f32_4x4x4_16b_bf16 v[64:67], v[46:47], a[182:183], v[64:67] cbsz:2 abid:1
  v_and_b32_dpp v45, v20, v13 quad_perm:[3,3,3,3] row_mask:0xf bank_mask:0xf
  v_mfma_f32_4x4x4_16b_bf16 v[60:63], v[46:47], a[212:213], v[60:63] cbsz:2 abid:2
  v_mfma_f32_4x4x4_16b_bf16 v[64:67], v[46:47], a[214:215], v[64:67] cbsz:2 abid:2
  s_nop 0
  v_mfma_f32_4x4x4_16b_bf16 v[60:63], v[46:47], a[244:245], v[60:63] cbsz:2 abid:3
  v_mfma_f32_4x4x4_16b_bf16 v[64:67], v[46:47], a[246:247], v[64:67] cbsz:2 abid:3
  s_nop 0
  v_mfma_f32_4x4x4_16b_bf16 v[60:63], v[44:45], a[152:153], v[60:63] cbsz:2 abid:0
  v_mfma_f32_4x4x4_16b_bf16 v[64:67], v[44:45], a[154:155], v[64:67] cbsz:2 abid:0
  v_and_b32_dpp v46, v21, v12 quad_perm:[3,3,3,3] row_mask:0xf bank_mask:0xf
  v_mfma_f32_4x4x4_16b_bf16 v[60:63], v[44:45], a[184:185], v[60:63] cbsz:2 abid:1
  v_mfma_f32_4x4x4_16b_bf16 v[64:67], v[44:45], a[186:187], v[64:67] cbsz:2 abid:1
  v_and_b32_dpp v47, v21, v13 quad_perm:[3,3,3,3] row_mask:0xf bank_mask:0xf
  v_mfma_f32_4x4x4_16b_bf16 v[60:63], v[44:45], a[216:217], v[60:63] cbsz:2 abid:2
  v_mfma_f32_4x4x4_16b_bf16 v[64:67], v[44:45], a[218:219], v[64:67] cbsz:2 abid:2
  s_nop 0
  v_mfma_f32_4x4x4_16b_bf16 v[60:63], v[44:45], a[248:249], v[60:63] cbsz:2 abid:3
  v_mfma_f32_4x4x4_16b_bf16 v[64:67], v[44:45], a[250:251], v[64:67] cbsz:2 abid:3
  s_nop 0
  v_mfma_f32_4x4x4_16b_bf16 v[60:63], v[46:47], a[156:157], v[60:63] cbsz:2 abid:0
  v_mfma_f32_4x4x4_16b_bf16 v[64:67], v[46:47], a[158:159], v[64:67] cbsz:2 abid:0
  s_nop 0
  v_mfma_f32_4x4x4_16b_bf16 v[60:63], v[46:47], a[188:189], v[60:63] cbsz:2 abid:1
  v_mfma_f32_4x4x4_16b_bf16 v[64:67], v[46:47], a[190:191], v[64:67] cbsz:2 abid:1
  s_nop 0
  v_mfma_f32_4x4x4_16b_bf16 v[60:63], v[46:47], a[220:221], v[60:63] cbsz:2 abid:2
  v_mfma_f32_4x4x4_16b_bf16 v[64:67], v[46:47], a[222:223], v[64:67] cbsz:2 abid:2
  s_nop 0
  v_mfma_f32_4x4x4_16b_bf16 v[60:63], v[46:47], a[252:253], v[60:63] cbsz:2 abid:3
  v_mfma_f32_4x4x4_16b_bf16 v[64:67], v[46:47], a[254:255], v[64:67] cbsz:2 abid:3
  s_nop 4
  v_permlane32_swap_b32 v60, v64
  v_permlane32_swap_b32 v61, v65
  v_permlane32_swap_b32 v62, v66
  v_permlane32_swap_b32 v63, v67
  v_add_f32 v60, v60, v64
  v_add_f32 v61, v61, v65
  v_add_f32 v62, v62, v66
  v_add_f32 v63, v63, v67
  s_nop 0
  v_permlane16_swap_b32 v60, v62
  v_permlane16_swap_b32 v61, v63
  v_add_f32 v92, v60, v62
  v_add_f32 v93, v61, v63
  buffer_store_dwordx4 v[92:95], v8, s[28:31], s86 offen sc1
  s_lshl_b32 s50, s90, 5
  s_add_u32 s50, s50, s91
  s_lshl_b32 s50, s50, 12
  v_lshl_add_u32 v3, v11, 1, s50
  v_mov_b32 v94, s56
  v_mov_b32 v95, s57
  s_getreg_b32 s95, hwreg(HW_REG_XCC_ID, 0, 4)
  v_mov_b32 v93, s95
  v_lshlrev_b32 v89, 16, v14
  v_and_b32 v90, 0xffff0000, v14
  s_waitcnt lgkmcnt(0)
  v_add_f32 v28, v28, v30
  v_add_f32 v29, v29, v31
  v_add_f32 v32, v32, v34
  v_add_f32 v33, v33, v35
  v_add_f32 v28, v28, v32
  v_add_f32 v29, v29, v33
  s_sleep 16
  buffer_load_dwordx4 v[96:99], v9, s[28:31], s86 offen sc1
  s_mov_b32 s58, 200000
L_p1:
  s_waitcnt vmcnt(0)
  v_cmp_eq_u64 vcc, s[56:57], v[98:99]
  s_nop 1
  v_cndmask_b32 v24, v24, v96, vcc
  v_cndmask_b32 v25, v25, v97, vcc
  s_andn2_b64 exec, exec, vcc
  s_cbranch_scc0 L_p1_ok
  s_sub_u32 s58, s58, 1
  buffer_load_dwordx4 v[96:99], v9, s[28:31], s86 offen sc1
  s_cmp_lg_u32 s58, 0
  s_cbranch_scc1 L_p1
L_p1_ok:
  s_mov_b64 exec, -1
  v_add_f32_dpp v24, v24, v24 row_ror:8 row_mask:0xf bank_mask:0xf
  v_add_f32_dpp v25, v25, v25 row_ror:8 row_mask:0xf bank_mask:0xf
  s_nop 0
  v_add_f32_dpp v24, v24, v24 row_ror:4 row_mask:0xf bank_mask:0xf
  v_add_f32_dpp v25, v25, v25 row_ror:4 row_mask:0xf bank_mask:0xf
  s_nop 0
  v_add_f32_dpp v24, v24, v24 row_ror:2 row_mask:0xf bank_mask:0xf
  v_add_f32_dpp v25, v25, v25 row_ror:2 row_mask:0xf bank_mask:0xf
  v_mov_b32 v70, v24
  v_mov_b32 v71, v25
  s_nop 0
  v_permlane16_swap_b32 v24, v70
  v_permlane16_swap_b32 v25, v71
  v_add_f32 v24, v24, v70
  v_add_f32 v25, v25, v71
  v_mov_b32 v70, v24
  v_mov_b32 v71, v25
  s_nop 0
  v_permlane32_swap_b32 v24, v70
  v_permlane32_swap_b32 v25, v71
  v_add_f32 v24, v24, v70
  v_add_f32 v25, v25, v71
  v_cvt_pk_bf16_f32 v24, v24, v25
  v_lshlrev_b32 v70, 16, v24
  v_and_b32 v71, 0xffff0000, v24
  v_add_f32 v70, v70, v89
  v_add_f32 v71, v71, v90
  v_cvt_pk_bf16_f32 v92, v70, v71
  s_mov_b64 exec, 3
  buffer_store_dwordx4 v[92:95], v88, s[28:31], s47 offen sc1
  s_mov_b64 exec, -1
  s_mov_b32 s77, 7340032
  s_mov_b32 s82, 8388608
  v_lshlrev_b32 v89, 16, v92
  v_and_b32 v90, 0xffff0000, v92
  s_sleep 20
  buffer_load_dwordx4 v[112:115], v88, s[28:31], s94 offen sc1
  s_mov_b32 s58, 200000
L_h:
  s_waitcnt vmcnt(0)
  v_cmp_eq_u64 vcc, s[56:57], v[114:115]
  s_nop 1
  v_cndmask_b32 v24, v24, v112, vcc
  s_andn2_b64 exec, exec, vcc
  s_cbranch_scc0 L_h_ok
  s_sub_u32 s58, s58, 1
  buffer_load_dwordx4 v[112:115], v88, s[28:31], s94 offen sc1
  s_cmp_lg_u32 s58, 0
  s_cbranch_scc1 L_h
L_h_ok:
  s_mov_b64 exec, -1
  v_lshlrev_b32 v36, 16, v24
  v_and_b32 v37, 0xffff0000, v24
  v_and_b32 v20, 0xffff, v24
  v_lshrrev_b32 v21, 16, v24
  v_or_b32 v20, v20, v36
  v_or_b32 v21, v21, v37
  v_add_f32 v38, v36, v37
  v_and_b32_dpp v44, v20, v12 quad_perm:[0,0,0,0] row_mask:0xf bank_mask:0xf
  v_and_b32_dpp v45, v20, v13 quad_perm:[0,0,0,0] row_mask:0xf bank_mask:0xf
  s_nop 1
  v_mfma_f32_4x4x4_16b_bf16 v[60:63], v[44:45], a[0:1], 0 cbsz:2 abid:0
  v_mfma_f32_4x4x4_16b_bf16 v[64:67], v[44:45], a[2:3], 0 cbsz:2 abid:0
  v_and_b32_dpp v46, v21, v12 quad_perm:[0,0,0,0] row_mask:0xf bank_mask:0xf
  v_add_f32_dpp v38, v38, v38 row_ror:8 row_mask:0xf bank_mask:0xf
  v_mfma_f32_4x4x4_16b_bf16 v[60:63], v[44:45], a[32:33], v[60:63] cbsz:2 abid:1
  v_mfma_f32_4x4x4_16b_bf16 v[64:67], v[44:45], a[34:35], v[64:67] cbsz:2 abid:1
  v_and_b32_dpp v47, v21, v13 quad_perm:[0,0,0,0] row_mask:0xf bank_mask:0xf
  v_mfma_f32_4x4x4_16b_bf16 v[60:63], v[44:45], a[64:65], v[60:63] cbsz:2 abid:2
  v_mfma_f32_4x4x4_16b_bf16 v[64:67], v[44:45], a[66:67], v[64:67] cbsz:2 abid:2
  v_add_f32_dpp v38, v38, v38 row_ror:4 row_mask:0xf bank_mask:0xf
  s_nop 1
  v_add_f32_dpp v38, v38, v38 row_ror:2 row_mask:0xf bank_mask:0xf
  v_mfma_f32_4x4x4_16b_bf16 v[60:63], v[44:45], a[96:97], v[60:63] cbsz:2 abid:3
  v_mfma_f32_4x4x4_16b_bf16 v[64:67], v[44:45], a[98:99], v[64:67] cbsz:2 abid:3
  v_add_f32_dpp v38, v38, v38 row_ror:1 row_mask:0xf bank_mask:0xf
  v_mfma_f32_4x4x4_16b_bf16 v[60:63], v[46:47], a[4:5], v[60:63] cbsz:2 abid:0
  v_mfma_f32_4x4x4_16b_bf16 v[64:67], v[46:47], a[6:7], v[64:67] cbsz:2 abid:0
  v_and_b32_dpp v44, v20, v12 quad_perm:[1,1,1,1] row_mask:0xf bank_mask:0xf
  v_mov_b32 v39, v38
  v_mfma_f32_4x4x4_16b_bf16 v[60:63], v[46:47], a[36:37], v[60:63] cbsz:2 abid:1
  v_mfma_f32_4x4x4_16b_bf16 v[64:67], v[46:47], a[38:39], v[64:67] cbsz:2 abid:1
  v_and_b32_dpp v45, v20, v13 quad_perm:[1,1,1,1] row_mask:0xf bank_mask:0xf
  v_mfma_f32_4x4x4_16b_bf16 v[60:63], v[46:47], a[68:69], v[60:63] cbsz:2 abid:2
  v_mfma_f32_4x4x4_16b_bf16 v[64:67], v[46:47], a[70:71], v[64:67] cbsz:2 abid:2
  v_permlane16_swap_b32 v38, v39
  v_add_f32 v38, v38, v39
  v_mfma_f32_4x4x4_16b_bf16 v[60:63], v[46:47], a[100:101], v[60:63] cbsz:2 abid:3
  v_mfma_f32_4x4x4_16b_bf16 v[64:67], v[46:47], a[102:103], v[64:67] cbsz:2 abid:3
  v_mov_b32 v39, v38
  v_mfma_f32_4x4x4_16b_bf16 v[60:63], v[44:45], a[8:9], v[60:63] cbsz:2 abid:0
  v_mfma_f32_4x4x4_16b_bf16 v[64:67], v[44:45], a[10:11], v[64:67] cbsz:2 abid:0
  v_and_b32_dpp v46, v21, v12 quad_perm:[1,1,1,1] row_mask:0xf bank_mask:0xf
  v_permlane32_swap_b32 v38, v39
  v_mfma_f32_4x4x4_16b_bf16 v[60:63], v[44:45], a[40:41], v[60:63] cbsz:2 abid:1
  v_mfma_f32_4x4x4_16b_bf16 v[64:67], v[44:45], a[42:43], v[64:67] cbsz:2 abid:1
  v_and_b32_dpp v47, v21, v13 quad_perm:[1,1,1,1] row_mask:0xf bank_mask:0xf
  v_mfma_f32_4x4x4_16b_bf16 v[60:63], v[44:45], a[72:73], v[60:63] cbsz:2 abid:2
  v_mfma_f32_4x4x4_16b_bf16 v[64:67], v[44:45], a[74:75], v[64:67] cbsz:2 abid:2
  v_add_f32 v38, v38, v39
  v_mul_f32 v38, 0x3c000000, v38
  v_mfma_f32_4x4x4_16b_bf16 v[60:63], v[44:45], a[104:105], v[60:63] cbsz:2 abid:3
  v_mfma_f32_4x4x4_16b_bf16 v[64:67], v[44:45], a[106:107], v[64:67] cbsz:2 abid:3
  v_sub_f32 v36, v36, v38
  v_mfma_f32_4x4x4_16b_bf16 v[60:63], v[46:47], a[12:13], v[60:63] cbsz:2 abid:0
  v_mfma_f32_4x4x4_16b_bf16 v[64:67], v[46:47], a[14:15], v[64:67] cbsz:2 abid:0
  v_and_b32_dpp v44, v20, v12 quad_perm:[2,2,2,2] row_mask:0xf bank_mask:0xf
  v_sub_f32 v37, v37, v38
  v_mfma_f32_4x4x4_16b_bf16 v[60:63], v[46:47], a[44:45], v[60:63] cbsz:2 abid:1
  v_mfma_f32_4x4x4_16b_bf16 v[64:67], v[46:47], a[46:47], v[64:67] cbsz:2 abid:1
  v_and_b32_dpp v45, v20, v13 quad_perm:[2,2,2,2] row_mask:0xf bank_mask:0xf
  v_mfma_f32_4x4x4_16b_bf16 v[60:63], v[46:47], a[76:77], v[60:63] cbsz:2 abid:2
  v_mfma_f32_4x4x4_16b_bf16 v[64:67], v[46:47], a[78:79], v[64:67] cbsz:2 abid:2
  v_mul_f32 v36, v36, v36
  v_fmac_f32 v36, v37, v37
  v_mfma_f32_4x4x4_16b_bf16 v[60:63], v[46:47], a[108:109], v[60:63] cbsz:2 abid:3
  v_mfma_f32_4x4x4_16b_bf16 v[64:67], v[46:47], a[110:111], v[64:67] cbsz:2 abid:3
  v_add_f32_dpp v36, v36, v36 row_ror:8 row_mask:0xf bank_mask:0xf
  v_mfma_f32_4x4x4_16b_bf16 v[60:63], v[44:45], a[16:17], v[60:63] cbsz:2 abid:0
  v_mfma_f32_4x4x4_16b_bf16 v[64:67], v[44:45], a[18:19], v[64:67] cbsz:2 abid:0
  v_and_b32_dpp v46, v21, v12 quad_perm:[2,2,2,2] row_mask:0xf bank_mask:0xf
  v_add_f32_dpp v36, v36, v36 row_ror:4 row_mask:0xf bank_mask:0xf
  v_mfma_f32_4x4x4_16b_bf16 v[60:63], v[44:45], a[48:49], v[60:63] cbsz:2 abid:1
  v_mfma_f32_4x4x4_16b_bf16 v[64:67], v[44:45], a[50:51], v[64:67] cbsz:2 abid:1
  v_and_b32_dpp v47, v21, v13 quad_perm:[2,2,2,2] row_mask:0xf bank_mask:0xf
  v_mfma_f32_4x4x4_16b_bf16 v[60:63], v[44:45], a[80:81], v[60:63] cbsz:2 abid:2
  v_mfma_f32_4x4x4_16b_bf16 v[64:67], v[44:45], a[82:83], v[64:67] cbsz:2 abid:2
  v_add_f32_dpp v36, v36, v36 row_ror:2 row_mask:0xf bank_mask:0xf
  s_nop 1
  v_add_f32_dpp v36, v36, v36 row_ror:1 row_mask:0xf bank_mask:0xf
  v_mfma_f32_4x4x4_16b_bf16 v[60:63], v[44:45], a[112:113], v[60:63] cbsz:2 abid:3
  v_mfma_f32_4x4x4_16b_bf16 v[64:67], v[44:45], a[114:115], v[64:67] cbsz:2 abid:3
  v_mov_b32 v39, v36
  v_mfma_f32_4x4x4_16b_bf16 v[60:63], v[46:47], a[20:21], v[60:63] cbsz:2 abid:0
  v_mfma_f32_4x4x4_16b_bf16 v[64:67], v[46:47], a[22:23], v[64:67] cbsz:2 abid:0
  v_and_b32_dpp v44, v20, v12 quad_perm:[3,3,3,3] row_mask:0xf bank_mask:0xf
  v_permlane16_swap_b32 v36, v39
  v_mfma_f32_4x4x4_16b_bf16 v[60:63], v[46:47], a[52:53], v[60:63] cbsz:2 abid:1
  v_mfma_f32_4x4x4_16b_bf16 v[64:67], v[46:47], a[54:55], v[64:67] cbsz:2 abid:1
  v_and_b32_dpp v45, v20, v13 quad_perm:[3,3,3,3] row_mask:0xf bank_mask:0xf
  v_mfma_f32_4x4x4_16b_bf16 v[60:63], v[46:47], a[84:85], v[60:63] cbsz:2 abid:2
  v_mfma_f32_4x4x4_16b_bf16 v[64:67], v[46:47], a[86:87], v[64:67] cbsz:2 abid:2
  v_add_f32 v36, v36, v39
  v_mov_b32 v39, v36
  v_mfma_f32_4x4x4_16b_bf16 v[60:63], v[46:47], a[116:117], v[60:63] cbsz:2 abid:3
  v_mfma_f32_4x4x4_16b_bf16 v[64:67], v[46:47], a[118:119], v[64:67] cbsz:2 abid:3
  v_permlane32_swap_b32 v36, v39
  v_mfma_f32_4x4x4_16b_bf16 v[60:63], v[44:45], a[24:25], v[60:63] cbsz:2 abid:0
  v_mfma_f32_4x4x4_16b_bf16 v[64:67], v[44:45], a[26:27], v[64:67] cbsz:2 abid:0
  v_and_b32_dpp v46, v21, v12 quad_perm:[3,3,3,3] row_mask:0xf bank_mask:0xf
  v_add_f32 v36, v36, v39
  v_mfma_f32_4x4x4_16b_bf16 v[60:63], v[44:45], a[56:57], v[60:63] cbsz:2 abid:1
  v_mfma_f32_4x4x4_16b_bf16 v[64:67], v[44:45], a[58:59], v[64:67] cbsz:2 abid:1
  v_and_b32_dpp v47, v21, v13 quad_perm:[3,3,3,3] row_mask:0xf bank_mask:0xf
  v_mfma_f32_4x4x4_16b_bf16 v[60:63], v[44:45], a[88:89], v[60:63] cbsz:2 abid:2
  v_mfma_f32_4x4x4_16b_bf16 v[64:67], v[44:45], a[90:91], v[64:67] cbsz:2 abid:2
  v_mov_b32 v37, v38
  v_mfma_f32_4x4x4_16b_bf16 v[60:63], v[44:45], a[120:121], v[60:63] cbsz:2 abid:3
  v_mfma_f32_4x4x4_16b_bf16 v[64:67], v[44:45], a[122:123], v[64:67] cbsz:2 abid:3
  s_nop 0
  v_mfma_f32_4x4x4_16b_bf16 v[60:63], v[46:47], a[28:29], v[60:63] cbsz:2 abid:0
  v_mfma_f32_4x4x4_16b_bf16 v[64:67], v[46:47], a[30:31], v[64:67] cbsz:2 abid:0
  s_nop 0
  v_mfma_f32_4x4x4_16b_bf16 v[60:63], v[46:47], a[60:61], v[60:63] cbsz:2 abid:1
  v_mfma_f32_4x4x4_16b_bf16 v[64:67], v[46:47], a[62:63], v[64:67] cbsz:2 abid:1
  s_nop 0
  v_mfma_f32_4x4x4_16b_bf16 v[60:63], v[46:47], a[92:93], v[60:63] cbsz:2 abid:2
  v_mfma_f32_4x4x4_16b_bf16 v[64:67], v[46:47], a[94:95], v[64:67] cbsz:2 abid:2
  s_nop 0
  v_mfma_f32_4x4x4_16b_bf16 v[60:63], v[46:47], a[124:125], v[60:63] cbsz:2 abid:3
  v_mfma_f32_4x4x4_16b_bf16 v[64:67], v[46:47], a[126:127], v[64:67] cbsz:2 abid:3
  s_lshl_b32 s50, s3, 3
  v_mov_b32 v39, s50
  s_mov_b64 exec, 1
  ds_write_b64 v39, v[36:37] offset:10240
  s_mov_b64 exec, -1
  v_mov_b32 v39, 0
  v_permlane32_swap_b32 v60, v64
  v_permlane32_swap_b32 v61, v65
  v_permlane32_swap_b32 v62, v66
  v_permlane32_swap_b32 v63, v67
  v_add_f32 v60, v60, v64
  v_add_f32 v61, v61, v65
  v_add_f32 v62, v62, v66
  v_add_f32 v63, v63, v67
  s_nop 0
  v_permlane16_swap_b32 v60, v62
  v_permlane16_swap_b32 v61, v63
  v_add_f32 v68, v60, v62
  v_add_f32 v69, v61, v63
  ds_write_b64 v11, v[68:69] offset:6144
  s_waitcnt lgkmcnt(0)
  s_barrier
  ds_read_b128 v[44:47], v39 offset:10240
  ds_read_b128 v[48:51], v39 offset:10256
  ds_read2st64_b32 v[68:69], v85 offset0:0 offset1:1
  ds_read2st64_b32 v[70:71], v85 offset0:2 offset1:3
  ds_read2st64_b32 v[72:73], v85 offset0:4 offset1:5
  ds_read2st64_b32 v[74:75], v85 offset0:6 offset1:7
  s_waitcnt lgkmcnt(4)
  v_add_f32 v52, v45, v47
  v_add_f32 v53, v49, v51
  v_add_f32 v44, v44, v46
  v_add_f32 v52, v52, v53
  v_add_f32 v48, v48, v50
  v_mul_f32 v52, 0x3e800000, v52
  v_add_f32 v44, v44, v48
  v_sub_f32 v45, v45, v52
  v_sub_f32 v47, v47, v52
  v_sub_f32 v49, v49, v52
  v_sub_f32 v51, v51, v52
  v_mul_f32 v45, v45, v45
  v_mul_f32 v49, v49, v49
  v_fmac_f32 v45, v47, v47
  v_fmac_f32 v49, v51, v51
  v_mul_f32 v44, 0x3b000000, v44
  v_add_f32 v45, v45, v49
  v_fmac_f32 v44, 0x3e800000, v45
  v_cvt_pk_bf16_f32 v53, v52, v44
  s_waitcnt lgkmcnt(0)
  v_add_f32 v68, v68, v70
  v_lshlrev_b32 v52, 16, v53
  v_and_b32 v53, 0xffff0000, v53
  v_add_f32 v69, v69, v71
  v_add_f32 v53, 0x3727c5ac, v53
  v_add_f32 v72, v72, v74
  v_cvt_pk_bf16_f32 v53, v53, v53
  v_add_f32 v73, v73, v75
  v_and_b32 v53, 0xffff0000, v53
  v_add_f32 v68, v68, v72
  v_sqrt_f32 v53, v53
  v_add_f32 v69, v69, v73
  v_cvt_pk_bf16_f32 v53, v53, v53
  v_fma_f32 v68, -v52, v28, v68
  v_and_b32 v53, 0xffff0000, v53
  v_fma_f32 v69, -v52, v29, v69
  v_rcp_f32 v53, v53
  s_nop 0
  v_mul_f32 v68, v68, v53
  v_mul_f32 v69, v69, v53
  v_cvt_pk_bf16_f32 v68, v68, v69
  v_and_b32 v69, 0xffff0000, v68
  v_lshlrev_b32 v68, 16, v68
  v_max_f32 v68, 0, v68
  v_mul_f32 v68, v68, v69
  v_cvt_pk_bf16_f32 v20, v68, v68
  s_nop 1
  v_and_b32_dpp v44, v20, v12 quad_perm:[0,0,0,0] row_mask:0xf bank_mask:0xf
  v_and_b32_dpp v45, v20, v13 quad_perm:[0,0,0,0] row_mask:0xf bank_mask:0xf
  s_nop 1
  v_mfma_f32_4x4x4_16b_bf16 v[60:63], v[44:45], v[192:193], 0 cbsz:2 abid:0
  v_mfma_f32_4x4x4_16b_bf16 v[64:67], v[44:45], v[194:195], 0 cbsz:2 abid:0
  v_and_b32_dpp v46, v20, v12 quad_perm:[1,1,1,1] row_mask:0xf bank_mask:0xf
  v_mfma_f32_4x4x4_16b_bf16 v[60:63], v[44:45], v[208:209], v[60:63] cbsz:2 abid:1
  v_mfma_f32_4x4x4_16b_bf16 v[64:67], v[44:45], v[210:211], v[64:67] cbsz:2 abid:1
  v_and_b32_dpp v47, v20, v13 quad_perm:[1,1,1,1] row_mask:0xf bank_mask:0xf
  v_mfma_f32_4x4x4_16b_bf16 v[60:63], v[44:45], v[224:225], v[60:63] cbsz:2 abid:2
  v_mfma_f32_4x4x4_16b_bf16 v[64:67], v[44:45], v[226:227], v[64:67] cbsz:2 abid:2
  s_nop 0
  v_mfma_f32_4x4x4_16b_bf16 v[60:63], v[44:45], v[240:241], v[60:63] cbsz:2 abid:3
  v_mfma_f32_4x4x4_16b_bf16 v[64:67], v[44:45], v[242:243], v[64:67] cbsz:2 abid:3
  s_nop 0
  v_mfma_f32_4x4x4_16b_bf16 v[60:63], v[46:47], v[196:197], v[60:63] cbsz:2 abid:0
  v_mfma_f32_4x4x4_16b_bf16 v[64:67], v[46:47], v[198:199], v[64:67] cbsz:2 abid:0
  v_and_b32_dpp v44, v20, v12 quad_perm:[2,2,2,2] row_mask:0xf bank_mask:0xf
  v_mfma_f32_4x4x4_16b_bf16 v[60:63], v[46:47], v[212:213], v[60:63] cbsz:2 abid:1
  v_mfma_f32_4x4x4_16b_bf16 v[64:67], v[46:47], v[214:215], v[64:67] cbsz:2 abid:1
  v_and_b32_dpp v45, v20, v13 quad_perm:[2,2,2,2] row_mask:0xf bank_mask:0xf
  v_mfma_f32_4x4x4_16b_bf16 v[60:63], v[46:47], v[228:229], v[60:63] cbsz:2 abid:2
  v_mfma_f32_4x4x4_16b_bf16 v[64:67], v[46:47], v[230:231], v[64:67] cbsz:2 abid:2
  s_nop 0
  v_mfma_f32_4x4x4_16b_bf16 v[60:63], v[46:47], v[244:245], v[60:63] cbsz:2 abid:3
  v_mfma_f32_4x4x4_16b_bf16 v[64:67], v[46:47], v[246:247], v[64:67] cbsz:2 abid:3
  s_nop 0
  v_mfma_f32_4x4x4_16b_bf16 v[60:63], v[44:45], v[200:201], v[60:63] cbsz:2 abid:0
  v_mfma_f32_4x4x4_16b_bf16 v[64:67], v[44:45], v[202:203], v[64:67] cbsz:2 abid:0
  v_and_b32_dpp v46, v20, v12 quad_perm:[3,3,3,3] row_mask:0xf bank_mask:0xf
  v_mfma_f32_4x4x4_16b_bf16 v[60:63], v[44:45], v[216:217], v[60:63] cbsz:2 abid:1
  v_mfma_f32_4x4x4_16b_bf16 v[64:67], v[44:45], v[218:219], v[64:67] cbsz:2 abid:1
  v_and_b32_dpp v47, v20, v13 quad_perm:[3,3,3,3] row_mask:0xf bank_mask:0xf
  v_mfma_f32_4x4x4_16b_bf16 v[60:63], v[44:45], v[232:233], v[60:63] cbsz:2 abid:2
  v_mfma_f32_4x4x4_16b_bf16 v[64:67], v[44:45], v[234:235], v[64:67] cbsz:2 abid:2
  s_nop 0
  v_mfma_f32_4x4x4_16b_bf16 v[60:63], v[44:45], v[248:249], v[60:63] cbsz:2 abid:3
  v_mfma_f32_4x4x4_16b_bf16 v[64:67], v[44:45], v[250:251], v[64:67] cbsz:2 abid:3
  s_nop 0
  v_mfma_f32_4x4x4_16b_bf16 v[60:63], v[46:47], v[204:205], v[60:63] cbsz:2 abid:0
  v_mfma_f32_4x4x4_16b_bf16 v[64:67], v[46:47], v[206:207], v[64:67] cbsz:2 abid:0
  s_nop 0
  v_mfma_f32_4x4x4_16b_bf16 v[60:63], v[46:47], v[220:221], v[60:63] cbsz:2 abid:1
  v_mfma_f32_4x4x4_16b_bf16 v[64:67], v[46:47], v[222:223], v[64:67] cbsz:2 abid:1
  s_nop 0
  v_mfma_f32_4x4x4_16b_bf16 v[60:63], v[46:47], v[236:237], v[60:63] cbsz:2 abid:2
  v_mfma_f32_4x4x4_16b_bf16 v[64:67], v[46:47], v[238:239], v[64:67] cbsz:2 abid:2
  s_nop 0
  v_mfma_f32_4x4x4_16b_bf16 v[60:63], v[46:47], v[252:253], v[60:63] cbsz:2 abid:3
  v_mfma_f32_4x4x4_16b_bf16 v[64:67], v[46:47], v[254:255], v[64:67] cbsz:2 abid:3
  s_nop 4
  v_permlane32_swap_b32 v60, v64
  v_permlane32_swap_b32 v61, v65
  v_permlane32_swap_b32 v62, v66
  v_permlane32_swap_b32 v63, v67
  v_add_f32 v60, v60, v64
  v_add_f32 v61, v61, v65
  v_add_f32 v62, v62, v66
  v_add_f32 v63, v63, v67
  s_nop 0
  v_permlane16_swap_b32 v60, v62
  v_permlane16_swap_b32 v61, v63
  v_add_f32 v92, v60, v62
  v_add_f32 v93, v61, v63
  s_cmp_ge_u32 s91, 28
  s_cbranch_scc1 L_local
  buffer_store_dwordx4 v[92:95], v3, s[28:31], s46 offen sc1
L_local:
  s_lshl_b32 s50, s91, 2
  s_add_u32 s50, s50, s3
  s_cmp_lg_u32 s50, 0
  s_cbranch_scc1 L_noep
  s_lshl_b32 s50, s90, 7
  s_mov_b64 exec, 1
  buffer_store_dwordx2 v[94:95], v88, s[28:31], s50 offen
  s_mov_b64 exec, -1
L_noep:
L_noffn:
L_final:
  v_mov_b32 v24, 0
  v_mov_b32 v25, 0
  s_mov_b32 exec_hi, 0x00ffffff
  s_sleep 12
  buffer_load_dwordx4 v[128:131], v9, s[28:31], s46 offen sc1
  s_mov_b32 s58, 200000
L_p2:
  s_waitcnt vmcnt(0)
  v_cmp_eq_u64 vcc, s[56:57], v[130:131]
  s_nop 1
  v_cndmask_b32 v24, v24, v128, vcc
  v_cndmask_b32 v25, v25, v129, vcc
  s_andn2_b64 exec, exec, vcc
  s_cbranch_scc0 L_p2_ok
  s_sub_u32 s58, s58, 1
  buffer_load_dwordx4 v[128:131], v9, s[28:31], s46 offen sc1
  s_cmp_lg_u32 s58, 0
  s_cbranch_scc1 L_p2
L_p2_ok:
  s_mov_b64 exec, -1
  v_add_f32_dpp v24, v24, v24 row_ror:8 row_mask:0xf bank_mask:0xf
  v_add_f32_dpp v25, v25, v25 row_ror:8 row_mask:0xf bank_mask:0xf
  s_nop 0
  v_add_f32_dpp v24, v24, v24 row_ror:4 row_mask:0xf bank_mask:0xf
  v_add_f32_dpp v25, v25, v25 row_ror:4 row_mask:0xf bank_mask:0xf
  s_nop 0
  v_add_f32_dpp v24, v24, v24 row_ror:2 row_mask:0xf bank_mask:0xf
  v_add_f32_dpp v25, v25, v25 row_ror:2 row_mask:0xf bank_mask:0xf
  v_mov_b32 v70, v24
  v_mov_b32 v71, v25
  s_nop 0
  v_permlane16_swap_b32 v24, v70
  v_permlane16_swap_b32 v25, v71
  v_add_f32 v24, v24, v70
  v_add_f32 v25, v25, v71
  v_mov_b32 v70, v24
  v_mov_b32 v71, v25
  s_nop 0
  v_permlane32_swap_b32 v24, v70
  v_permlane32_swap_b32 v25, v71
  v_add_f32 v24, v24, v70
  v_add_f32 v25, v25, v71
  v_cvt_pk_bf16_f32 v24, v24, v25
  v_lshlrev_b32 v70, 16, v24
  v_and_b32 v71, 0xffff0000, v24
  v_add_f32 v70, v70, v89
  v_add_f32 v71, v71, v90
  v_cvt_pk_bf16_f32 v68, v70, v71
  s_mov_b64 exec, 3
  buffer_store_dword v68, v87, s[36:39], s100 offen
  s_mov_b64 exec, -1
L_end:
  s_endpgm
.section .rodata,"a"
.p2align 6
.amdhsa_kernel sequential_preLN__mha_block_cached__glu_gated_reglu__decode_kernel
  .amdhsa_next_free_vgpr 512
  .amdhsa_next_free_sgpr 102
  .amdhsa_accum_offset 256
  .amdhsa_group_segment_fixed_size 0
  .amdhsa_kernarg_size 96
  .amdhsa_user_sgpr_count 2
  .amdhsa_user_sgpr_kernarg_segment_ptr 1
  .amdhsa_system_sgpr_workgroup_id_x 1
.end_amdhsa_kernel
```
